```python
import torch

def _softmax(x, axis=-1):
    return torch.softmax(x, dim=axis)
def _gelu(x):
    return torch.nn.functional.gelu(x, approximate="tanh")
def _silu(x):
    return torch.nn.functional.silu(x)
def _sigmoid(x):
    return torch.sigmoid(x)
def _layernorm(x, axis=-1, eps=1e-5):
    m = x.mean(dim=axis, keepdim=True)
    v = x.var(dim=axis, keepdim=True, unbiased=False)
    return (x - m) / torch.sqrt(v + eps)
def _scatter_add(tgt, idx, src, axis=0):
    return tgt.clone().index_add_(axis, idx, src)
def _segment_sum(src, seg, n):
    out = torch.zeros((n,) + src.shape[1:], dtype=src.dtype)
    return out.index_add_(0, seg, src)
def _pad(x, pw):
    flat = tuple(v for pair in reversed(pw) for v in pair)
    return torch.nn.functional.pad(x, flat)

kernel_name = 'parallel_sum__linear_kernel_hedgehog__glu_gated_reglu__prompt'

def setup_inputs():

    _w = (lambda a: (lambda t: t.to(torch.bfloat16) if t.is_floating_point() else t)(torch.as_tensor(a)))
    def _A_setup():
        B, S, D, H = 1, 2048, 448, 16
        Dh = D // H
        return {
            "x": _w((lambda *s: torch.randn(*s, dtype=torch.bfloat16) * 0.05)(B, S, D)),
            "wqkv": _w((lambda *s: torch.randn(*s, dtype=torch.bfloat16) * 0.2)(D, 3 * D)),
            "w_phi": _w((lambda *s: torch.randn(*s, dtype=torch.bfloat16) * 0.2)(H, Dh, Dh) * (Dh ** -0.5)),
            "wo": _w((lambda *s: torch.randn(*s, dtype=torch.bfloat16) * 0.05)(D, D)),
        }
    _A_in = _A_setup()

    def _B_setup():
        B, S, D, F = 1, 2048, 448, 1792
        return {
            "x": _w((lambda *s: torch.randn(*s, dtype=torch.bfloat16) * 0.05)(B, S, D)),
            "W_gate": _w((lambda *s: torch.randn(*s, dtype=torch.bfloat16) * 0.4)(D, F) * (2.0 / D) ** 0.5),
            "W_up": _w((lambda *s: torch.randn(*s, dtype=torch.bfloat16) * 0.4)(D, F) * (2.0 / D) ** 0.5),
            "W_down": _w((lambda *s: torch.randn(*s, dtype=torch.bfloat16) * 0.4)(F, D) * (1.0 / F) ** 0.5),
        }
    _B_in = _B_setup()

    return {
        "A_x": _A_in["x"],
        "A_wqkv": _A_in["wqkv"],
        "A_w_phi": _A_in["w_phi"],
        "A_wo": _A_in["wo"],
        "B_x": _B_in["x"],
        "B_W_gate": _B_in["W_gate"],
        "B_W_up": _B_in["W_up"],
        "B_W_down": _B_in["W_down"],
    }

def reference(A_x, A_wqkv, A_w_phi, A_wo, B_x, B_W_gate, B_W_up, B_W_down):
    def _A_ref(x, wqkv, w_phi, wo):
        B, S, D = x.shape
        H = 16; Dh = D // H
        qkv = (lambda x, *d: x.permute(*d))((x @ wqkv).reshape(B, S, 3, H, Dh), 2, 0, 3, 1, 4)
        q, k, v = qkv[0], qkv[1], qkv[2]
        pq = torch.einsum("bhsd,hdf->bhsf", q, w_phi)
        pk = torch.einsum("bhsd,hdf->bhsf", k, w_phi)
        phi_q = torch.concatenate([_softmax(pq, axis=-1), _softmax(-pq, axis=-1)], axis=-1)
        phi_k = torch.concatenate([_softmax(pk, axis=-1), _softmax(-pk, axis=-1)], axis=-1)
        kv = torch.einsum("bhsf,bhsd->bhfd", phi_k, v)
        z  = torch.einsum("bhsf->bhf", phi_k)
        num = torch.einsum("bhqf,bhfd->bhqd", phi_q, kv)
        den = torch.einsum("bhqf,bhf->bhq", phi_q, z)[..., None] + 1e-6
        o = num / den
        return (lambda x, *d: x.permute(*d))(o, 0, 2, 1, 3).reshape(B, S, D) @ wo

    def _B_ref(x, W_gate, W_up, W_down):
        gate = torch.einsum("bsd,df->bsf", x, W_gate)
        up = torch.einsum("bsd,df->bsf", x, W_up)
        gate = gate * (lambda x, dt: x.to(dt))(gate > 0, gate.dtype)
        h = gate * up
        return torch.einsum("bsf,fd->bsd", h, W_down)

    x = A_x
    xn = _layernorm(x, axis=-1)
    return x + _A_ref(xn, A_wqkv, A_w_phi, A_wo) + _B_ref(xn, B_W_gate, B_W_up, B_W_down)
```

```asm
; @launch grid=(256,1,1) block=(512,1,1) lds=163840
.amdgcn_target "amdgcn-amd-amdhsa--gfx950"
.text
.globl parallel_sum__linear_kernel_hedgehog__glu_gated_reglu__prompt_kernel
.p2align 8
.type parallel_sum__linear_kernel_hedgehog__glu_gated_reglu__prompt_kernel,@function
parallel_sum__linear_kernel_hedgehog__glu_gated_reglu__prompt_kernel:
    s_cmp_ge_u32 s2, 256
    s_cbranch_scc1 .Lend
    s_load_dwordx2 s[4:5], s[0:1], 0
    s_load_dwordx2 s[8:9], s[0:1], 8
    s_load_dwordx2 s[20:21], s[0:1], 40
    s_load_dwordx2 s[24:25], s[0:1], 48
    s_load_dwordx2 s[40:41], s[0:1], 80
    s_load_dwordx2 s[36:37], s[0:1], 72
    s_load_dwordx2 s[12:13], s[0:1], 16
    s_load_dwordx2 s[16:17], s[0:1], 24
    s_load_dwordx2 s[28:29], s[0:1], 56
    s_load_dwordx2 s[32:33], s[0:1], 64
    v_lshrrev_b32 v252, 6, v0
    v_and_b32 v253, 63, v0
    s_mov_b32 s6, 1835008
    s_mov_b32 s7, 0x00020000
    s_mov_b32 s10, 1204224
    s_mov_b32 s11, 0x00020000
    v_readfirstlane_b32 s44, v252
    s_and_b32 s92, s2, 7
    s_lshr_b32 s93, s2, 3
    s_lshr_b32 s94, s92, 1
    s_and_b32 s48, s92, 1
    s_and_b32 s62, s93, 3
    s_lshr_b32 s49, s93, 2
    s_add_u32 s49, s49, 7
    s_and_b32 s49, s49, 7
    s_lshl_b32 s47, s94, 2
    s_add_u32 s47, s47, s62
    s_lshl_b32 s52, s44, 10
    s_lshl_b32 s53, s44, 11
    v_lshrrev_b32 v254, 3, v253
    v_and_b32 v255, 7, v253
    v_lshrrev_b32 v222, 1, v254
    v_xor_b32 v223, v255, v222
    v_lshlrev_b32 v223, 4, v223
    s_lshl_b32 s97, s47, 3
    s_add_u32 s97, s97, s44
    s_mul_i32 s97, s97, 14336
    v_mul_u32_u24 v220, 896, v254
    v_add3_u32 v220, v220, v223, s97
    v_xor_b32 v221, 64, v220
    v_add_u32 v221, 7168, v221
    s_lshl_b32 s95, s62, 1
    s_add_u32 s95, s95, s49
    s_add_u32 s95, s95, s94
    s_cmp_ge_u32 s95, 7
    s_cselect_b32 s96, 7, 0
    s_sub_u32 s95, s95, s96
    s_cmp_ge_u32 s95, 7
    s_cselect_b32 s96, 7, 0
    s_sub_u32 s95, s95, s96
    s_lshl_b32 s64, s95, 7
    s_mul_i32 s78, s95, 172032
    s_add_u32 s95, s95, 1
    s_cmp_eq_u32 s95, 7
    s_cselect_b32 s95, 0, s95
    s_lshl_b32 s65, s95, 7
    s_mul_i32 s79, s95, 172032
    s_cmp_eq_u32 s48, 0
    s_cselect_b32 s96, 0x27654310, s96
    s_cselect_b32 s96, s96, 0x17654320
    s_lshl_b32 s97, s49, 2
    s_lshr_b32 s96, s96, s97
    s_and_b32 s96, s96, 7
    s_lshl_b32 s50, s48, 3
    s_add_u32 s50, s50, s96
    v_and_b32 v222, 1, v222
    v_lshl_add_u32 v223, s44, 3, v254
    s_mul_i32 s97, s50, 56
    s_add_u32 s97, s97, 896
    s_movk_i32 s96, 896
    v_and_b32 v224, 3, v255
    v_lshlrev_b32 v224, 4, v224
    v_min_u32 v224, 40, v224
    v_lshrrev_b32 v225, 2, v255
    v_xor_b32 v225, v225, v222
    v_mad_u32_u24 v224, v225, s96, v224
    v_mul_u32_u24 v202, 2688, v223
    v_add3_u32 v202, v202, v224, s97
    s_waitcnt lgkmcnt(0)
    s_add_u32 m0, s53, 0
    s_nop 0
    buffer_load_dwordx4 v220, s[4:7], s64 offen lds
    s_add_u32 m0, s53, 1024
    s_nop 0
    buffer_load_dwordx4 v221, s[4:7], s64 offen lds
    s_add_u32 m0, s53, 16384
    s_nop 0
    buffer_load_dwordx4 v220, s[4:7], s65 offen lds
    s_add_u32 m0, s53, 17408
    s_nop 0
    buffer_load_dwordx4 v221, s[4:7], s65 offen lds
    s_add_u32 m0, s52, 32768
    s_nop 0
    buffer_load_dwordx4 v202, s[8:11], s78 offen lds
    s_add_u32 m0, s52, 40960
    s_nop 0
    buffer_load_dwordx4 v202, s[8:11], s79 offen lds
    s_add_u32 s95, s95, 1
    s_cmp_eq_u32 s95, 7
    s_cselect_b32 s95, 0, s95
    s_lshl_b32 s66, s95, 7
    s_mul_i32 s80, s95, 172032
    s_add_u32 s95, s95, 1
    s_cmp_eq_u32 s95, 7
    s_cselect_b32 s95, 0, s95
    s_lshl_b32 s67, s95, 7
    s_mul_i32 s81, s95, 172032
    s_add_u32 s95, s95, 1
    s_cmp_eq_u32 s95, 7
    s_cselect_b32 s95, 0, s95
    s_lshl_b32 s68, s95, 7
    s_mul_i32 s82, s95, 172032
    s_add_u32 s95, s95, 1
    s_cmp_eq_u32 s95, 7
    s_cselect_b32 s95, 0, s95
    s_lshl_b32 s69, s95, 7
    s_mul_i32 s83, s95, 172032
    s_add_u32 s95, s95, 1
    s_cmp_eq_u32 s95, 7
    s_cselect_b32 s95, 0, s95
    s_lshl_b32 s70, s95, 7
    s_mul_i32 s84, s95, 172032
    s_mul_i32 s71, s64, 1792
    s_mul_i32 s72, s65, 1792
    s_mul_i32 s73, s66, 1792
    s_mul_i32 s74, s67, 1792
    s_mul_i32 s75, s68, 1792
    s_mul_i32 s76, s69, 1792
    s_mul_i32 s77, s70, 1792
    s_mov_b32 s14, 25088
    s_mov_b32 s15, 0x00020000
    s_mov_b32 s18, 401408
    s_mov_b32 s19, 0x00020000
    s_mov_b32 s22, 1605632
    s_mov_b32 s23, 0x00020000
    s_mov_b32 s26, 1605632
    s_mov_b32 s27, 0x00020000
    s_mov_b32 s30, 1605632
    s_mov_b32 s31, 0x00020000
    s_mov_b32 s34, 1835008
    s_mov_b32 s35, 0x00020000
    s_mov_b32 s38, 256
    s_mov_b32 s39, 0x00020000
    s_mov_b32 s42, 16777216
    s_mov_b32 s43, 0x00020000
    v_lshlrev_b32 v204, 4, v253
    s_mul_i32 s51, s48, 7
    s_add_u32 s51, s51, s49
    s_and_b32 s45, s44, 3
    s_lshr_b32 s46, s44, 2
    s_mov_b32 s60, -1
    s_mov_b32 s61, 0
    s_lshl_b32 s96, s47, 2
    s_add_u32 s96, s96, s45
    s_mul_i32 s54, s96, 144
    s_lshl_b32 s55, s96, 7
    s_lshl_b32 s97, s94, 3
    s_add_u32 s62, s62, s97
    s_lshl_b32 s97, s48, 2
    s_add_u32 s62, s62, s97
    s_cmp_eq_u32 s49, 7
    s_cbranch_scc1 .LQ
    s_cmp_eq_u32 s46, 1
    s_cbranch_scc1 .LM1
    s_nop 4
    s_mul_i32 s96, s50, 1568
    s_add_u32 m0, s53, 155648
    s_nop 0
    buffer_load_dwordx4 v204, s[12:15], s96 offen lds
    buffer_load_dwordx4 v204, s[12:15], s96 offen offset:1024 lds
    v_bfe_u32 v115, v204, 4, 5
    v_subrev_u32 v116, 2, v115
    v_cmp_gt_u32 vcc, 26, v115
    s_nop 1
    v_cndmask_b32 v116, v116, v115, vcc
    v_lshlrev_b32 v116, 1, v116
    v_lshrrev_b32 v113, 9, v204
    v_mul_u32_u24 v113, 224, v113
    v_add_u32 v113, v113, v116
    v_add_u32 v113, s53, v113
    v_add_u32 v113, 0x26000, v113
    v_lshlrev_b32 v224, 4, v255
    v_lshlrev_b32 v225, 5, v222
    v_xor_b32 v224, v224, v225
    v_mul_u32_u24 v200, 3584, v223
    s_lshl_b32 s97, s51, 8
    v_add3_u32 v200, v200, v224, s97
    v_xor_b32 v201, 64, v200
    v_lshlrev_b32 v224, 4, v255
    v_lshlrev_b32 v225, 6, v222
    v_xor_b32 v224, v224, v225
    v_mul_u32_u24 v203, 896, v223
    s_lshl_b32 s97, s49, 7
    v_add3_u32 v203, v203, v224, s97
    v_bfe_u32 v230, v253, 4, 1
    v_lshrrev_b32 v231, 5, v253
    v_bfe_u32 v232, v253, 2, 2
    v_and_b32 v233, 3, v253
    s_add_u32 s92, s45, 0
    s_and_b32 s92, s92, 3
    s_add_u32 s93, s45, 1
    s_and_b32 s93, s93, 3
    s_add_u32 s94, s45, 2
    s_and_b32 s94, s94, 3
    s_add_u32 s95, s45, 3
    s_and_b32 s95, s95, 3
    v_bfe_u32 v224, v253, 1, 3
    v_xor_b32 v224, v224, v231
    v_lshlrev_b32 v224, 4, v224
    v_and_b32 v225, 31, v253
    v_lshl_add_u32 v234, v225, 7, v224
    s_lshl_b32 s96, s45, 12
    v_add_u32 v234, s96, v234
    v_lshlrev_b32 v206, 4, v225
    v_add_u32 v206, 0x25000, v206
    v_lshl_add_u32 v207, v231, 3, v206
    v_lshl_add_u32 v206, s45, 2, v206
    v_mov_b32 v224, 0x40000000
    v_cmp_eq_u32 vcc, 0, v253
    s_nop 1
    v_cndmask_b32 v205, v224, 0, vcc
    s_lshl_b32 s96, s92, 5
    v_xor_b32 v222, s96, v234
    s_lshl_b32 s96, s93, 5
    v_xor_b32 v223, s96, v234
    s_lshl_b32 s96, s94, 5
    v_xor_b32 v224, s96, v234
    s_lshl_b32 s96, s95, 5
    v_xor_b32 v225, s96, v234
    v_and_b32 v226, 7, v253
    v_lshlrev_b32 v227, 2, v230
    v_cmp_eq_u32 vcc, v226, v227
    v_mov_b32 v234, 0x3f803f80
    s_nop 0
    v_cndmask_b32 v176, 0, v234, vcc
    v_cndmask_b32 v177, 0, v234, vcc
    v_cndmask_b32 v178, 0, v234, vcc
    v_cndmask_b32 v179, 0, v234, vcc
    v_lshl_add_u32 v226, v231, 3, v232
    v_lshlrev_b32 v226, 7, v226
    v_lshl_add_u32 v226, v233, 3, v226
    v_lshrrev_b32 v227, 1, v232
    v_lshlrev_b32 v228, 1, v227
    v_xor_b32 v228, v228, v230
    v_xor_b32 v229, 0, v228
    v_lshl_add_u32 v229, v229, 5, v226
    s_lshl_b32 s92, s92, 11
    v_add_u32 v196, s92, v229
    s_lshl_b32 s93, s93, 11
    v_add_u32 v197, s93, v229
    s_lshl_b32 s94, s94, 11
    v_add_u32 v198, s94, v229
    s_lshl_b32 s95, s95, 11
    v_add_u32 v199, s95, v229
    v_lshl_add_u32 v229, v231, 2, v232
    v_lshlrev_b32 v229, 7, v229
    v_lshl_add_u32 v229, v233, 3, v229
    v_lshl_add_u32 v229, v228, 5, v229
    v_add_u32 v216, s92, v229
    v_xor_b32 v217, 64, v216
    v_lshl_or_b32 v228, v230, 1, v227
    v_xor_b32 v228, 0, v228
    v_lshl_add_u32 v228, v228, 5, v226
    v_lshl_add_u32 v228, v230, 13, v228
    v_add_u32 v188, s92, v228
    v_xor_b32 v189, 32, v188
    v_add_u32 v190, s93, v228
    v_xor_b32 v191, 32, v190
    v_add_u32 v192, s94, v228
    v_xor_b32 v193, 32, v192
    v_add_u32 v194, s95, v228
    v_xor_b32 v195, 32, v194
    s_lshl_b32 s96, s51, 3
    s_add_u32 s54, s54, s96
    s_add_u32 s54, s54, 0
    s_lshl_b32 s54, s54, 10
    s_lshl_b32 s96, s51, 2
    s_add_u32 s55, s55, s96
    s_add_u32 s55, s55, 0xa20000
    s_lshl_b32 s96, s62, 1
    s_add_u32 s96, s96, 0
    s_mul_i32 s57, s96, 147456
    s_lshl_b32 s59, s62, 7
    s_add_u32 s59, s59, 0xa24000
    s_lshl_b32 s56, s62, 8
    s_add_u32 s56, s56, 0xa20000
    s_lshl_b32 s97, s45, 10
    s_add_u32 s97, s97, s57
    s_lshl_b32 s85, s64, 7
    s_add_u32 s85, s85, s97
    s_lshl_b32 s86, s65, 7
    s_add_u32 s86, s86, s97
    s_lshl_b32 s87, s66, 7
    s_add_u32 s87, s87, s97
    s_lshl_b32 s88, s67, 7
    s_add_u32 s88, s88, s97
    s_lshl_b32 s89, s68, 7
    s_add_u32 s89, s89, s97
    s_lshl_b32 s90, s69, 7
    s_add_u32 s90, s90, s97
    s_lshl_b32 s91, s70, 7
    s_add_u32 s91, s91, s97
    s_bfe_u32 s96, s44, 0x10001
    s_add_u32 s96, s96, 0
    s_mul_i32 s96, s96, 28
    s_and_b32 s97, s44, 6
    s_lshl_b32 s97, s97, 3
    s_sub_u32 s96, s96, s97
    s_mul_i32 s58, s96, 896
    s_and_b32 s97, s44, 1
    s_mul_i32 s97, s97, 3584
    s_sub_u32 s63, s58, s97
    s_add_u32 s63, s63, 14336
    s_add_u32 m0, s53, 49152
    s_nop 0
    buffer_load_dwordx4 v220, s[4:7], s66 offen lds
    s_add_u32 m0, s53, 50176
    s_nop 0
    buffer_load_dwordx4 v221, s[4:7], s66 offen lds
    s_add_u32 m0, s53, 65536
    s_nop 0
    buffer_load_dwordx4 v220, s[4:7], s67 offen lds
    s_add_u32 m0, s53, 66560
    s_nop 0
    buffer_load_dwordx4 v221, s[4:7], s67 offen lds
    s_add_u32 m0, s52, 81920
    s_nop 0
    buffer_load_dwordx4 v202, s[8:11], s80 offen lds
    s_add_u32 m0, s52, 90112
    s_nop 0
    buffer_load_dwordx4 v202, s[8:11], s81 offen lds
    s_waitcnt vmcnt(8)
    s_barrier
    ds_read_b128 v[0:3], v222 offset:0
    ds_read_b64_tr_b16 v[160:161], v196 offset:32768
    ds_read_b64_tr_b16 v[162:163], v196 offset:33280
    ds_read_b128 v[4:7], v223 offset:0
    ds_read_b64_tr_b16 v[164:165], v197 offset:32768
    ds_read_b64_tr_b16 v[166:167], v197 offset:33280
    ds_read_b128 v[8:11], v224 offset:0
    ds_read_b64_tr_b16 v[168:169], v198 offset:32768
    ds_read_b64_tr_b16 v[170:171], v198 offset:33280
    s_waitcnt lgkmcnt(6)
    v_mfma_f32_32x32x16_bf16 v[144:159], v[160:163], v[0:3], 0
    v_mfma_f32_16x16x32_bf16 v[212:215], v[176:179], v[160:163], 0
    ds_read_b128 v[12:15], v225 offset:0
    ds_read_b64_tr_b16 v[172:173], v199 offset:32768
    ds_read_b64_tr_b16 v[174:175], v199 offset:33280
    s_add_u32 m0, s53, 98304
    s_nop 0
    buffer_load_dwordx4 v220, s[4:7], s68 offen lds
    s_add_u32 m0, s53, 99328
    s_nop 0
    buffer_load_dwordx4 v221, s[4:7], s68 offen lds
    v_mov_b32 v226, 0
    v_mov_b32 v227, 0
    v_mov_b32 v228, 0
    v_mov_b32 v229, 0
    v_dot2c_f32_bf16 v226, v0, v234
    s_waitcnt lgkmcnt(6)
    v_mfma_f32_32x32x16_bf16 v[144:159], v[164:167], v[4:7], v[144:159]
    ds_read_b128 v[16:19], v222 offset:16384
    ds_read_b64_tr_b16 v[160:161], v196 offset:40960
    ds_read_b64_tr_b16 v[162:163], v196 offset:41472
    s_add_u32 m0, s53, 114688
    s_nop 0
    buffer_load_dwordx4 v220, s[4:7], s69 offen lds
    v_dot2c_f32_bf16 v228, v0, v0
    v_dot2c_f32_bf16 v227, v1, v234
    v_dot2c_f32_bf16 v229, v1, v1
    v_dot2c_f32_bf16 v226, v2, v234
    v_dot2c_f32_bf16 v228, v2, v2
    v_dot2c_f32_bf16 v227, v3, v234
    s_waitcnt lgkmcnt(6)
    v_mfma_f32_32x32x16_bf16 v[144:159], v[168:171], v[8:11], v[144:159]
    ds_read_b128 v[20:23], v223 offset:16384
    ds_read_b64_tr_b16 v[164:165], v197 offset:40960
    ds_read_b64_tr_b16 v[166:167], v197 offset:41472
    v_dot2c_f32_bf16 v229, v3, v3
    v_dot2c_f32_bf16 v226, v4, v234
    v_dot2c_f32_bf16 v228, v4, v4
    v_dot2c_f32_bf16 v227, v5, v234
    v_dot2c_f32_bf16 v229, v5, v5
    v_dot2c_f32_bf16 v226, v6, v234
    s_waitcnt lgkmcnt(6)
    v_mfma_f32_32x32x16_bf16 v[144:159], v[172:175], v[12:15], v[144:159]
    ds_read_b128 v[24:27], v224 offset:16384
    ds_read_b64_tr_b16 v[168:169], v198 offset:40960
    ds_read_b64_tr_b16 v[170:171], v198 offset:41472
    s_add_u32 m0, s53, 115712
    s_nop 0
    buffer_load_dwordx4 v221, s[4:7], s69 offen lds
    v_dot2c_f32_bf16 v228, v6, v6
    v_dot2c_f32_bf16 v227, v7, v234
    v_dot2c_f32_bf16 v229, v7, v7
    s_waitcnt lgkmcnt(6)
    v_mfma_f32_32x32x16_bf16 v[144:159], v[160:163], v[16:19], v[144:159]
    v_mfma_f32_16x16x32_bf16 v[212:215], v[176:179], v[160:163], v[212:215]
    ds_read_b128 v[28:31], v225 offset:16384
    ds_read_b64_tr_b16 v[172:173], v199 offset:40960
    ds_read_b64_tr_b16 v[174:175], v199 offset:41472
    s_add_u32 m0, s52, 131072
    s_nop 0
    buffer_load_dwordx4 v202, s[8:11], s82 offen lds
    v_dot2c_f32_bf16 v226, v16, v234
    v_dot2c_f32_bf16 v228, v16, v16
    v_dot2c_f32_bf16 v227, v17, v234
    v_dot2c_f32_bf16 v229, v17, v17
    v_dot2c_f32_bf16 v226, v18, v234
    v_dot2c_f32_bf16 v228, v18, v18
    s_waitcnt lgkmcnt(6)
    v_mfma_f32_32x32x16_bf16 v[144:159], v[164:167], v[20:23], v[144:159]
    s_waitcnt vmcnt(5) lgkmcnt(0)
    s_barrier
    ds_read_b128 v[32:35], v222 offset:49152
    v_add_u32 v196, 0x10000, v196
    ds_read_b64_tr_b16 v[160:161], v196 offset:16384
    ds_read_b64_tr_b16 v[162:163], v196 offset:16896
    s_add_u32 m0, s52, 139264
    s_nop 0
    buffer_load_dwordx4 v202, s[8:11], s83 offen lds
    v_dot2c_f32_bf16 v227, v19, v234
    v_dot2c_f32_bf16 v229, v19, v19
    v_dot2c_f32_bf16 v226, v20, v234
    v_dot2c_f32_bf16 v228, v20, v20
    v_dot2c_f32_bf16 v227, v21, v234
    v_dot2c_f32_bf16 v229, v21, v21
    v_mfma_f32_32x32x16_bf16 v[144:159], v[168:171], v[24:27], v[144:159]
    ds_read_b128 v[36:39], v223 offset:49152
    v_add_u32 v197, 0x10000, v197
    ds_read_b64_tr_b16 v[164:165], v197 offset:16384
    ds_read_b64_tr_b16 v[166:167], v197 offset:16896
    s_add_u32 m0, s53, 0
    s_nop 0
    buffer_load_dwordx4 v220, s[4:7], s70 offen lds
    v_dot2c_f32_bf16 v226, v22, v234
    v_dot2c_f32_bf16 v228, v22, v22
    v_dot2c_f32_bf16 v227, v23, v234
    v_dot2c_f32_bf16 v229, v23, v23
    v_mfma_f32_32x32x16_bf16 v[144:159], v[172:175], v[28:31], v[144:159]
    ds_read_b128 v[40:43], v224 offset:49152
    v_add_u32 v198, 0x10000, v198
    ds_read_b64_tr_b16 v[168:169], v198 offset:16384
    ds_read_b64_tr_b16 v[170:171], v198 offset:16896
    s_add_u32 m0, s53, 1024
    s_nop 0
    buffer_load_dwordx4 v221, s[4:7], s70 offen lds
    s_waitcnt lgkmcnt(6)
    v_mfma_f32_32x32x16_bf16 v[144:159], v[160:163], v[32:35], v[144:159]
    v_mfma_f32_16x16x32_bf16 v[212:215], v[176:179], v[160:163], v[212:215]
    ds_read_b128 v[44:47], v225 offset:49152
    v_add_u32 v199, 0x10000, v199
    ds_read_b64_tr_b16 v[172:173], v199 offset:16384
    ds_read_b64_tr_b16 v[174:175], v199 offset:16896
    v_dot2c_f32_bf16 v226, v32, v234
    v_dot2c_f32_bf16 v228, v32, v32
    v_dot2c_f32_bf16 v227, v33, v234
    v_dot2c_f32_bf16 v229, v33, v33
    v_dot2c_f32_bf16 v226, v34, v234
    v_dot2c_f32_bf16 v228, v34, v34
    s_waitcnt lgkmcnt(6)
    v_mfma_f32_32x32x16_bf16 v[144:159], v[164:167], v[36:39], v[144:159]
    v_add_u32 v222, 0x10000, v222
    ds_read_b128 v[48:51], v222 offset:0
    ds_read_b64_tr_b16 v[160:161], v196 offset:24576
    ds_read_b64_tr_b16 v[162:163], v196 offset:25088
    s_add_u32 m0, s52, 16384
    s_nop 0
    buffer_load_dwordx4 v202, s[8:11], s84 offen lds
    v_dot2c_f32_bf16 v227, v35, v234
    v_dot2c_f32_bf16 v229, v35, v35
    v_dot2c_f32_bf16 v226, v36, v234
    v_dot2c_f32_bf16 v228, v36, v36
    v_dot2c_f32_bf16 v227, v37, v234
    v_dot2c_f32_bf16 v229, v37, v37
    s_waitcnt lgkmcnt(6)
    v_mfma_f32_32x32x16_bf16 v[144:159], v[168:171], v[40:43], v[144:159]
    v_add_u32 v223, 0x10000, v223
    ds_read_b128 v[52:55], v223 offset:0
    ds_read_b64_tr_b16 v[164:165], v197 offset:24576
    ds_read_b64_tr_b16 v[166:167], v197 offset:25088
    s_add_u32 m0, s52, 32768
    s_nop 0
    buffer_load_dwordx4 v200, s[20:23], s71 offen lds
    v_dot2c_f32_bf16 v226, v38, v234
    v_dot2c_f32_bf16 v228, v38, v38
    v_dot2c_f32_bf16 v227, v39, v234
    v_dot2c_f32_bf16 v229, v39, v39
    ds_read_u16 v236, v113 offset:0
    ds_read_u16 v244, v113 offset:56
    s_waitcnt lgkmcnt(8)
    v_mfma_f32_32x32x16_bf16 v[144:159], v[172:175], v[44:47], v[144:159]
    v_add_u32 v224, 0x10000, v224
    ds_read_b128 v[56:59], v224 offset:0
    ds_read_b64_tr_b16 v[168:169], v198 offset:24576
    ds_read_b64_tr_b16 v[170:171], v198 offset:25088
    s_add_u32 m0, s52, 40960
    s_nop 0
    buffer_load_dwordx4 v201, s[24:27], s71 offen lds
    ds_read_u16 v237, v113 offset:112
    ds_read_u16 v245, v113 offset:168
    ds_read_u16 v238, v113 offset:448
    ds_read_u16 v246, v113 offset:504
    ds_read_u16 v239, v113 offset:560
    ds_read_u16 v247, v113 offset:616
    s_waitcnt lgkmcnt(14)
    v_mfma_f32_32x32x16_bf16 v[144:159], v[160:163], v[48:51], v[144:159]
    v_mfma_f32_16x16x32_bf16 v[212:215], v[176:179], v[160:163], v[212:215]
    v_add_u32 v225, 0x10000, v225
    ds_read_b128 v[60:63], v225 offset:0
    ds_read_b64_tr_b16 v[172:173], v199 offset:24576
    ds_read_b64_tr_b16 v[174:175], v199 offset:25088
    ds_read_u16 v240, v113 offset:896
    ds_read_u16 v248, v113 offset:952
    ds_read_u16 v241, v113 offset:1008
    ds_read_u16 v249, v113 offset:1064
    ds_read_u16 v242, v113 offset:1120
    ds_read_u16 v250, v113 offset:1176
    s_waitcnt lgkmcnt(15)
    v_mfma_f32_32x32x16_bf16 v[144:159], v[164:167], v[52:55], v[144:159]
    s_waitcnt vmcnt(5) lgkmcnt(6)
    s_barrier
    ds_read_b128 v[64:67], v222 offset:32768
    v_add_u32 v196, 0x10000, v196
    ds_read_b64_tr_b16 v[160:161], v196 offset:0
    ds_read_b64_tr_b16 v[162:163], v196 offset:512
    s_add_u32 m0, s52, 49152
    s_nop 0
    buffer_load_dwordx4 v200, s[20:23], s72 offen lds
    ds_read_u16 v243, v113 offset:1232
    ds_read_u16 v251, v113 offset:1288
    v_mfma_f32_32x32x16_bf16 v[144:159], v[168:171], v[56:59], v[144:159]
    ds_read_b128 v[68:71], v223 offset:32768
    v_add_u32 v197, 0x10000, v197
    ds_read_b64_tr_b16 v[164:165], v197 offset:0
    ds_read_b64_tr_b16 v[166:167], v197 offset:512
    s_add_u32 m0, s52, 57344
    s_nop 0
    buffer_load_dwordx4 v201, s[24:27], s72 offen lds
    v_mfma_f32_32x32x16_bf16 v[144:159], v[172:175], v[60:63], v[144:159]
    ds_read_b128 v[72:75], v224 offset:32768
    v_add_u32 v198, 0x10000, v198
    ds_read_b64_tr_b16 v[168:169], v198 offset:0
    ds_read_b64_tr_b16 v[170:171], v198 offset:512
    s_add_u32 m0, s52, 65536
    s_nop 0
    buffer_load_dwordx4 v200, s[20:23], s73 offen lds
    v_lshl_or_b32 v236, v244, 16, v236
    v_lshl_or_b32 v237, v245, 16, v237
    v_lshl_or_b32 v238, v246, 16, v238
    v_lshl_or_b32 v239, v247, 16, v239
    s_waitcnt lgkmcnt(15)
    v_lshl_or_b32 v240, v248, 16, v240
    s_waitcnt lgkmcnt(13)
    v_lshl_or_b32 v241, v249, 16, v241
    s_waitcnt lgkmcnt(8)
    v_mfma_f32_32x32x16_bf16 v[144:159], v[160:163], v[64:67], v[144:159]
    v_mfma_f32_16x16x32_bf16 v[212:215], v[176:179], v[160:163], v[212:215]
    ds_read_b128 v[76:79], v225 offset:32768
    v_add_u32 v199, 0x10000, v199
    ds_read_b64_tr_b16 v[172:173], v199 offset:0
    ds_read_b64_tr_b16 v[174:175], v199 offset:512
    v_lshl_or_b32 v242, v250, 16, v242
    s_waitcnt lgkmcnt(9)
    v_lshl_or_b32 v243, v251, 16, v243
    s_mov_b32 s94, 0xcc000000
    s_mov_b32 s95, 0xcc000000
    v_cndmask_b32 v236, v236, 0, s[94:95]
    v_cndmask_b32 v237, v237, 0, s[94:95]
    v_cndmask_b32 v238, v238, 0, s[94:95]
    v_cndmask_b32 v239, v239, 0, s[94:95]
    v_cndmask_b32 v240, v240, 0, s[94:95]
    v_cndmask_b32 v241, v241, 0, s[94:95]
    s_mov_b32 s94, -1
    v_cndmask_b32 v242, v242, 0, s[94:95]
    v_cndmask_b32 v243, v243, 0, s[94:95]
    s_waitcnt lgkmcnt(6)
    v_mfma_f32_32x32x16_bf16 v[144:159], v[164:167], v[68:71], v[144:159]
    ds_read_b128 v[80:83], v222 offset:49152
    ds_read_b64_tr_b16 v[160:161], v196 offset:8192
    ds_read_b64_tr_b16 v[162:163], v196 offset:8704
    s_add_u32 m0, s52, 73728
    s_nop 0
    buffer_load_dwordx4 v201, s[24:27], s73 offen lds
    v_dot2c_f32_bf16 v226, v48, v234
    v_dot2c_f32_bf16 v228, v48, v48
    v_dot2c_f32_bf16 v227, v49, v234
    v_dot2c_f32_bf16 v229, v49, v49
    v_dot2c_f32_bf16 v226, v50, v234
    v_dot2c_f32_bf16 v228, v50, v50
    s_waitcnt lgkmcnt(6)
    v_mfma_f32_32x32x16_bf16 v[144:159], v[168:171], v[72:75], v[144:159]
    ds_read_b128 v[84:87], v223 offset:49152
    ds_read_b64_tr_b16 v[164:165], v197 offset:8192
    ds_read_b64_tr_b16 v[166:167], v197 offset:8704
    s_add_u32 m0, s52, 81920
    s_nop 0
    buffer_load_dwordx4 v200, s[20:23], s74 offen lds
    v_dot2c_f32_bf16 v227, v51, v234
    v_dot2c_f32_bf16 v229, v51, v51
    v_dot2c_f32_bf16 v226, v52, v234
    v_dot2c_f32_bf16 v228, v52, v52
    v_dot2c_f32_bf16 v227, v53, v234
    v_dot2c_f32_bf16 v229, v53, v53
    s_waitcnt lgkmcnt(6)
    v_mfma_f32_32x32x16_bf16 v[144:159], v[172:175], v[76:79], v[144:159]
    ds_read_b128 v[88:91], v224 offset:49152
    ds_read_b64_tr_b16 v[168:169], v198 offset:8192
    ds_read_b64_tr_b16 v[170:171], v198 offset:8704
    s_add_u32 m0, s52, 90112
    s_nop 0
    buffer_load_dwordx4 v201, s[24:27], s74 offen lds
    v_dot2c_f32_bf16 v226, v54, v234
    v_dot2c_f32_bf16 v228, v54, v54
    v_dot2c_f32_bf16 v227, v55, v234
    v_dot2c_f32_bf16 v229, v55, v55
    v_dot2c_f32_bf16 v226, v64, v234
    v_dot2c_f32_bf16 v228, v64, v64
    s_waitcnt lgkmcnt(6)
    v_mfma_f32_32x32x16_bf16 v[144:159], v[160:163], v[80:83], v[144:159]
    v_mfma_f32_16x16x32_bf16 v[212:215], v[176:179], v[160:163], v[212:215]
    ds_read_b128 v[92:95], v225 offset:49152
    ds_read_b64_tr_b16 v[172:173], v199 offset:8192
    ds_read_b64_tr_b16 v[174:175], v199 offset:8704
    v_dot2c_f32_bf16 v227, v65, v234
    v_dot2c_f32_bf16 v229, v65, v65
    v_dot2c_f32_bf16 v226, v66, v234
    v_dot2c_f32_bf16 v228, v66, v66
    v_dot2c_f32_bf16 v227, v67, v234
    v_dot2c_f32_bf16 v229, v67, v67
    s_waitcnt lgkmcnt(6)
    v_mfma_f32_32x32x16_bf16 v[144:159], v[164:167], v[84:87], v[144:159]
    s_waitcnt vmcnt(8) lgkmcnt(0)
    s_barrier
    v_add_u32 v222, 0xffff0000, v222
    ds_read_b128 v[96:99], v222 offset:0
    v_add_u32 v196, 0xfffe0000, v196
    ds_read_b64_tr_b16 v[160:161], v196 offset:16384
    ds_read_b64_tr_b16 v[162:163], v196 offset:16896
    s_add_u32 m0, s52, 98304
    s_nop 0
    buffer_load_dwordx4 v200, s[20:23], s75 offen lds
    s_add_u32 m0, s52, 106496
    s_nop 0
    buffer_load_dwordx4 v201, s[24:27], s75 offen lds
    v_dot2c_f32_bf16 v226, v68, v234
    v_dot2c_f32_bf16 v228, v68, v68
    v_dot2c_f32_bf16 v227, v69, v234
    v_dot2c_f32_bf16 v229, v69, v69
    v_dot2c_f32_bf16 v226, v70, v234
    v_dot2c_f32_bf16 v228, v70, v70
    v_mfma_f32_32x32x16_bf16 v[144:159], v[168:171], v[88:91], v[144:159]
    v_add_u32 v223, 0xffff0000, v223
    ds_read_b128 v[100:103], v223 offset:0
    v_add_u32 v197, 0xfffe0000, v197
    ds_read_b64_tr_b16 v[164:165], v197 offset:16384
    ds_read_b64_tr_b16 v[166:167], v197 offset:16896
    s_add_u32 m0, s52, 114688
    s_nop 0
    buffer_load_dwordx4 v200, s[20:23], s76 offen lds
    v_dot2c_f32_bf16 v227, v71, v234
    v_dot2c_f32_bf16 v229, v71, v71
    v_dot2c_f32_bf16 v226, v80, v234
    v_dot2c_f32_bf16 v228, v80, v80
    v_dot2c_f32_bf16 v227, v81, v234
    v_dot2c_f32_bf16 v229, v81, v81
    v_mfma_f32_32x32x16_bf16 v[144:159], v[172:175], v[92:95], v[144:159]
    v_add_u32 v224, 0xffff0000, v224
    ds_read_b128 v[104:107], v224 offset:0
    v_add_u32 v198, 0xfffe0000, v198
    ds_read_b64_tr_b16 v[168:169], v198 offset:16384
    ds_read_b64_tr_b16 v[170:171], v198 offset:16896
    s_add_u32 m0, s52, 122880
    s_nop 0
    buffer_load_dwordx4 v201, s[24:27], s76 offen lds
    s_add_u32 m0, s52, 131072
    s_nop 0
    buffer_load_dwordx4 v200, s[20:23], s77 offen lds
    v_dot2c_f32_bf16 v226, v82, v234
    v_dot2c_f32_bf16 v228, v82, v82
    v_dot2c_f32_bf16 v227, v83, v234
    v_dot2c_f32_bf16 v229, v83, v83
    v_dot2c_f32_bf16 v226, v84, v234
    v_dot2c_f32_bf16 v228, v84, v84
    s_waitcnt lgkmcnt(6)
    v_mfma_f32_32x32x16_bf16 v[144:159], v[160:163], v[96:99], v[144:159]
    v_mfma_f32_16x16x32_bf16 v[212:215], v[176:179], v[160:163], v[212:215]
    v_add_u32 v225, 0xffff0000, v225
    ds_read_b128 v[108:111], v225 offset:0
    v_add_u32 v199, 0xfffe0000, v199
    ds_read_b64_tr_b16 v[172:173], v199 offset:16384
    ds_read_b64_tr_b16 v[174:175], v199 offset:16896
    s_add_u32 m0, s52, 139264
    s_nop 0
    buffer_load_dwordx4 v201, s[24:27], s77 offen lds
    v_dot2c_f32_bf16 v227, v85, v234
    v_dot2c_f32_bf16 v229, v85, v85
    v_dot2c_f32_bf16 v226, v86, v234
    v_dot2c_f32_bf16 v228, v86, v86
    v_dot2c_f32_bf16 v227, v87, v234
    v_dot2c_f32_bf16 v229, v87, v87
    s_waitcnt lgkmcnt(6)
    v_mfma_f32_32x32x16_bf16 v[144:159], v[164:167], v[100:103], v[144:159]
    s_waitcnt vmcnt(12) lgkmcnt(0)
    s_barrier
    ds_read_b64_tr_b16 v[160:161], v188 offset:32768
    ds_read_b64_tr_b16 v[162:163], v188 offset:33280
    v_add_u32 v200, 128, v200
    v_add_u32 v201, 128, v201
    s_add_u32 m0, s52, 0
    s_nop 0
    buffer_load_dwordx4 v200, s[20:23], s71 offen lds
    v_dot2c_f32_bf16 v226, v96, v234
    v_dot2c_f32_bf16 v228, v96, v96
    v_dot2c_f32_bf16 v227, v97, v234
    v_dot2c_f32_bf16 v229, v97, v97
    v_dot2c_f32_bf16 v226, v98, v234
    v_dot2c_f32_bf16 v228, v98, v98
    v_mfma_f32_32x32x16_bf16 v[144:159], v[168:171], v[104:107], v[144:159]
    ds_read_b64_tr_b16 v[164:165], v189 offset:32768
    ds_read_b64_tr_b16 v[166:167], v189 offset:33280
    v_dot2c_f32_bf16 v227, v99, v234
    v_dot2c_f32_bf16 v229, v99, v99
    v_dot2c_f32_bf16 v226, v100, v234
    v_dot2c_f32_bf16 v228, v100, v100
    v_dot2c_f32_bf16 v227, v101, v234
    v_dot2c_f32_bf16 v229, v101, v101
    v_mfma_f32_32x32x16_bf16 v[144:159], v[172:175], v[108:111], v[144:159]
    ds_read_b64_tr_b16 v[168:169], v190 offset:32768
    ds_read_b64_tr_b16 v[170:171], v190 offset:33280
    s_add_u32 m0, s52, 8192
    s_nop 0
    buffer_load_dwordx4 v201, s[24:27], s71 offen lds
    v_dot2c_f32_bf16 v226, v102, v234
    v_dot2c_f32_bf16 v228, v102, v102
    v_dot2c_f32_bf16 v227, v103, v234
    v_dot2c_f32_bf16 v229, v103, v103
    s_nop 1
    v_add_f32 v226, v226, v227
    v_add_f32 v227, v228, v229
    s_waitcnt lgkmcnt(4)
    v_mfma_f32_32x32x16_bf16 v[112:127], v[160:163], v[0:3], 0
    v_mfma_f32_16x16x32_bf16 v[180:183], v[176:179], v[160:163], 0
    ds_read_b64_tr_b16 v[172:173], v191 offset:32768
    ds_read_b64_tr_b16 v[174:175], v191 offset:33280
    v_and_b32 v230, 0x1f0, v204
    v_lshlrev_b32 v230, 1, v230
    s_lshl_b32 s94, s45, 10
    s_add_u32 s94, s94, 147456
    v_add_u32 v230, s94, v230
    v_lshrrev_b32 v231, 9, v204
    v_lshl_add_u32 v231, v231, 3, v230
    s_waitcnt lgkmcnt(4)
    v_mfma_f32_32x32x16_bf16 v[128:143], v[164:167], v[0:3], 0
    v_mfma_f32_16x16x32_bf16 v[184:187], v[176:179], v[164:167], 0
    ds_read_b64_tr_b16 v[160:161], v192 offset:32768
    ds_read_b64_tr_b16 v[162:163], v192 offset:33280
    s_add_u32 m0, s52, 16384
    s_nop 0
    buffer_load_dwordx4 v200, s[20:23], s72 offen lds
    ds_write_b64 v231, v[226:227] offset:0
    s_waitcnt lgkmcnt(5)
    v_mfma_f32_32x32x16_bf16 v[112:127], v[168:171], v[4:7], v[112:127]
    ds_read_b64_tr_b16 v[164:165], v193 offset:32768
    ds_read_b64_tr_b16 v[166:167], v193 offset:33280
    s_waitcnt lgkmcnt(5)
    v_mfma_f32_32x32x16_bf16 v[128:143], v[172:175], v[4:7], v[128:143]
    ds_read_b64_tr_b16 v[168:169], v194 offset:32768
    ds_read_b64_tr_b16 v[170:171], v194 offset:33280
    s_add_u32 m0, s52, 24576
    s_nop 0
    buffer_load_dwordx4 v201, s[24:27], s72 offen lds
    ds_write_b32 v206, v212 offset:0
    s_waitcnt lgkmcnt(6)
    v_mfma_f32_32x32x16_bf16 v[112:127], v[160:163], v[8:11], v[112:127]
    ds_read_b64_tr_b16 v[172:173], v195 offset:32768
    ds_read_b64_tr_b16 v[174:175], v195 offset:33280
    s_waitcnt lgkmcnt(5)
    v_mfma_f32_32x32x16_bf16 v[128:143], v[164:167], v[8:11], v[128:143]
    s_waitcnt vmcnt(14) lgkmcnt(2)
    s_barrier
    ds_read_b64_tr_b16 v[160:161], v188 offset:49152
    ds_read_b64_tr_b16 v[162:163], v188 offset:49664
    ds_read_b128 v[220:223], v230
    ds_read_b128 v[224:227], v230 offset:16
    v_mfma_f32_32x32x16_bf16 v[112:127], v[168:171], v[12:15], v[112:127]
    ds_read_b64_tr_b16 v[164:165], v189 offset:49152
    ds_read_b64_tr_b16 v[166:167], v189 offset:49664
    s_waitcnt lgkmcnt(6)
    v_mfma_f32_32x32x16_bf16 v[128:143], v[172:175], v[12:15], v[128:143]
    ds_read_b64_tr_b16 v[168:169], v190 offset:49152
    ds_read_b64_tr_b16 v[170:171], v190 offset:49664
    s_waitcnt lgkmcnt(5)
    v_add_f32 v220, v220, v222
    v_add_f32 v221, v221, v223
    s_waitcnt lgkmcnt(4)
    v_add_f32 v224, v224, v226
    v_add_f32 v225, v225, v227
    v_add_f32 v220, v220, v224
    v_add_f32 v221, v221, v225
    v_mul_f32 v208, 0xbb124925, v220
    v_mul_f32 v221, 0x3b124925, v221
    v_fma_f32 v221, -v208, v208, v221
    v_max_f32 v221, 0, v221
    v_mfma_f32_32x32x16_bf16 v[112:127], v[160:163], v[16:19], v[112:127]
    v_mfma_f32_16x16x32_bf16 v[180:183], v[176:179], v[160:163], v[180:183]
    ds_read_b64_tr_b16 v[172:173], v191 offset:49152
    ds_read_b64_tr_b16 v[174:175], v191 offset:49664
    v_add_f32 v221, 0x3727c5ac, v221
    v_rsq_f32 v209, v221
    v_rcp_f32 v210, v221
    s_nop 0
    v_mul_f32 v211, 0x3fb8aa3b, v209
    v_bfe_u32 v254, v204, 2, 7
    s_cmp_eq_u32 s44, 0
    s_cselect_b32 s94, 0, 0x40000000
    v_or_b32 v254, s94, v254
    s_waitcnt lgkmcnt(4)
    v_mfma_f32_32x32x16_bf16 v[128:143], v[164:167], v[16:19], v[128:143]
    v_mfma_f32_16x16x32_bf16 v[184:187], v[176:179], v[164:167], v[184:187]
    ds_read_b64_tr_b16 v[160:161], v192 offset:49152
    ds_read_b64_tr_b16 v[162:163], v192 offset:49664
    buffer_load_dword v255, v254, s[36:39], 0 offen offset:128 sc1
    ds_read_b64 v[228:229], v207 offset:0
    s_waitcnt lgkmcnt(5)
    v_mfma_f32_32x32x16_bf16 v[112:127], v[168:171], v[20:23], v[112:127]
    ds_read_b64_tr_b16 v[164:165], v193 offset:49152
    ds_read_b64_tr_b16 v[166:167], v193 offset:49664
    s_waitcnt lgkmcnt(5)
    v_mfma_f32_32x32x16_bf16 v[128:143], v[172:175], v[20:23], v[128:143]
    ds_read_b64_tr_b16 v[168:169], v194 offset:49152
    ds_read_b64_tr_b16 v[170:171], v194 offset:49664
    s_waitcnt lgkmcnt(4)
    v_add_f32 v228, v228, v229
    v_mfma_f32_32x32x16_bf16 v[112:127], v[160:163], v[24:27], v[112:127]
    ds_read_b64_tr_b16 v[172:173], v195 offset:49152
    ds_read_b64_tr_b16 v[174:175], v195 offset:49664
    v_mfma_f32_32x32x2_f32 v[144:159], v228, v208, v[144:159]
    s_waitcnt lgkmcnt(4)
    v_mfma_f32_32x32x16_bf16 v[128:143], v[164:167], v[24:27], v[128:143]
    s_waitcnt vmcnt(13)
    s_barrier
    v_add_u32 v188, 0x10000, v188
    ds_read_b64_tr_b16 v[160:161], v188 offset:0
    ds_read_b64_tr_b16 v[162:163], v188 offset:512
    s_add_u32 m0, s52, 32768
    s_nop 0
    buffer_load_dwordx4 v200, s[20:23], s73 offen lds
    s_waitcnt lgkmcnt(4)
    v_mfma_f32_32x32x16_bf16 v[112:127], v[168:171], v[28:31], v[112:127]
    v_add_u32 v189, 0x10000, v189
    ds_read_b64_tr_b16 v[164:165], v189 offset:0
    ds_read_b64_tr_b16 v[166:167], v189 offset:512
    s_waitcnt lgkmcnt(4)
    v_mfma_f32_32x32x16_bf16 v[128:143], v[172:175], v[28:31], v[128:143]
    v_add_u32 v190, 0x10000, v190
    ds_read_b64_tr_b16 v[168:169], v190 offset:0
    ds_read_b64_tr_b16 v[170:171], v190 offset:512
    s_waitcnt lgkmcnt(4)
    v_mfma_f32_32x32x16_bf16 v[112:127], v[160:163], v[32:35], v[112:127]
    v_mfma_f32_16x16x32_bf16 v[180:183], v[176:179], v[160:163], v[180:183]
    v_add_u32 v191, 0x10000, v191
    ds_read_b64_tr_b16 v[172:173], v191 offset:0
    ds_read_b64_tr_b16 v[174:175], v191 offset:512
    v_cvt_pk_bf16_f32 v144, v144, v145
    v_cvt_pk_bf16_f32 v145, v146, v147
    v_cvt_pk_bf16_f32 v146, v148, v149
    v_cvt_pk_bf16_f32 v147, v150, v151
    v_cvt_pk_bf16_f32 v148, v152, v153
    v_cvt_pk_bf16_f32 v149, v154, v155
    v_cvt_pk_bf16_f32 v150, v156, v157
    v_cvt_pk_bf16_f32 v151, v158, v159
    s_waitcnt lgkmcnt(4)
    v_mfma_f32_32x32x16_bf16 v[128:143], v[164:167], v[32:35], v[128:143]
    v_mfma_f32_16x16x32_bf16 v[184:187], v[176:179], v[164:167], v[184:187]
    v_add_u32 v192, 0x10000, v192
    ds_read_b64_tr_b16 v[160:161], v192 offset:0
    ds_read_b64_tr_b16 v[162:163], v192 offset:512
    s_add_u32 m0, s52, 40960
    s_nop 0
    buffer_load_dwordx4 v201, s[24:27], s73 offen lds
    s_waitcnt lgkmcnt(4)
    v_mfma_f32_32x32x16_bf16 v[112:127], v[168:171], v[36:39], v[112:127]
    v_add_u32 v193, 0x10000, v193
    ds_read_b64_tr_b16 v[164:165], v193 offset:0
    ds_read_b64_tr_b16 v[166:167], v193 offset:512
    v_mfma_f32_32x32x16_bf16 v[220:235], v[236:239], v[144:147], 0
    v_mfma_f32_32x32x16_bf16 v[220:235], v[240:243], v[148:151], v[220:235]
    s_waitcnt lgkmcnt(4)
    v_mfma_f32_32x32x16_bf16 v[128:143], v[172:175], v[36:39], v[128:143]
    v_add_u32 v194, 0x10000, v194
    ds_read_b64_tr_b16 v[168:169], v194 offset:0
    ds_read_b64_tr_b16 v[170:171], v194 offset:512
    s_waitcnt lgkmcnt(4)
    v_mfma_f32_32x32x16_bf16 v[112:127], v[160:163], v[40:43], v[112:127]
    v_add_u32 v195, 0x10000, v195
    ds_read_b64_tr_b16 v[172:173], v195 offset:0
    ds_read_b64_tr_b16 v[174:175], v195 offset:512
    s_waitcnt lgkmcnt(4)
    v_mfma_f32_32x32x16_bf16 v[128:143], v[164:167], v[40:43], v[128:143]
    s_waitcnt vmcnt(13)
    s_barrier
    ds_read_b64_tr_b16 v[160:161], v188 offset:16384
    ds_read_b64_tr_b16 v[162:163], v188 offset:16896
    v_max3_f32 v244, v220, v221, v222
    v_min3_f32 v245, v220, v221, v222
    v_max3_f32 v244, v244, v223, v224
    v_min3_f32 v245, v245, v223, v224
    v_max3_f32 v244, v244, v225, v226
    v_min3_f32 v245, v245, v225, v226
    v_max3_f32 v244, v244, v227, v228
    v_min3_f32 v245, v245, v227, v228
    v_max3_f32 v244, v244, v229, v230
    v_min3_f32 v245, v245, v229, v230
    s_waitcnt lgkmcnt(4)
    v_mfma_f32_32x32x16_bf16 v[112:127], v[168:171], v[44:47], v[112:127]
    ds_read_b64_tr_b16 v[164:165], v189 offset:16384
    ds_read_b64_tr_b16 v[166:167], v189 offset:16896
    v_max3_f32 v244, v244, v231, v232
    v_min3_f32 v245, v245, v231, v232
    v_max_f32 v244, v244, v233
    v_min_f32 v245, v245, v233
    v_mul_f32 v245, -1.0, v245
    s_nop 1
    v_permlane32_swap_b32 v244, v245
    v_max_f32 v244, v244, v245
    v_mov_b32 v245, v244
    s_nop 1
    v_permlane32_swap_b32 v244, v245
    s_waitcnt lgkmcnt(4)
    v_mfma_f32_32x32x16_bf16 v[128:143], v[172:175], v[44:47], v[128:143]
    ds_read_b64_tr_b16 v[168:169], v190 offset:16384
    ds_read_b64_tr_b16 v[170:171], v190 offset:16896
    v_mul_f32 v244, v244, v211
    v_mul_f32 v245, v245, v211
    v_fma_f32 v144, -v220, v211, -v245
    v_fma_f32 v145, -v221, v211, -v245
    v_fma_f32 v220, v220, v211, -v244
    v_fma_f32 v221, v221, v211, -v244
    v_fma_f32 v146, -v222, v211, -v245
    v_fma_f32 v147, -v223, v211, -v245
    v_fma_f32 v222, v222, v211, -v244
    v_fma_f32 v223, v223, v211, -v244
    s_waitcnt lgkmcnt(4)
    v_mfma_f32_32x32x16_bf16 v[112:127], v[160:163], v[48:51], v[112:127]
    v_mfma_f32_16x16x32_bf16 v[180:183], v[176:179], v[160:163], v[180:183]
    ds_read_b64_tr_b16 v[172:173], v191 offset:16384
    ds_read_b64_tr_b16 v[174:175], v191 offset:16896
    v_fma_f32 v148, -v224, v211, -v245
    v_fma_f32 v149, -v225, v211, -v245
    v_fma_f32 v224, v224, v211, -v244
    v_fma_f32 v225, v225, v211, -v244
    v_fma_f32 v150, -v226, v211, -v245
    v_fma_f32 v151, -v227, v211, -v245
    v_fma_f32 v226, v226, v211, -v244
    v_fma_f32 v227, v227, v211, -v244
    v_fma_f32 v152, -v228, v211, -v245
    v_fma_f32 v153, -v229, v211, -v245
    s_waitcnt lgkmcnt(4)
    v_mfma_f32_32x32x16_bf16 v[128:143], v[164:167], v[48:51], v[128:143]
    v_mfma_f32_16x16x32_bf16 v[184:187], v[176:179], v[164:167], v[184:187]
    ds_read_b64_tr_b16 v[160:161], v192 offset:16384
    ds_read_b64_tr_b16 v[162:163], v192 offset:16896
    v_fma_f32 v228, v228, v211, -v244
    v_fma_f32 v229, v229, v211, -v244
    v_fma_f32 v154, -v230, v211, -v245
    v_fma_f32 v155, -v231, v211, -v245
    v_fma_f32 v230, v230, v211, -v244
    v_fma_f32 v231, v231, v211, -v244
    v_fma_f32 v156, -v232, v211, -v245
    v_fma_f32 v157, -v233, v211, -v245
    v_fma_f32 v232, v232, v211, -v244
    v_fma_f32 v233, v233, v211, -v244
    s_waitcnt lgkmcnt(4)
    v_mfma_f32_32x32x16_bf16 v[112:127], v[168:171], v[52:55], v[112:127]
    ds_read_b64_tr_b16 v[164:165], v193 offset:16384
    ds_read_b64_tr_b16 v[166:167], v193 offset:16896
    v_exp_f32 v144, v144
    v_exp_f32 v220, v220
    v_exp_f32 v145, v145
    v_exp_f32 v221, v221
    v_exp_f32 v146, v146
    s_waitcnt lgkmcnt(4)
    v_mfma_f32_32x32x16_bf16 v[128:143], v[172:175], v[52:55], v[128:143]
    ds_read_b64_tr_b16 v[168:169], v194 offset:16384
    ds_read_b64_tr_b16 v[170:171], v194 offset:16896
    v_exp_f32 v222, v222
    v_exp_f32 v147, v147
    v_exp_f32 v223, v223
    v_exp_f32 v148, v148
    v_exp_f32 v224, v224
    s_waitcnt lgkmcnt(4)
    v_mfma_f32_32x32x16_bf16 v[112:127], v[160:163], v[56:59], v[112:127]
    ds_read_b64_tr_b16 v[172:173], v195 offset:16384
    ds_read_b64_tr_b16 v[174:175], v195 offset:16896
    v_exp_f32 v149, v149
    v_exp_f32 v225, v225
    v_exp_f32 v150, v150
    v_exp_f32 v226, v226
    v_exp_f32 v151, v151
    s_waitcnt lgkmcnt(4)
    v_mfma_f32_32x32x16_bf16 v[128:143], v[164:167], v[56:59], v[128:143]
    s_waitcnt vmcnt(11)
    s_barrier
    ds_read_b64_tr_b16 v[160:161], v188 offset:32768
    ds_read_b64_tr_b16 v[162:163], v188 offset:33280
    s_add_u32 m0, s52, 65536
    s_nop 0
    buffer_load_dwordx4 v200, s[20:23], s74 offen lds
    v_exp_f32 v227, v227
    v_exp_f32 v152, v152
    v_exp_f32 v228, v228
    v_exp_f32 v153, v153
    v_exp_f32 v229, v229
    s_waitcnt lgkmcnt(4)
    v_mfma_f32_32x32x16_bf16 v[112:127], v[168:171], v[60:63], v[112:127]
    ds_read_b64_tr_b16 v[164:165], v189 offset:32768
    ds_read_b64_tr_b16 v[166:167], v189 offset:33280
    v_exp_f32 v154, v154
    v_exp_f32 v230, v230
    v_exp_f32 v155, v155
    v_exp_f32 v231, v231
    v_exp_f32 v156, v156
    s_waitcnt lgkmcnt(4)
    v_mfma_f32_32x32x16_bf16 v[128:143], v[172:175], v[60:63], v[128:143]
    ds_read_b64_tr_b16 v[168:169], v190 offset:32768
    ds_read_b64_tr_b16 v[170:171], v190 offset:33280
    v_exp_f32 v232, v232
    v_exp_f32 v157, v157
    v_exp_f32 v233, v233
    v_add_f32 v246, v220, v222
    v_add_f32 v247, v221, v223
    v_add_f32 v248, v144, v146
    v_add_f32 v249, v145, v147
    s_waitcnt lgkmcnt(4)
    v_mfma_f32_32x32x16_bf16 v[112:127], v[160:163], v[64:67], v[112:127]
    v_mfma_f32_16x16x32_bf16 v[180:183], v[176:179], v[160:163], v[180:183]
    ds_read_b64_tr_b16 v[172:173], v191 offset:32768
    ds_read_b64_tr_b16 v[174:175], v191 offset:33280
    v_add_f32 v246, v246, v224
    v_add_f32 v247, v247, v225
    v_add_f32 v248, v248, v148
    v_add_f32 v249, v249, v149
    v_add_f32 v246, v246, v226
    v_add_f32 v247, v247, v227
    v_add_f32 v248, v248, v150
    v_add_f32 v249, v249, v151
    v_add_f32 v246, v246, v228
    v_add_f32 v247, v247, v229
    s_waitcnt lgkmcnt(4)
    v_mfma_f32_32x32x16_bf16 v[128:143], v[164:167], v[64:67], v[128:143]
    v_mfma_f32_16x16x32_bf16 v[184:187], v[176:179], v[164:167], v[184:187]
    ds_read_b64_tr_b16 v[160:161], v192 offset:32768
    ds_read_b64_tr_b16 v[162:163], v192 offset:33280
    s_add_u32 m0, s52, 73728
    s_nop 0
    buffer_load_dwordx4 v201, s[24:27], s74 offen lds
    v_add_f32 v248, v248, v152
    v_add_f32 v249, v249, v153
    v_add_f32 v246, v246, v230
    v_add_f32 v247, v247, v231
    v_add_f32 v248, v248, v154
    v_add_f32 v249, v249, v155
    v_add_f32 v246, v246, v232
    v_add_f32 v247, v247, v233
    v_add_f32 v248, v248, v156
    v_add_f32 v249, v249, v157
    s_waitcnt lgkmcnt(4)
    v_mfma_f32_32x32x16_bf16 v[112:127], v[168:171], v[68:71], v[112:127]
    ds_read_b64_tr_b16 v[164:165], v193 offset:32768
    ds_read_b64_tr_b16 v[166:167], v193 offset:33280
    v_add_f32 v247, v246, v247
    v_add_f32 v248, v248, v249
    s_nop 1
    v_permlane32_swap_b32 v247, v248
    v_add_f32 v247, v247, v248
    v_rcp_f32 v247, v247
    s_nop 0
    v_mov_b32 v248, v247
    s_nop 1
    v_permlane32_swap_b32 v247, v248
    v_mul_f32 v220, v220, v247
    s_waitcnt lgkmcnt(4)
    v_mfma_f32_32x32x16_bf16 v[128:143], v[172:175], v[68:71], v[128:143]
    ds_read_b64_tr_b16 v[168:169], v194 offset:32768
    ds_read_b64_tr_b16 v[170:171], v194 offset:33280
    v_mul_f32 v221, v221, v247
    v_mul_f32 v144, v144, v248
    v_mul_f32 v145, v145, v248
    v_mul_f32 v222, v222, v247
    v_mul_f32 v223, v223, v247
    v_mul_f32 v146, v146, v248
    v_mul_f32 v147, v147, v248
    v_mul_f32 v224, v224, v247
    v_mul_f32 v225, v225, v247
    v_mul_f32 v148, v148, v248
    s_waitcnt lgkmcnt(4)
    v_mfma_f32_32x32x16_bf16 v[112:127], v[160:163], v[72:75], v[112:127]
    ds_read_b64_tr_b16 v[172:173], v195 offset:32768
    ds_read_b64_tr_b16 v[174:175], v195 offset:33280
    v_mul_f32 v149, v149, v248
    v_mul_f32 v226, v226, v247
    v_mul_f32 v227, v227, v247
    v_mul_f32 v150, v150, v248
    v_mul_f32 v151, v151, v248
    v_mul_f32 v228, v228, v247
    v_mul_f32 v229, v229, v247
    v_mul_f32 v152, v152, v248
    v_mul_f32 v153, v153, v248
    v_mul_f32 v230, v230, v247
    s_waitcnt lgkmcnt(4)
    v_mfma_f32_32x32x16_bf16 v[128:143], v[164:167], v[72:75], v[128:143]
    v_mul_f32 v231, v231, v247
    v_mul_f32 v154, v154, v248
    v_mul_f32 v155, v155, v248
    v_mul_f32 v232, v232, v247
    v_mul_f32 v233, v233, v247
    v_mul_f32 v156, v156, v248
    v_mul_f32 v157, v157, v248
    v_cvt_pk_bf16_f32 v220, v220, v221
    v_cvt_pk_bf16_f32 v144, v144, v145
    v_cvt_pk_bf16_f32 v221, v222, v223
    v_cvt_pk_bf16_f32 v145, v146, v147
    v_cvt_pk_bf16_f32 v222, v224, v225
    v_cvt_pk_bf16_f32 v146, v148, v149
    v_cvt_pk_bf16_f32 v223, v226, v227
    v_cvt_pk_bf16_f32 v147, v150, v151
    v_cvt_pk_bf16_f32 v224, v228, v229
    v_cvt_pk_bf16_f32 v148, v152, v153
    v_cvt_pk_bf16_f32 v225, v230, v231
    v_cvt_pk_bf16_f32 v149, v154, v155
    v_cvt_pk_bf16_f32 v226, v232, v233
    v_cvt_pk_bf16_f32 v150, v156, v157
    v_mov_b32 v227, 0
    v_mov_b32 v151, 0
    v_bfe_u32 v252, v204, 4, 3
    v_bfe_u32 v253, v204, 7, 1
    v_lshlrev_b32 v253, 2, v253
    v_xor_b32 v252, v252, v253
    v_lshrrev_b32 v253, 9, v204
    v_xor_b32 v252, v252, v253
    v_lshlrev_b32 v252, 4, v252
    v_and_b32 v253, 0x1f0, v204
    v_lshl_add_u32 v252, v253, 3, v252
    s_lshl_b32 s94, s45, 12
    s_add_u32 s94, s94, 49152
    v_add_u32 v252, s94, v252
    ds_write_b128 v252, v[220:223]
    v_xor_b32 v253, 32, v252
    ds_write_b128 v253, v[224:227]
    v_xor_b32 v253, 64, v252
    ds_write_b128 v253, v[144:147]
    v_xor_b32 v253, 96, v252
    ds_write_b128 v253, v[148:151]
    s_waitcnt vmcnt(4)
    s_cmp_lg_u32 s44, 0
    s_cbranch_scc1 .ok1
    v_cmp_ne_u32 vcc, 0, v255
    s_and_b32 s99, vcc_lo, vcc_hi
    s_and_b32 s99, s99, -1
    s_cmp_eq_u32 s99, -1
    s_cbranch_scc1 .ok1
    s_mov_b32 s98, 20000
.sp2:
    buffer_load_dword v255, v254, s[36:39], 0 offen offset:128 sc1
    s_waitcnt vmcnt(0)
    v_cmp_ne_u32 vcc, 0, v255
    s_and_b32 s99, vcc_lo, vcc_hi
    s_and_b32 s99, s99, -1
    s_cmp_eq_u32 s99, -1
    s_cbranch_scc1 .ok1
    s_sub_u32 s98, s98, 1
    s_cmp_lg_u32 s98, 0
    s_cbranch_scc1 .sp2
.ok1:
    s_nop 1
    s_waitcnt lgkmcnt(0)
    s_barrier
    ds_read_b64_tr_b16 v[160:161], v188 offset:49152
    ds_read_b64_tr_b16 v[162:163], v188 offset:49664
    s_add_u32 m0, s52, 81920
    s_nop 0
    buffer_load_dwordx4 v200, s[20:23], s75 offen lds
    v_lshrrev_b32 v248, 8, v204
    v_bfe_u32 v249, v204, 6, 2
    v_bfe_u32 v250, v204, 4, 2
    v_and_b32 v245, 1, v248
    v_lshlrev_b32 v245, 2, v245
    v_xor_b32 v244, v249, v245
    v_lshrrev_b32 v246, 1, v250
    v_lshl_add_u32 v246, s45, 1, v246
    v_xor_b32 v244, v244, v246
    v_lshlrev_b32 v244, 4, v244
    v_mfma_f32_32x32x16_bf16 v[112:127], v[168:171], v[76:79], v[112:127]
    ds_read_b64_tr_b16 v[164:165], v189 offset:49152
    ds_read_b64_tr_b16 v[166:167], v189 offset:49664
    v_and_b32 v246, 1, v250
    v_lshl_add_u32 v244, v246, 3, v244
    v_lshl_add_u32 v248, v248, 3, v249
    v_lshl_add_u32 v244, v248, 7, v244
    v_add_u32 v244, 0xc000, v244
    v_or_b32 v246, 0, v250
    v_xor_b32 v246, v246, v245
    v_lshlrev_b32 v246, 3, v246
    v_lshl_add_u32 v246, v248, 6, v246
    v_add_u32 v246, 0x26000, v246
    v_mfma_f32_32x32x16_bf16 v[128:143], v[172:175], v[76:79], v[128:143]
    ds_read_b64_tr_b16 v[168:169], v190 offset:49152
    ds_read_b64_tr_b16 v[170:171], v190 offset:49664
    v_xor_b32 v245, 64, v244
    v_xor_b32 v247, 8, v246
    ds_read_b64_tr_b16 v[220:221], v244 offset:0
    ds_read_b64_tr_b16 v[222:223], v245 offset:512
    ds_read_b64_tr_b16 v[224:225], v246 offset:0
    ds_read_b64_tr_b16 v[226:227], v247 offset:256
    ds_read_b64_tr_b16 v[228:229], v244 offset:4096
    ds_read_b64_tr_b16 v[230:231], v245 offset:4608
    ds_read_b64_tr_b16 v[232:233], v246 offset:2048
    ds_read_b64_tr_b16 v[234:235], v247 offset:2304
    s_waitcnt lgkmcnt(12)
    v_mfma_f32_32x32x16_bf16 v[112:127], v[160:163], v[80:83], v[112:127]
    v_mfma_f32_16x16x32_bf16 v[180:183], v[176:179], v[160:163], v[180:183]
    ds_read_b64_tr_b16 v[172:173], v191 offset:49152
    ds_read_b64_tr_b16 v[174:175], v191 offset:49664
    s_waitcnt lgkmcnt(12)
    v_mfma_f32_32x32x16_bf16 v[128:143], v[164:167], v[80:83], v[128:143]
    v_mfma_f32_16x16x32_bf16 v[184:187], v[176:179], v[164:167], v[184:187]
    ds_read_b64_tr_b16 v[160:161], v192 offset:49152
    ds_read_b64_tr_b16 v[162:163], v192 offset:49664
    s_add_u32 m0, s52, 90112
    s_nop 0
    buffer_load_dwordx4 v201, s[24:27], s75 offen lds
    s_waitcnt lgkmcnt(8)
    v_mfma_f32_16x16x32_bf16 v[236:239], v[220:223], v[224:227], 0
    s_waitcnt lgkmcnt(4)
    v_mfma_f32_16x16x32_bf16 v[236:239], v[228:231], v[232:235], v[236:239]
    ds_read_b64_tr_b16 v[220:221], v244 offset:8192
    ds_read_b64_tr_b16 v[222:223], v245 offset:8704
    ds_read_b64_tr_b16 v[224:225], v246 offset:4096
    ds_read_b64_tr_b16 v[226:227], v247 offset:4352
    ds_read_b64_tr_b16 v[228:229], v244 offset:12288
    ds_read_b64_tr_b16 v[230:231], v245 offset:12800
    ds_read_b64_tr_b16 v[232:233], v246 offset:6144
    ds_read_b64_tr_b16 v[234:235], v247 offset:6400
    v_mfma_f32_32x32x16_bf16 v[112:127], v[168:171], v[84:87], v[112:127]
    ds_read_b64_tr_b16 v[164:165], v193 offset:49152
    ds_read_b64_tr_b16 v[166:167], v193 offset:49664
    s_waitcnt lgkmcnt(12)
    v_mfma_f32_32x32x16_bf16 v[128:143], v[172:175], v[84:87], v[128:143]
    ds_read_b64_tr_b16 v[168:169], v194 offset:49152
    ds_read_b64_tr_b16 v[170:171], v194 offset:49664
    s_waitcnt lgkmcnt(8)
    v_mfma_f32_16x16x32_bf16 v[236:239], v[220:223], v[224:227], v[236:239]
    s_waitcnt lgkmcnt(4)
    v_mfma_f32_16x16x32_bf16 v[236:239], v[228:231], v[232:235], v[236:239]
    v_lshrrev_b32 v248, 8, v204
    v_bfe_u32 v250, v204, 4, 4
    v_lshlrev_b32 v250, 2, v250
    v_lshl_add_u32 v248, v248, 9, v250
    s_lshl_b32 s94, s50, 13
    s_lshl_b32 s95, s45, 11
    s_add_u32 s94, s94, s95
    s_add_u32 s94, s94, 10485760
    v_mfma_f32_32x32x16_bf16 v[112:127], v[160:163], v[88:91], v[112:127]
    ds_read_b64_tr_b16 v[172:173], v195 offset:49152
    ds_read_b64_tr_b16 v[174:175], v195 offset:49664
    s_waitcnt lgkmcnt(4)
    v_mfma_f32_32x32x16_bf16 v[128:143], v[164:167], v[88:91], v[128:143]
    s_barrier
    v_add_u32 v188, 0x10000, v188
    ds_read_b64_tr_b16 v[160:161], v188 offset:0
    ds_read_b64_tr_b16 v[162:163], v188 offset:512
    s_add_u32 m0, s52, 98304
    s_nop 0
    buffer_load_dwordx4 v200, s[20:23], s76 offen lds
    buffer_atomic_add_f32 v236, v248, s[40:43], s94 offen offset:0
    buffer_atomic_add_f32 v237, v248, s[40:43], s94 offen offset:128
    buffer_atomic_add_f32 v238, v248, s[40:43], s94 offen offset:256
    buffer_atomic_add_f32 v239, v248, s[40:43], s94 offen offset:384
    s_waitcnt lgkmcnt(4)
    v_mfma_f32_32x32x16_bf16 v[112:127], v[168:171], v[92:95], v[112:127]
    v_add_u32 v189, 0x10000, v189
    ds_read_b64_tr_b16 v[164:165], v189 offset:0
    ds_read_b64_tr_b16 v[166:167], v189 offset:512
    s_waitcnt lgkmcnt(4)
    v_mfma_f32_32x32x16_bf16 v[128:143], v[172:175], v[92:95], v[128:143]
    v_add_u32 v190, 0x10000, v190
    ds_read_b64_tr_b16 v[168:169], v190 offset:0
    ds_read_b64_tr_b16 v[170:171], v190 offset:512
    s_waitcnt lgkmcnt(4)
    v_mfma_f32_32x32x16_bf16 v[112:127], v[160:163], v[96:99], v[112:127]
    v_mfma_f32_16x16x32_bf16 v[180:183], v[176:179], v[160:163], v[180:183]
    v_add_u32 v191, 0x10000, v191
    ds_read_b64_tr_b16 v[172:173], v191 offset:0
    ds_read_b64_tr_b16 v[174:175], v191 offset:512
    s_waitcnt lgkmcnt(4)
    v_mfma_f32_32x32x16_bf16 v[128:143], v[164:167], v[96:99], v[128:143]
    v_mfma_f32_16x16x32_bf16 v[184:187], v[176:179], v[164:167], v[184:187]
    v_add_u32 v192, 0x10000, v192
    ds_read_b64_tr_b16 v[160:161], v192 offset:0
    ds_read_b64_tr_b16 v[162:163], v192 offset:512
    s_add_u32 m0, s52, 106496
    s_nop 0
    buffer_load_dwordx4 v201, s[24:27], s76 offen lds
    s_waitcnt lgkmcnt(4)
    v_mfma_f32_32x32x16_bf16 v[112:127], v[168:171], v[100:103], v[112:127]
    v_add_u32 v193, 0x10000, v193
    ds_read_b64_tr_b16 v[164:165], v193 offset:0
    ds_read_b64_tr_b16 v[166:167], v193 offset:512
    s_waitcnt lgkmcnt(4)
    v_mfma_f32_32x32x16_bf16 v[128:143], v[172:175], v[100:103], v[128:143]
    v_add_u32 v194, 0x10000, v194
    ds_read_b64_tr_b16 v[168:169], v194 offset:0
    ds_read_b64_tr_b16 v[170:171], v194 offset:512
    ds_write_b32 v206, v180 offset:2048
    ds_write_b32 v206, v184 offset:2560
    s_waitcnt lgkmcnt(6)
    v_mfma_f32_32x32x16_bf16 v[112:127], v[160:163], v[104:107], v[112:127]
    v_add_u32 v195, 0x10000, v195
    ds_read_b64_tr_b16 v[172:173], v195 offset:0
    ds_read_b64_tr_b16 v[174:175], v195 offset:512
    s_waitcnt lgkmcnt(6)
    v_mfma_f32_32x32x16_bf16 v[128:143], v[164:167], v[104:107], v[128:143]
    s_waitcnt lgkmcnt(2)
    s_barrier
    v_add_u32 v188, 0xfffe0000, v188
    ds_read_b64_tr_b16 v[160:161], v188 offset:0
    ds_read_b64_tr_b16 v[162:163], v188 offset:512
    s_add_u32 m0, s52, 114688
    s_nop 0
    buffer_load_dwordx4 v200, s[20:23], s77 offen lds
    ds_read_b64 v[228:229], v207 offset:2048
    ds_read_b64 v[230:231], v207 offset:2560
    v_mfma_f32_32x32x16_bf16 v[112:127], v[168:171], v[108:111], v[112:127]
    v_add_u32 v189, 0xfffe0000, v189
    ds_read_b64_tr_b16 v[164:165], v189 offset:0
    ds_read_b64_tr_b16 v[166:167], v189 offset:512
    s_waitcnt lgkmcnt(6)
    v_mfma_f32_32x32x16_bf16 v[128:143], v[172:175], v[108:111], v[128:143]
    v_add_u32 v190, 0xfffe0000, v190
    ds_read_b64_tr_b16 v[168:169], v190 offset:0
    ds_read_b64_tr_b16 v[170:171], v190 offset:512
    s_add_u32 m0, s52, 122880
    s_nop 0
    buffer_load_dwordx4 v201, s[24:27], s77 offen lds
    s_waitcnt lgkmcnt(5)
    v_add_f32 v228, v228, v229
    s_waitcnt lgkmcnt(4)
    v_add_f32 v230, v230, v231
    v_mfma_f32_32x32x16_bf16 v[144:159], v[160:163], v[0:3], 0
    v_mfma_f32_16x16x32_bf16 v[180:183], v[176:179], v[160:163], 0
    v_add_u32 v191, 0xfffe0000, v191
    ds_read_b64_tr_b16 v[172:173], v191 offset:0
    ds_read_b64_tr_b16 v[174:175], v191 offset:512
    v_mfma_f32_32x32x2_f32 v[112:127], v228, v208, v[112:127]
    s_waitcnt lgkmcnt(4)
    v_mfma_f32_32x32x16_bf16 v[236:251], v[164:167], v[0:3], 0
    v_mfma_f32_16x16x32_bf16 v[184:187], v[176:179], v[164:167], 0
    v_add_u32 v192, 0xfffe0000, v192
    ds_read_b64_tr_b16 v[160:161], v192 offset:0
    ds_read_b64_tr_b16 v[162:163], v192 offset:512
    s_add_u32 s92, s71, 0
    s_add_u32 m0, s52, 49152
    s_nop 0
    buffer_load_dwordx4 v203, s[28:31], s92 offen lds
    v_mfma_f32_32x32x2_f32 v[128:143], v230, v208, v[128:143]
    s_waitcnt lgkmcnt(4)
    v_mfma_f32_32x32x16_bf16 v[144:159], v[168:171], v[4:7], v[144:159]
    v_add_u32 v193, 0xfffe0000, v193
    ds_read_b64_tr_b16 v[164:165], v193 offset:0
    ds_read_b64_tr_b16 v[166:167], v193 offset:512
    s_lshl_b32 s95, s50, 9
    s_lshl_b32 s94, s47, 5
    s_add_u32 s95, s95, s94
    s_lshl_b32 s94, s44, 2
    s_add_u32 s95, s95, s94
    s_add_u32 s95, s95, 10637312
    v_mov_b32 v255, 1
    s_waitcnt vmcnt(4)
    buffer_store_dword v255, v205, s[40:43], s95 offen sc1
    s_waitcnt lgkmcnt(4)
    v_mfma_f32_32x32x16_bf16 v[236:251], v[172:175], v[4:7], v[236:251]
    v_add_u32 v194, 0xfffe0000, v194
    ds_read_b64_tr_b16 v[168:169], v194 offset:0
    ds_read_b64_tr_b16 v[170:171], v194 offset:512
    s_add_u32 s93, s71, 114688
    s_add_u32 m0, s52, 57344
    s_nop 0
    buffer_load_dwordx4 v203, s[28:31], s93 offen lds
    s_waitcnt lgkmcnt(4)
    v_mfma_f32_32x32x16_bf16 v[144:159], v[160:163], v[8:11], v[144:159]
    v_add_u32 v195, 0xfffe0000, v195
    ds_read_b64_tr_b16 v[172:173], v195 offset:0
    ds_read_b64_tr_b16 v[174:175], v195 offset:512
    s_waitcnt lgkmcnt(4)
    v_mfma_f32_32x32x16_bf16 v[236:251], v[164:167], v[8:11], v[236:251]
    s_barrier
    ds_read_b64_tr_b16 v[160:161], v188 offset:16384
    ds_read_b64_tr_b16 v[162:163], v188 offset:16896
    s_add_u32 s92, s72, 0
    s_add_u32 m0, s52, 131072
    s_nop 0
    buffer_load_dwordx4 v203, s[28:31], s92 offen lds
    s_waitcnt lgkmcnt(4)
    v_mfma_f32_32x32x16_bf16 v[144:159], v[168:171], v[12:15], v[144:159]
    ds_read_b64_tr_b16 v[164:165], v189 offset:16384
    ds_read_b64_tr_b16 v[166:167], v189 offset:16896
    v_max_f32 v112, 0, v112
    v_mul_f32 v120, v120, v210
    v_mul_f32 v121, v121, v210
    v_max_f32 v113, 0, v113
    v_max_f32 v114, 0, v114
    v_mul_f32 v122, v122, v210
    v_mul_f32 v123, v123, v210
    v_max_f32 v115, 0, v115
    v_max_f32 v116, 0, v116
    v_mul_f32 v124, v124, v210
    v_mul_f32 v125, v125, v210
    v_max_f32 v117, 0, v117
    s_waitcnt lgkmcnt(4)
    v_mfma_f32_32x32x16_bf16 v[236:251], v[172:175], v[12:15], v[236:251]
    ds_read_b64_tr_b16 v[168:169], v190 offset:16384
    ds_read_b64_tr_b16 v[170:171], v190 offset:16896
    v_max_f32 v118, 0, v118
    v_mul_f32 v126, v126, v210
    v_mul_f32 v127, v127, v210
    v_max_f32 v119, 0, v119
    v_mul_f32 v112, v112, v120
    v_mul_f32 v113, v113, v121
    v_mul_f32 v114, v114, v122
    v_mul_f32 v115, v115, v123
    v_mul_f32 v116, v116, v124
    v_mul_f32 v117, v117, v125
    v_mul_f32 v118, v118, v126
    v_mul_f32 v119, v119, v127
    s_waitcnt lgkmcnt(4)
    v_mfma_f32_32x32x16_bf16 v[144:159], v[160:163], v[16:19], v[144:159]
    v_mfma_f32_16x16x32_bf16 v[180:183], v[176:179], v[160:163], v[180:183]
    ds_read_b64_tr_b16 v[172:173], v191 offset:16384
    ds_read_b64_tr_b16 v[174:175], v191 offset:16896
    v_cvt_pk_bf16_f32 v112, v112, v113
    v_cvt_pk_bf16_f32 v113, v114, v115
    v_cvt_pk_bf16_f32 v114, v116, v117
    v_cvt_pk_bf16_f32 v115, v118, v119
    s_add_u32 s94, s54, 0
    buffer_store_dwordx4 v[112:115], v204, s[40:43], s94 offen sc1
    v_max_f32 v128, 0, v128
    v_mul_f32 v136, v136, v210
    v_mul_f32 v137, v137, v210
    v_max_f32 v129, 0, v129
    v_max_f32 v130, 0, v130
    v_mul_f32 v138, v138, v210
    v_mul_f32 v139, v139, v210
    s_waitcnt lgkmcnt(4)
    v_mfma_f32_32x32x16_bf16 v[236:251], v[164:167], v[16:19], v[236:251]
    v_mfma_f32_16x16x32_bf16 v[184:187], v[176:179], v[164:167], v[184:187]
    ds_read_b64_tr_b16 v[160:161], v192 offset:16384
    ds_read_b64_tr_b16 v[162:163], v192 offset:16896
    s_add_u32 s93, s72, 114688
    s_add_u32 m0, s52, 139264
    s_nop 0
    buffer_load_dwordx4 v203, s[28:31], s93 offen lds
    v_max_f32 v131, 0, v131
    v_max_f32 v132, 0, v132
    v_mul_f32 v140, v140, v210
    v_mul_f32 v141, v141, v210
    v_max_f32 v133, 0, v133
    v_max_f32 v134, 0, v134
    v_mul_f32 v142, v142, v210
    v_mul_f32 v143, v143, v210
    v_max_f32 v135, 0, v135
    v_mul_f32 v128, v128, v136
    v_mul_f32 v129, v129, v137
    v_mul_f32 v130, v130, v138
    s_waitcnt lgkmcnt(4)
    v_mfma_f32_32x32x16_bf16 v[144:159], v[168:171], v[20:23], v[144:159]
    ds_read_b64_tr_b16 v[164:165], v193 offset:16384
    ds_read_b64_tr_b16 v[166:167], v193 offset:16896
    v_mul_f32 v131, v131, v139
    v_mul_f32 v132, v132, v140
    v_mul_f32 v133, v133, v141
    v_mul_f32 v134, v134, v142
    v_mul_f32 v135, v135, v143
    v_cvt_pk_bf16_f32 v128, v128, v129
    v_cvt_pk_bf16_f32 v129, v130, v131
    v_cvt_pk_bf16_f32 v130, v132, v133
    v_cvt_pk_bf16_f32 v131, v134, v135
    s_add_u32 s94, s54, 1024
    buffer_store_dwordx4 v[128:131], v204, s[40:43], s94 offen sc1
    v_lshrrev_b32 v220, 7, v204
    v_lshl_add_u32 v220, s44, 3, v220
    s_waitcnt lgkmcnt(4)
    v_mfma_f32_32x32x16_bf16 v[236:251], v[172:175], v[20:23], v[236:251]
    ds_read_b64_tr_b16 v[168:169], v194 offset:16384
    ds_read_b64_tr_b16 v[170:171], v194 offset:16896
    v_and_b32 v221, 0x70, v204
    v_mul_u32_u24 v222, 896, v220
    v_add_u32 v222, v222, v221
    s_mul_i32 s96, s62, 57344
    s_lshl_b32 s97, s49, 7
    s_add_u32 s96, s96, s97
    buffer_load_dwordx4 v[224:227], v222, s[4:7], s96 offen
    s_lshr_b32 s94, s45, 1
    s_lshl_b32 s94, s94, 3
    s_and_b32 s95, s45, 1
    s_add_u32 s94, s94, s95
    s_lshl_b32 s94, s94, 11
    s_add_u32 s57, s57, s94
    s_add_u32 s57, s57, 114688
    v_lshrrev_b32 v196, 2, v204
    s_cmp_eq_u32 s44, 0
    s_cselect_b32 s94, 0, 0x40000000
    s_waitcnt lgkmcnt(4)
    v_mfma_f32_32x32x16_bf16 v[144:159], v[160:163], v[24:27], v[144:159]
    ds_read_b64_tr_b16 v[172:173], v195 offset:16384
    ds_read_b64_tr_b16 v[174:175], v195 offset:16896
    v_or_b32 v196, s94, v196
    v_and_b32 v198, 0x4000007f, v196
    s_waitcnt lgkmcnt(4)
    v_mfma_f32_32x32x16_bf16 v[236:251], v[164:167], v[24:27], v[236:251]
    s_barrier
    ds_read_b64_tr_b16 v[160:161], v188 offset:32768
    ds_read_b64_tr_b16 v[162:163], v188 offset:33280
    s_add_u32 s92, s73, 0
    s_add_u32 m0, s52, 0
    s_nop 0
    buffer_load_dwordx4 v203, s[28:31], s92 offen lds
    s_waitcnt lgkmcnt(4)
    v_mfma_f32_32x32x16_bf16 v[144:159], v[168:171], v[28:31], v[144:159]
    ds_read_b64_tr_b16 v[164:165], v189 offset:32768
    ds_read_b64_tr_b16 v[166:167], v189 offset:33280
    s_waitcnt lgkmcnt(4)
    v_mfma_f32_32x32x16_bf16 v[236:251], v[172:175], v[28:31], v[236:251]
    ds_read_b64_tr_b16 v[168:169], v190 offset:32768
    ds_read_b64_tr_b16 v[170:171], v190 offset:33280
    s_waitcnt lgkmcnt(4)
    v_mfma_f32_32x32x16_bf16 v[144:159], v[160:163], v[32:35], v[144:159]
    v_mfma_f32_16x16x32_bf16 v[180:183], v[176:179], v[160:163], v[180:183]
    ds_read_b64_tr_b16 v[172:173], v191 offset:32768
    ds_read_b64_tr_b16 v[174:175], v191 offset:33280
    s_waitcnt lgkmcnt(4)
    v_mfma_f32_32x32x16_bf16 v[236:251], v[164:167], v[32:35], v[236:251]
    v_mfma_f32_16x16x32_bf16 v[184:187], v[176:179], v[164:167], v[184:187]
    ds_read_b64_tr_b16 v[160:161], v192 offset:32768
    ds_read_b64_tr_b16 v[162:163], v192 offset:33280
    s_add_u32 s93, s73, 114688
    s_add_u32 m0, s52, 8192
    s_nop 0
    buffer_load_dwordx4 v203, s[28:31], s93 offen lds
    s_waitcnt lgkmcnt(4)
    v_mfma_f32_32x32x16_bf16 v[144:159], v[168:171], v[36:39], v[144:159]
    ds_read_b64_tr_b16 v[164:165], v193 offset:32768
    ds_read_b64_tr_b16 v[166:167], v193 offset:33280
    s_waitcnt lgkmcnt(4)
    v_mfma_f32_32x32x16_bf16 v[236:251], v[172:175], v[36:39], v[236:251]
    ds_read_b64_tr_b16 v[168:169], v194 offset:32768
    ds_read_b64_tr_b16 v[170:171], v194 offset:33280
    s_waitcnt lgkmcnt(4)
    v_mfma_f32_32x32x16_bf16 v[144:159], v[160:163], v[40:43], v[144:159]
    ds_read_b64_tr_b16 v[172:173], v195 offset:32768
    ds_read_b64_tr_b16 v[174:175], v195 offset:33280
    s_waitcnt lgkmcnt(4)
    v_mfma_f32_32x32x16_bf16 v[236:251], v[164:167], v[40:43], v[236:251]
    s_barrier
    v_add_u32 v188, 0x10000, v188
    ds_read_b64_tr_b16 v[160:161], v188 offset:0
    ds_read_b64_tr_b16 v[162:163], v188 offset:512
    s_add_u32 s92, s74, 0
    s_add_u32 m0, s52, 16384
    s_nop 0
    buffer_load_dwordx4 v203, s[28:31], s92 offen lds
    s_waitcnt lgkmcnt(4)
    v_mfma_f32_32x32x16_bf16 v[144:159], v[168:171], v[44:47], v[144:159]
    v_add_u32 v189, 0x10000, v189
    ds_read_b64_tr_b16 v[164:165], v189 offset:0
    ds_read_b64_tr_b16 v[166:167], v189 offset:512
    s_add_u32 s95, s55, 0
    v_mov_b32 v255, 1
    s_waitcnt vmcnt(4)
    buffer_store_dword v255, v205, s[40:43], s95 offen sc1
    s_waitcnt lgkmcnt(4)
    v_mfma_f32_32x32x16_bf16 v[236:251], v[172:175], v[44:47], v[236:251]
    v_add_u32 v190, 0x10000, v190
    ds_read_b64_tr_b16 v[168:169], v190 offset:0
    ds_read_b64_tr_b16 v[170:171], v190 offset:512
    s_waitcnt lgkmcnt(4)
    v_mfma_f32_32x32x16_bf16 v[144:159], v[160:163], v[48:51], v[144:159]
    v_mfma_f32_16x16x32_bf16 v[180:183], v[176:179], v[160:163], v[180:183]
    v_add_u32 v191, 0x10000, v191
    ds_read_b64_tr_b16 v[172:173], v191 offset:0
    ds_read_b64_tr_b16 v[174:175], v191 offset:512
    s_waitcnt lgkmcnt(4)
    v_mfma_f32_32x32x16_bf16 v[236:251], v[164:167], v[48:51], v[236:251]
    v_mfma_f32_16x16x32_bf16 v[184:187], v[176:179], v[164:167], v[184:187]
    v_add_u32 v192, 0x10000, v192
    ds_read_b64_tr_b16 v[160:161], v192 offset:0
    ds_read_b64_tr_b16 v[162:163], v192 offset:512
    s_add_u32 s93, s74, 114688
    s_add_u32 m0, s52, 24576
    s_nop 0
    buffer_load_dwordx4 v203, s[28:31], s93 offen lds
    s_waitcnt lgkmcnt(4)
    v_mfma_f32_32x32x16_bf16 v[144:159], v[168:171], v[52:55], v[144:159]
    v_add_u32 v193, 0x10000, v193
    ds_read_b64_tr_b16 v[164:165], v193 offset:0
    ds_read_b64_tr_b16 v[166:167], v193 offset:512
    s_waitcnt lgkmcnt(4)
    v_mfma_f32_32x32x16_bf16 v[236:251], v[172:175], v[52:55], v[236:251]
    v_add_u32 v194, 0x10000, v194
    ds_read_b64_tr_b16 v[168:169], v194 offset:0
    ds_read_b64_tr_b16 v[170:171], v194 offset:512
    s_waitcnt lgkmcnt(4)
    v_mfma_f32_32x32x16_bf16 v[144:159], v[160:163], v[56:59], v[144:159]
    v_add_u32 v195, 0x10000, v195
    ds_read_b64_tr_b16 v[172:173], v195 offset:0
    ds_read_b64_tr_b16 v[174:175], v195 offset:512
    s_waitcnt lgkmcnt(4)
    v_mfma_f32_32x32x16_bf16 v[236:251], v[164:167], v[56:59], v[236:251]
    s_barrier
    ds_read_b64_tr_b16 v[160:161], v188 offset:16384
    ds_read_b64_tr_b16 v[162:163], v188 offset:16896
    s_add_u32 s92, s75, 0
    s_add_u32 m0, s52, 32768
    s_nop 0
    buffer_load_dwordx4 v203, s[28:31], s92 offen lds
    s_waitcnt lgkmcnt(4)
    v_mfma_f32_32x32x16_bf16 v[144:159], v[168:171], v[60:63], v[144:159]
    ds_read_b64_tr_b16 v[164:165], v189 offset:16384
    ds_read_b64_tr_b16 v[166:167], v189 offset:16896
    s_waitcnt lgkmcnt(4)
    v_mfma_f32_32x32x16_bf16 v[236:251], v[172:175], v[60:63], v[236:251]
    ds_read_b64_tr_b16 v[168:169], v190 offset:16384
    ds_read_b64_tr_b16 v[170:171], v190 offset:16896
    s_waitcnt lgkmcnt(4)
    v_mfma_f32_32x32x16_bf16 v[144:159], v[160:163], v[64:67], v[144:159]
    v_mfma_f32_16x16x32_bf16 v[180:183], v[176:179], v[160:163], v[180:183]
    ds_read_b64_tr_b16 v[172:173], v191 offset:16384
    ds_read_b64_tr_b16 v[174:175], v191 offset:16896
    s_waitcnt lgkmcnt(4)
    v_mfma_f32_32x32x16_bf16 v[236:251], v[164:167], v[64:67], v[236:251]
    v_mfma_f32_16x16x32_bf16 v[184:187], v[176:179], v[164:167], v[184:187]
    ds_read_b64_tr_b16 v[160:161], v192 offset:16384
    ds_read_b64_tr_b16 v[162:163], v192 offset:16896
    s_add_u32 s93, s75, 114688
    s_add_u32 m0, s52, 40960
    s_nop 0
    buffer_load_dwordx4 v203, s[28:31], s93 offen lds
    s_waitcnt lgkmcnt(4)
    v_mfma_f32_32x32x16_bf16 v[144:159], v[168:171], v[68:71], v[144:159]
    ds_read_b64_tr_b16 v[164:165], v193 offset:16384
    ds_read_b64_tr_b16 v[166:167], v193 offset:16896
    s_waitcnt lgkmcnt(4)
    v_mfma_f32_32x32x16_bf16 v[236:251], v[172:175], v[68:71], v[236:251]
    ds_read_b64_tr_b16 v[168:169], v194 offset:16384
    ds_read_b64_tr_b16 v[170:171], v194 offset:16896
    s_waitcnt lgkmcnt(4)
    v_mfma_f32_32x32x16_bf16 v[144:159], v[160:163], v[72:75], v[144:159]
    ds_read_b64_tr_b16 v[172:173], v195 offset:16384
    ds_read_b64_tr_b16 v[174:175], v195 offset:16896
    s_waitcnt lgkmcnt(4)
    v_mfma_f32_32x32x16_bf16 v[236:251], v[164:167], v[72:75], v[236:251]
    s_barrier
    ds_read_b64_tr_b16 v[160:161], v188 offset:32768
    ds_read_b64_tr_b16 v[162:163], v188 offset:33280
    s_add_u32 s92, s76, 0
    s_add_u32 m0, s52, 65536
    s_nop 0
    buffer_load_dwordx4 v203, s[28:31], s92 offen lds
    buffer_load_dword v197, v196, s[40:43], s56 offen sc1
    s_waitcnt lgkmcnt(4)
    v_mfma_f32_32x32x16_bf16 v[144:159], v[168:171], v[76:79], v[144:159]
    ds_read_b64_tr_b16 v[164:165], v189 offset:32768
    ds_read_b64_tr_b16 v[166:167], v189 offset:33280
    s_waitcnt lgkmcnt(4)
    v_mfma_f32_32x32x16_bf16 v[236:251], v[172:175], v[76:79], v[236:251]
    ds_read_b64_tr_b16 v[168:169], v190 offset:32768
    ds_read_b64_tr_b16 v[170:171], v190 offset:33280
    s_waitcnt lgkmcnt(4)
    v_mfma_f32_32x32x16_bf16 v[144:159], v[160:163], v[80:83], v[144:159]
    v_mfma_f32_16x16x32_bf16 v[180:183], v[176:179], v[160:163], v[180:183]
    ds_read_b64_tr_b16 v[172:173], v191 offset:32768
    ds_read_b64_tr_b16 v[174:175], v191 offset:33280
    s_waitcnt lgkmcnt(4)
    v_mfma_f32_32x32x16_bf16 v[236:251], v[164:167], v[80:83], v[236:251]
    v_mfma_f32_16x16x32_bf16 v[184:187], v[176:179], v[164:167], v[184:187]
    ds_read_b64_tr_b16 v[160:161], v192 offset:32768
    ds_read_b64_tr_b16 v[162:163], v192 offset:33280
    s_add_u32 s93, s76, 114688
    s_add_u32 m0, s52, 73728
    s_nop 0
    buffer_load_dwordx4 v203, s[28:31], s93 offen lds
    s_waitcnt lgkmcnt(4)
    v_mfma_f32_32x32x16_bf16 v[144:159], v[168:171], v[84:87], v[144:159]
    ds_read_b64_tr_b16 v[164:165], v193 offset:32768
    ds_read_b64_tr_b16 v[166:167], v193 offset:33280
    buffer_load_dword v199, v196, s[40:43], s56 offen sc1
    s_waitcnt lgkmcnt(4)
    v_mfma_f32_32x32x16_bf16 v[236:251], v[172:175], v[84:87], v[236:251]
    ds_read_b64_tr_b16 v[168:169], v194 offset:32768
    ds_read_b64_tr_b16 v[170:171], v194 offset:33280
    s_waitcnt lgkmcnt(4)
    v_mfma_f32_32x32x16_bf16 v[144:159], v[160:163], v[88:91], v[144:159]
    ds_read_b64_tr_b16 v[172:173], v195 offset:32768
    ds_read_b64_tr_b16 v[174:175], v195 offset:33280
    s_mov_b32 s98, 20001
    s_waitcnt vmcnt(2)
    s_cmp_lg_u32 s44, 0
    s_cbranch_scc1 .ok3
    v_cmp_ne_u32 vcc, 0, v197
    s_and_b32 s99, vcc_lo, vcc_hi
    s_and_b32 s99, s99, 0x3fff3fff
    s_cmp_eq_u32 s99, 0x3fff3fff
    s_cbranch_scc1 .ok3
    s_mov_b32 s98, 20000
.sp4:
    buffer_load_dword v197, v196, s[40:43], s56 offen sc1
    s_waitcnt vmcnt(1)
    v_cmp_ne_u32 vcc, 0, v199
    s_and_b32 s99, vcc_lo, vcc_hi
    s_and_b32 s99, s99, 0x3fff3fff
    s_cmp_eq_u32 s99, 0x3fff3fff
    s_cbranch_scc1 .ok3
    buffer_load_dword v199, v196, s[40:43], s56 offen sc1
    s_waitcnt vmcnt(1)
    v_cmp_ne_u32 vcc, 0, v197
    s_and_b32 s99, vcc_lo, vcc_hi
    s_and_b32 s99, s99, 0x3fff3fff
    s_cmp_eq_u32 s99, 0x3fff3fff
    s_cbranch_scc1 .ok3
    s_sub_u32 s98, s98, 1
    s_cmp_lg_u32 s98, 0
    s_cbranch_scc1 .sp4
.ok3:
    s_nop 1
    s_waitcnt lgkmcnt(4)
    v_mfma_f32_32x32x16_bf16 v[236:251], v[164:167], v[88:91], v[236:251]
    s_barrier
    ds_read_b64_tr_b16 v[160:161], v188 offset:49152
    ds_read_b64_tr_b16 v[162:163], v188 offset:49664
    s_add_u32 s92, s77, 0
    s_add_u32 m0, s52, 81920
    s_nop 0
    buffer_load_dwordx4 v203, s[28:31], s92 offen lds
    s_add_u32 s94, s85, 0
    buffer_load_dwordx4 v[0:3], v204, s[40:43], s94 offen
    s_waitcnt lgkmcnt(4)
    v_mfma_f32_32x32x16_bf16 v[144:159], v[168:171], v[92:95], v[144:159]
    ds_read_b64_tr_b16 v[164:165], v189 offset:49152
    ds_read_b64_tr_b16 v[166:167], v189 offset:49664
    s_add_u32 s94, s85, 8192
    buffer_load_dwordx4 v[4:7], v204, s[40:43], s94 offen
    s_waitcnt lgkmcnt(4)
    v_mfma_f32_32x32x16_bf16 v[236:251], v[172:175], v[92:95], v[236:251]
    ds_read_b64_tr_b16 v[168:169], v190 offset:49152
    ds_read_b64_tr_b16 v[170:171], v190 offset:49664
    s_add_u32 s94, s86, 0
    buffer_load_dwordx4 v[8:11], v204, s[40:43], s94 offen
    s_waitcnt lgkmcnt(4)
    v_mfma_f32_32x32x16_bf16 v[144:159], v[160:163], v[96:99], v[144:159]
    v_mfma_f32_16x16x32_bf16 v[180:183], v[176:179], v[160:163], v[180:183]
    ds_read_b64_tr_b16 v[172:173], v191 offset:49152
    ds_read_b64_tr_b16 v[174:175], v191 offset:49664
    s_add_u32 s94, s86, 8192
    buffer_load_dwordx4 v[12:15], v204, s[40:43], s94 offen
    s_waitcnt lgkmcnt(4)
    v_mfma_f32_32x32x16_bf16 v[236:251], v[164:167], v[96:99], v[236:251]
    v_mfma_f32_16x16x32_bf16 v[184:187], v[176:179], v[164:167], v[184:187]
    ds_read_b64_tr_b16 v[160:161], v192 offset:49152
    ds_read_b64_tr_b16 v[162:163], v192 offset:49664
    s_add_u32 s93, s77, 114688
    s_add_u32 m0, s52, 90112
    s_nop 0
    buffer_load_dwordx4 v203, s[28:31], s93 offen lds
    s_add_u32 s94, s87, 0
    buffer_load_dwordx4 v[16:19], v204, s[40:43], s94 offen
    s_waitcnt lgkmcnt(4)
    v_mfma_f32_32x32x16_bf16 v[144:159], v[168:171], v[100:103], v[144:159]
    ds_read_b64_tr_b16 v[164:165], v193 offset:49152
    ds_read_b64_tr_b16 v[166:167], v193 offset:49664
    s_add_u32 s94, s87, 8192
    buffer_load_dwordx4 v[20:23], v204, s[40:43], s94 offen
    s_waitcnt lgkmcnt(4)
    v_mfma_f32_32x32x16_bf16 v[236:251], v[172:175], v[100:103], v[236:251]
    ds_read_b64_tr_b16 v[168:169], v194 offset:49152
    ds_read_b64_tr_b16 v[170:171], v194 offset:49664
    s_waitcnt lgkmcnt(4)
    v_mfma_f32_32x32x16_bf16 v[144:159], v[160:163], v[104:107], v[144:159]
    ds_read_b64_tr_b16 v[172:173], v195 offset:49152
    ds_read_b64_tr_b16 v[174:175], v195 offset:49664
    s_waitcnt lgkmcnt(4)
    v_mfma_f32_32x32x16_bf16 v[236:251], v[164:167], v[104:107], v[236:251]
    ds_write_b32 v206, v180 offset:0
    ds_write_b32 v206, v184 offset:512
    s_waitcnt lgkmcnt(0)
    s_barrier
    ds_read_b64_tr_b16 v[160:161], v216 offset:49152
    ds_read_b64_tr_b16 v[162:163], v216 offset:50176
    s_add_u32 s92, s71, 57344
    s_add_u32 m0, s52, 98304
    s_nop 0
    buffer_load_dwordx4 v203, s[28:31], s92 offen lds
    ds_read_b64 v[228:229], v207 offset:0
    ds_read_b64 v[230:231], v207 offset:512
    v_mfma_f32_32x32x16_bf16 v[144:159], v[168:171], v[108:111], v[144:159]
    ds_read_b64_tr_b16 v[164:165], v217 offset:49152
    ds_read_b64_tr_b16 v[166:167], v217 offset:50176
    v_mfma_f32_32x32x16_bf16 v[236:251], v[172:175], v[108:111], v[236:251]
    ds_read_b64_tr_b16 v[168:169], v216 offset:57344
    ds_read_b64_tr_b16 v[170:171], v216 offset:58368
    s_waitcnt lgkmcnt(5)
    v_add_f32 v228, v228, v229
    s_waitcnt lgkmcnt(4)
    v_add_f32 v230, v230, v231
    s_nop 0
    v_mfma_f32_32x32x2_f32 v[144:159], v228, v208, v[144:159]
    s_nop 1
    v_mfma_f32_32x32x2_f32 v[236:251], v230, v208, v[236:251]
    s_nop 15
    s_nop 0
    v_max_f32 v144, 0, v144
    v_mul_f32 v152, v152, v210
    v_mul_f32 v153, v153, v210
    v_max_f32 v145, 0, v145
    v_max_f32 v146, 0, v146
    v_mul_f32 v154, v154, v210
    v_mul_f32 v155, v155, v210
    v_max_f32 v147, 0, v147
    v_max_f32 v148, 0, v148
    v_mul_f32 v156, v156, v210
    v_mul_f32 v157, v157, v210
    v_max_f32 v149, 0, v149
    v_max_f32 v150, 0, v150
    v_mul_f32 v158, v158, v210
    v_mul_f32 v159, v159, v210
    v_max_f32 v151, 0, v151
    v_mul_f32 v144, v144, v152
    v_mul_f32 v145, v145, v153
    v_mul_f32 v146, v146, v154
    v_mul_f32 v147, v147, v155
    v_mul_f32 v148, v148, v156
    v_mul_f32 v149, v149, v157
    v_mul_f32 v150, v150, v158
    v_mul_f32 v151, v151, v159
    v_cvt_pk_bf16_f32 v144, v144, v145
    v_cvt_pk_bf16_f32 v145, v146, v147
    v_cvt_pk_bf16_f32 v146, v148, v149
    v_cvt_pk_bf16_f32 v147, v150, v151
    s_add_u32 s94, s54, 4096
    buffer_store_dwordx4 v[144:147], v204, s[40:43], s94 offen sc1
    v_max_f32 v236, 0, v236
    v_mul_f32 v244, v244, v210
    v_mul_f32 v245, v245, v210
    v_max_f32 v237, 0, v237
    v_max_f32 v238, 0, v238
    v_mul_f32 v246, v246, v210
    v_mul_f32 v247, v247, v210
    v_max_f32 v239, 0, v239
    v_max_f32 v240, 0, v240
    v_mul_f32 v248, v248, v210
    v_mul_f32 v249, v249, v210
    v_max_f32 v241, 0, v241
    v_max_f32 v242, 0, v242
    v_mul_f32 v250, v250, v210
    v_mul_f32 v251, v251, v210
    v_max_f32 v243, 0, v243
    v_mul_f32 v236, v236, v244
    v_mul_f32 v237, v237, v245
    v_mul_f32 v238, v238, v246
    v_mul_f32 v239, v239, v247
    v_mul_f32 v240, v240, v248
    v_mul_f32 v241, v241, v249
    v_mul_f32 v242, v242, v250
    v_mul_f32 v243, v243, v251
    v_cvt_pk_bf16_f32 v236, v236, v237
    v_cvt_pk_bf16_f32 v237, v238, v239
    v_cvt_pk_bf16_f32 v238, v240, v241
    v_cvt_pk_bf16_f32 v239, v242, v243
    s_add_u32 s94, s54, 5120
    buffer_store_dwordx4 v[236:239], v204, s[40:43], s94 offen sc1
    s_waitcnt vmcnt(9)
    v_mfma_f32_32x32x16_bf16 v[112:127], v[160:163], v[0:3], 0
    ds_read_b64_tr_b16 v[172:173], v217 offset:57344
    ds_read_b64_tr_b16 v[174:175], v217 offset:58368
    s_waitcnt lgkmcnt(4)
    v_mfma_f32_32x32x16_bf16 v[128:143], v[164:167], v[0:3], 0
    v_add_u32 v216, 0x20000, v216
    ds_read_b64_tr_b16 v[160:161], v216 offset:0
    ds_read_b64_tr_b16 v[162:163], v216 offset:1024
    s_add_u32 s93, s71, 172032
    s_add_u32 m0, s52, 106496
    s_nop 0
    buffer_load_dwordx4 v203, s[28:31], s93 offen lds
    s_waitcnt vmcnt(9) lgkmcnt(4)
    v_mfma_f32_32x32x16_bf16 v[112:127], v[168:171], v[4:7], v[112:127]
    v_add_u32 v217, 0x20000, v217
    ds_read_b64_tr_b16 v[164:165], v217 offset:0
    ds_read_b64_tr_b16 v[166:167], v217 offset:1024
    s_add_u32 s95, s55, 8192
    v_mov_b32 v255, 1
    s_waitcnt vmcnt(1)
    buffer_store_dword v255, v205, s[40:43], s95 offen sc1
    s_add_u32 s94, s88, 0
    buffer_load_dwordx4 v[24:27], v204, s[40:43], s94 offen
    s_waitcnt lgkmcnt(4)
    v_mfma_f32_32x32x16_bf16 v[128:143], v[172:175], v[4:7], v[128:143]
    ds_read_b64_tr_b16 v[168:169], v216 offset:8192
    ds_read_b64_tr_b16 v[170:171], v216 offset:9216
    s_add_u32 s94, s88, 8192
    buffer_load_dwordx4 v[28:31], v204, s[40:43], s94 offen
    s_waitcnt lgkmcnt(4)
    v_mfma_f32_32x32x16_bf16 v[112:127], v[160:163], v[8:11], v[112:127]
    ds_read_b64_tr_b16 v[172:173], v217 offset:8192
    ds_read_b64_tr_b16 v[174:175], v217 offset:9216
    s_add_u32 s94, s89, 0
    buffer_load_dwordx4 v[32:35], v204, s[40:43], s94 offen
    s_waitcnt lgkmcnt(4)
    v_mfma_f32_32x32x16_bf16 v[128:143], v[164:167], v[8:11], v[128:143]
    s_barrier
    v_add_u32 v216, 0xfffe0000, v216
    ds_read_b64_tr_b16 v[160:161], v216 offset:0
    ds_read_b64_tr_b16 v[162:163], v216 offset:1024
    s_add_u32 s92, s72, 57344
    s_add_u32 m0, s52, 114688
    s_nop 0
    buffer_load_dwordx4 v203, s[28:31], s92 offen lds
    s_add_u32 s94, s89, 8192
    buffer_load_dwordx4 v[36:39], v204, s[40:43], s94 offen
    s_waitcnt lgkmcnt(4)
    v_mfma_f32_32x32x16_bf16 v[112:127], v[168:171], v[12:15], v[112:127]
    v_add_u32 v217, 0xfffe0000, v217
    ds_read_b64_tr_b16 v[164:165], v217 offset:0
    ds_read_b64_tr_b16 v[166:167], v217 offset:1024
    s_add_u32 s94, s90, 0
    buffer_load_dwordx4 v[40:43], v204, s[40:43], s94 offen
    s_waitcnt lgkmcnt(4)
    v_mfma_f32_32x32x16_bf16 v[128:143], v[172:175], v[12:15], v[128:143]
    ds_read_b64_tr_b16 v[168:169], v216 offset:8192
    ds_read_b64_tr_b16 v[170:171], v216 offset:9216
    s_add_u32 s94, s90, 8192
    buffer_load_dwordx4 v[44:47], v204, s[40:43], s94 offen
    s_waitcnt lgkmcnt(4)
    v_mfma_f32_32x32x16_bf16 v[112:127], v[160:163], v[16:19], v[112:127]
    ds_read_b64_tr_b16 v[172:173], v217 offset:8192
    ds_read_b64_tr_b16 v[174:175], v217 offset:9216
    s_add_u32 s94, s91, 0
    buffer_load_dwordx4 v[48:51], v204, s[40:43], s94 offen
    s_waitcnt lgkmcnt(4)
    v_mfma_f32_32x32x16_bf16 v[128:143], v[164:167], v[16:19], v[128:143]
    ds_read_b64_tr_b16 v[160:161], v216 offset:16384
    ds_read_b64_tr_b16 v[162:163], v216 offset:17408
    s_add_u32 s93, s72, 172032
    s_add_u32 m0, s52, 122880
    s_nop 0
    buffer_load_dwordx4 v203, s[28:31], s93 offen lds
    s_add_u32 s94, s91, 8192
    buffer_load_dwordx4 v[52:55], v204, s[40:43], s94 offen
    s_waitcnt lgkmcnt(4)
    v_mfma_f32_32x32x16_bf16 v[112:127], v[168:171], v[20:23], v[112:127]
    ds_read_b64_tr_b16 v[164:165], v217 offset:16384
    ds_read_b64_tr_b16 v[166:167], v217 offset:17408
    s_add_u32 s56, s56, 8192
    s_waitcnt lgkmcnt(4)
    v_mfma_f32_32x32x16_bf16 v[128:143], v[172:175], v[20:23], v[128:143]
    ds_read_b64_tr_b16 v[168:169], v216 offset:24576
    ds_read_b64_tr_b16 v[170:171], v216 offset:25600
    s_waitcnt vmcnt(9) lgkmcnt(4)
    v_mfma_f32_32x32x16_bf16 v[112:127], v[160:163], v[24:27], v[112:127]
    ds_read_b64_tr_b16 v[172:173], v217 offset:24576
    ds_read_b64_tr_b16 v[174:175], v217 offset:25600
    s_waitcnt lgkmcnt(4)
    v_mfma_f32_32x32x16_bf16 v[128:143], v[164:167], v[24:27], v[128:143]
    s_barrier
    ds_read_b64_tr_b16 v[160:161], v216 offset:32768
    ds_read_b64_tr_b16 v[162:163], v216 offset:33792
    s_add_u32 s92, s73, 57344
    s_add_u32 m0, s52, 49152
    s_nop 0
    buffer_load_dwordx4 v203, s[28:31], s92 offen lds
    s_waitcnt vmcnt(9) lgkmcnt(4)
    v_mfma_f32_32x32x16_bf16 v[112:127], v[168:171], v[28:31], v[112:127]
    ds_read_b64_tr_b16 v[164:165], v217 offset:32768
    ds_read_b64_tr_b16 v[166:167], v217 offset:33792
    s_waitcnt lgkmcnt(4)
    v_mfma_f32_32x32x16_bf16 v[128:143], v[172:175], v[28:31], v[128:143]
    ds_read_b64_tr_b16 v[168:169], v216 offset:40960
    ds_read_b64_tr_b16 v[170:171], v216 offset:41984
    s_add_u32 s93, s73, 172032
    s_add_u32 m0, s52, 57344
    s_nop 0
    buffer_load_dwordx4 v203, s[28:31], s93 offen lds
    buffer_load_dword v197, v196, s[40:43], s56 offen sc1
    s_waitcnt vmcnt(10) lgkmcnt(4)
    v_mfma_f32_32x32x16_bf16 v[112:127], v[160:163], v[32:35], v[112:127]
    ds_read_b64_tr_b16 v[172:173], v217 offset:40960
    ds_read_b64_tr_b16 v[174:175], v217 offset:41984
    s_waitcnt lgkmcnt(4)
    v_mfma_f32_32x32x16_bf16 v[128:143], v[164:167], v[32:35], v[128:143]
    v_add_u32 v216, 0x10000, v216
    ds_read_b64_tr_b16 v[160:161], v216 offset:0
    ds_read_b64_tr_b16 v[162:163], v216 offset:1024
    s_add_u32 s92, s74, 57344
    s_add_u32 m0, s52, 131072
    s_nop 0
    buffer_load_dwordx4 v203, s[28:31], s92 offen lds
    s_waitcnt vmcnt(9) lgkmcnt(4)
    v_mfma_f32_32x32x16_bf16 v[112:127], v[168:171], v[36:39], v[112:127]
    v_add_u32 v217, 0x10000, v217
    ds_read_b64_tr_b16 v[164:165], v217 offset:0
    ds_read_b64_tr_b16 v[166:167], v217 offset:1024
    s_waitcnt lgkmcnt(4)
    v_mfma_f32_32x32x16_bf16 v[128:143], v[172:175], v[36:39], v[128:143]
    ds_read_b64_tr_b16 v[168:169], v216 offset:8192
    ds_read_b64_tr_b16 v[170:171], v216 offset:9216
    s_add_u32 s93, s74, 172032
    s_add_u32 m0, s52, 139264
    s_nop 0
    buffer_load_dwordx4 v203, s[28:31], s93 offen lds
    buffer_load_dword v199, v196, s[40:43], s56 offen sc1
    s_waitcnt vmcnt(10) lgkmcnt(4)
    v_mfma_f32_32x32x16_bf16 v[112:127], v[160:163], v[40:43], v[112:127]
    ds_read_b64_tr_b16 v[172:173], v217 offset:8192
    ds_read_b64_tr_b16 v[174:175], v217 offset:9216
    s_mov_b32 s98, 20001
    s_waitcnt vmcnt(3)
    s_cmp_lg_u32 s44, 0
    s_cbranch_scc1 .ok5
    v_cmp_ne_u32 vcc, 0, v197
    s_and_b32 s99, vcc_lo, vcc_hi
    s_and_b32 s99, s99, 0x3fff3fff
    s_cmp_eq_u32 s99, 0x3fff3fff
    s_cbranch_scc1 .ok5
    s_mov_b32 s98, 20000
.sp6:
    buffer_load_dword v197, v196, s[40:43], s56 offen sc1
    s_waitcnt vmcnt(1)
    v_cmp_ne_u32 vcc, 0, v199
    s_and_b32 s99, vcc_lo, vcc_hi
    s_and_b32 s99, s99, 0x3fff3fff
    s_cmp_eq_u32 s99, 0x3fff3fff
    s_cbranch_scc1 .ok5
    buffer_load_dword v199, v196, s[40:43], s56 offen sc1
    s_waitcnt vmcnt(1)
    v_cmp_ne_u32 vcc, 0, v197
    s_and_b32 s99, vcc_lo, vcc_hi
    s_and_b32 s99, s99, 0x3fff3fff
    s_cmp_eq_u32 s99, 0x3fff3fff
    s_cbranch_scc1 .ok5
    s_sub_u32 s98, s98, 1
    s_cmp_lg_u32 s98, 0
    s_cbranch_scc1 .sp6
.ok5:
    s_nop 1
    s_waitcnt lgkmcnt(4)
    v_mfma_f32_32x32x16_bf16 v[128:143], v[164:167], v[40:43], v[128:143]
    s_barrier
    ds_read_b64_tr_b16 v[160:161], v216 offset:16384
    ds_read_b64_tr_b16 v[162:163], v216 offset:17408
    s_add_u32 s92, s75, 57344
    s_add_u32 m0, s52, 0
    s_nop 0
    buffer_load_dwordx4 v203, s[28:31], s92 offen lds
    s_add_u32 s94, s85, 4096
    buffer_load_dwordx4 v[56:59], v204, s[40:43], s94 offen
    s_add_u32 s94, s85, 12288
    buffer_load_dwordx4 v[60:63], v204, s[40:43], s94 offen
    s_add_u32 s94, s86, 4096
    buffer_load_dwordx4 v[64:67], v204, s[40:43], s94 offen
    s_add_u32 s94, s86, 12288
    buffer_load_dwordx4 v[68:71], v204, s[40:43], s94 offen
    s_add_u32 s94, s87, 4096
    buffer_load_dwordx4 v[72:75], v204, s[40:43], s94 offen
    s_add_u32 s94, s87, 12288
    buffer_load_dwordx4 v[76:79], v204, s[40:43], s94 offen
    s_add_u32 s94, s88, 4096
    buffer_load_dwordx4 v[80:83], v204, s[40:43], s94 offen
    s_add_u32 s94, s88, 12288
    buffer_load_dwordx4 v[84:87], v204, s[40:43], s94 offen
    s_add_u32 s94, s89, 4096
    buffer_load_dwordx4 v[88:91], v204, s[40:43], s94 offen
    s_add_u32 s94, s89, 12288
    buffer_load_dwordx4 v[92:95], v204, s[40:43], s94 offen
    s_add_u32 s94, s90, 4096
    buffer_load_dwordx4 v[96:99], v204, s[40:43], s94 offen
    s_add_u32 s94, s90, 12288
    buffer_load_dwordx4 v[100:103], v204, s[40:43], s94 offen
    s_add_u32 s94, s91, 4096
    buffer_load_dwordx4 v[104:107], v204, s[40:43], s94 offen
    s_add_u32 s94, s91, 12288
    s_waitcnt lgkmcnt(4)
    v_mfma_f32_32x32x16_bf16 v[112:127], v[168:171], v[44:47], v[112:127]
    ds_read_b64_tr_b16 v[164:165], v217 offset:16384
    ds_read_b64_tr_b16 v[166:167], v217 offset:17408
    buffer_load_dwordx4 v[108:111], v204, s[40:43], s94 offen
    s_waitcnt lgkmcnt(4)
    v_mfma_f32_32x32x16_bf16 v[128:143], v[172:175], v[44:47], v[128:143]
    ds_read_b64_tr_b16 v[168:169], v216 offset:24576
    ds_read_b64_tr_b16 v[170:171], v216 offset:25600
    s_add_u32 s93, s75, 172032
    s_add_u32 m0, s52, 8192
    s_nop 0
    buffer_load_dwordx4 v203, s[28:31], s93 offen lds
    s_waitcnt lgkmcnt(4)
    v_mfma_f32_32x32x16_bf16 v[112:127], v[160:163], v[48:51], v[112:127]
    ds_read_b64_tr_b16 v[172:173], v217 offset:24576
    ds_read_b64_tr_b16 v[174:175], v217 offset:25600
    s_waitcnt lgkmcnt(4)
    v_mfma_f32_32x32x16_bf16 v[128:143], v[164:167], v[48:51], v[128:143]
    ds_read_b64_tr_b16 v[160:161], v216 offset:32768
    ds_read_b64_tr_b16 v[162:163], v216 offset:33792
    s_add_u32 s92, s76, 57344
    s_add_u32 m0, s52, 16384
    s_nop 0
    buffer_load_dwordx4 v203, s[28:31], s92 offen lds
    s_waitcnt lgkmcnt(4)
    v_mfma_f32_32x32x16_bf16 v[112:127], v[168:171], v[52:55], v[112:127]
    ds_read_b64_tr_b16 v[164:165], v217 offset:32768
    ds_read_b64_tr_b16 v[166:167], v217 offset:33792
    s_waitcnt lgkmcnt(4)
    v_mfma_f32_32x32x16_bf16 v[128:143], v[172:175], v[52:55], v[128:143]
    ds_read_b64_tr_b16 v[168:169], v216 offset:40960
    ds_read_b64_tr_b16 v[170:171], v216 offset:41984
    s_add_u32 s93, s76, 172032
    s_add_u32 m0, s52, 24576
    s_nop 0
    buffer_load_dwordx4 v203, s[28:31], s93 offen lds
    s_waitcnt vmcnt(16) lgkmcnt(4)
    v_mfma_f32_32x32x16_bf16 v[112:127], v[160:163], v[56:59], v[112:127]
    ds_read_b64_tr_b16 v[172:173], v217 offset:40960
    ds_read_b64_tr_b16 v[174:175], v217 offset:41984
    s_waitcnt lgkmcnt(4)
    v_mfma_f32_32x32x16_bf16 v[128:143], v[164:167], v[56:59], v[128:143]
    s_barrier
    ds_read_b64_tr_b16 v[160:161], v216 offset:49152
    ds_read_b64_tr_b16 v[162:163], v216 offset:50176
    s_add_u32 s92, s77, 57344
    s_add_u32 m0, s52, 32768
    s_nop 0
    buffer_load_dwordx4 v203, s[28:31], s92 offen lds
    s_waitcnt vmcnt(16) lgkmcnt(4)
    v_mfma_f32_32x32x16_bf16 v[112:127], v[168:171], v[60:63], v[112:127]
    ds_read_b64_tr_b16 v[164:165], v217 offset:49152
    ds_read_b64_tr_b16 v[166:167], v217 offset:50176
    s_waitcnt lgkmcnt(4)
    v_mfma_f32_32x32x16_bf16 v[128:143], v[172:175], v[60:63], v[128:143]
    ds_read_b64_tr_b16 v[168:169], v216 offset:57344
    ds_read_b64_tr_b16 v[170:171], v216 offset:58368
    s_add_u32 s93, s77, 172032
    s_add_u32 m0, s52, 40960
    s_nop 0
    buffer_load_dwordx4 v203, s[28:31], s93 offen lds
    s_waitcnt vmcnt(16) lgkmcnt(4)
    v_mfma_f32_32x32x16_bf16 v[112:127], v[160:163], v[64:67], v[112:127]
    ds_read_b64_tr_b16 v[172:173], v217 offset:57344
    ds_read_b64_tr_b16 v[174:175], v217 offset:58368
    s_waitcnt lgkmcnt(4)
    v_mfma_f32_32x32x16_bf16 v[128:143], v[164:167], v[64:67], v[128:143]
    v_add_u32 v216, 0xffff0000, v216
    ds_read_b64_tr_b16 v[160:161], v216 offset:49152
    ds_read_b64_tr_b16 v[162:163], v216 offset:50176
    s_add_u32 s92, s58, 0
    s_add_u32 m0, s52, 65536
    s_nop 0
    buffer_load_dwordx4 v203, s[16:19], s92 offen lds
    buffer_load_dword v197, v198, s[40:43], s59 offen sc1
    s_waitcnt vmcnt(17) lgkmcnt(4)
    v_mfma_f32_32x32x16_bf16 v[112:127], v[168:171], v[68:71], v[112:127]
    v_add_u32 v217, 0xffff0000, v217
    ds_read_b64_tr_b16 v[164:165], v217 offset:49152
    ds_read_b64_tr_b16 v[166:167], v217 offset:50176
    s_waitcnt lgkmcnt(4)
    v_mfma_f32_32x32x16_bf16 v[128:143], v[172:175], v[68:71], v[128:143]
    ds_read_b64_tr_b16 v[168:169], v216 offset:57344
    ds_read_b64_tr_b16 v[170:171], v216 offset:58368
    s_add_u32 s93, s63, 0
    s_add_u32 m0, s52, 73728
    s_nop 0
    buffer_load_dwordx4 v203, s[16:19], s93 offen lds
    s_waitcnt vmcnt(17) lgkmcnt(4)
    v_mfma_f32_32x32x16_bf16 v[112:127], v[160:163], v[72:75], v[112:127]
    ds_read_b64_tr_b16 v[172:173], v217 offset:57344
    ds_read_b64_tr_b16 v[174:175], v217 offset:58368
    s_waitcnt lgkmcnt(4)
    v_mfma_f32_32x32x16_bf16 v[128:143], v[164:167], v[72:75], v[128:143]
    s_waitcnt vmcnt(7)
    s_barrier
    v_add_u32 v216, 0x20000, v216
    ds_read_b64_tr_b16 v[160:161], v216 offset:0
    ds_read_b64_tr_b16 v[162:163], v216 offset:1024
    s_add_u32 s92, s58, 50176
    s_add_u32 m0, s52, 81920
    s_nop 0
    buffer_load_dwordx4 v203, s[16:19], s92 offen lds
    s_waitcnt lgkmcnt(4)
    v_mfma_f32_32x32x16_bf16 v[112:127], v[168:171], v[76:79], v[112:127]
    v_add_u32 v217, 0x20000, v217
    ds_read_b64_tr_b16 v[164:165], v217 offset:0
    ds_read_b64_tr_b16 v[166:167], v217 offset:1024
    s_waitcnt lgkmcnt(4)
    v_mfma_f32_32x32x16_bf16 v[128:143], v[172:175], v[76:79], v[128:143]
    ds_read_b64_tr_b16 v[168:169], v216 offset:8192
    ds_read_b64_tr_b16 v[170:171], v216 offset:9216
    s_add_u32 s93, s63, 50176
    s_add_u32 m0, s52, 90112
    s_nop 0
    buffer_load_dwordx4 v203, s[16:19], s93 offen lds
    buffer_load_dword v199, v198, s[40:43], s59 offen sc1
    s_waitcnt lgkmcnt(4)
    v_mfma_f32_32x32x16_bf16 v[112:127], v[160:163], v[80:83], v[112:127]
    ds_read_b64_tr_b16 v[172:173], v217 offset:8192
    ds_read_b64_tr_b16 v[174:175], v217 offset:9216
    s_waitcnt lgkmcnt(4)
    v_mfma_f32_32x32x16_bf16 v[128:143], v[164:167], v[80:83], v[128:143]
    v_add_u32 v216, 0xfffe0000, v216
    ds_read_b64_tr_b16 v[160:161], v216 offset:0
    ds_read_b64_tr_b16 v[162:163], v216 offset:1024
    s_add_u32 s92, s58, 100352
    s_add_u32 m0, s52, 98304
    s_nop 0
    buffer_load_dwordx4 v203, s[16:19], s92 offen lds
    s_waitcnt lgkmcnt(4)
    v_mfma_f32_32x32x16_bf16 v[112:127], v[168:171], v[84:87], v[112:127]
    v_add_u32 v217, 0xfffe0000, v217
    ds_read_b64_tr_b16 v[164:165], v217 offset:0
    ds_read_b64_tr_b16 v[166:167], v217 offset:1024
    s_waitcnt lgkmcnt(4)
    v_mfma_f32_32x32x16_bf16 v[128:143], v[172:175], v[84:87], v[128:143]
    ds_read_b64_tr_b16 v[168:169], v216 offset:8192
    ds_read_b64_tr_b16 v[170:171], v216 offset:9216
    s_add_u32 s93, s63, 100352
    s_add_u32 m0, s52, 106496
    s_nop 0
    buffer_load_dwordx4 v203, s[16:19], s93 offen lds
    s_waitcnt lgkmcnt(4)
    v_mfma_f32_32x32x16_bf16 v[112:127], v[160:163], v[88:91], v[112:127]
    ds_read_b64_tr_b16 v[172:173], v217 offset:8192
    ds_read_b64_tr_b16 v[174:175], v217 offset:9216
    s_mov_b32 s98, 20001
    s_waitcnt vmcnt(6)
    s_cmp_lg_u32 s44, 0
    s_cbranch_scc1 .ok7
    v_cmp_ne_u32 vcc, 0, v197
    s_and_b32 s99, vcc_lo, vcc_hi
    s_and_b32 s99, s99, 0x3f3f3f3f
    s_cmp_eq_u32 s99, 0x3f3f3f3f
    s_cbranch_scc1 .ok7
    s_mov_b32 s98, 20000
.sp8:
    buffer_load_dword v197, v198, s[40:43], s59 offen sc1
    s_waitcnt vmcnt(1)
    v_cmp_ne_u32 vcc, 0, v199
    s_and_b32 s99, vcc_lo, vcc_hi
    s_and_b32 s99, s99, 0x3f3f3f3f
    s_cmp_eq_u32 s99, 0x3f3f3f3f
    s_cbranch_scc1 .ok7
    buffer_load_dword v199, v198, s[40:43], s59 offen sc1
    s_waitcnt vmcnt(1)
    v_cmp_ne_u32 vcc, 0, v197
    s_and_b32 s99, vcc_lo, vcc_hi
    s_and_b32 s99, s99, 0x3f3f3f3f
    s_cmp_eq_u32 s99, 0x3f3f3f3f
    s_cbranch_scc1 .ok7
    s_sub_u32 s98, s98, 1
    s_cmp_lg_u32 s98, 0
    s_cbranch_scc1 .sp8
.ok7:
    s_nop 1
    s_waitcnt lgkmcnt(4)
    v_mfma_f32_32x32x16_bf16 v[128:143], v[164:167], v[88:91], v[128:143]
    s_barrier
    ds_read_b64_tr_b16 v[160:161], v216 offset:16384
    ds_read_b64_tr_b16 v[162:163], v216 offset:17408
    s_add_u32 s92, s58, 150528
    s_add_u32 m0, s52, 114688
    s_nop 0
    buffer_load_dwordx4 v203, s[16:19], s92 offen lds
    s_add_u32 s94, s57, 0
    buffer_load_dwordx4 v[0:3], v204, s[40:43], s94 offen
    s_add_u32 s94, s57, 1024
    buffer_load_dwordx4 v[4:7], v204, s[40:43], s94 offen
    s_add_u32 s94, s57, 4096
    buffer_load_dwordx4 v[8:11], v204, s[40:43], s94 offen
    s_add_u32 s94, s57, 5120
    buffer_load_dwordx4 v[12:15], v204, s[40:43], s94 offen
    s_add_u32 s94, s57, 8192
    buffer_load_dwordx4 v[16:19], v204, s[40:43], s94 offen
    s_add_u32 s94, s57, 9216
    buffer_load_dwordx4 v[20:23], v204, s[40:43], s94 offen
    s_waitcnt lgkmcnt(4)
    v_mfma_f32_32x32x16_bf16 v[112:127], v[168:171], v[92:95], v[112:127]
    ds_read_b64_tr_b16 v[164:165], v217 offset:16384
    ds_read_b64_tr_b16 v[166:167], v217 offset:17408
    s_waitcnt lgkmcnt(4)
    v_mfma_f32_32x32x16_bf16 v[128:143], v[172:175], v[92:95], v[128:143]
    ds_read_b64_tr_b16 v[168:169], v216 offset:24576
    ds_read_b64_tr_b16 v[170:171], v216 offset:25600
    s_waitcnt lgkmcnt(4)
    v_mfma_f32_32x32x16_bf16 v[112:127], v[160:163], v[96:99], v[112:127]
    ds_read_b64_tr_b16 v[172:173], v217 offset:24576
    ds_read_b64_tr_b16 v[174:175], v217 offset:25600
    s_waitcnt lgkmcnt(4)
    v_mfma_f32_32x32x16_bf16 v[128:143], v[164:167], v[96:99], v[128:143]
    ds_read_b64_tr_b16 v[160:161], v216 offset:32768
    ds_read_b64_tr_b16 v[162:163], v216 offset:33792
    s_add_u32 s93, s63, 150528
    s_add_u32 m0, s52, 122880
    s_nop 0
    buffer_load_dwordx4 v203, s[16:19], s93 offen lds
    buffer_load_dword v197, v198, s[40:43], s59 offen sc1
    s_waitcnt lgkmcnt(4)
    v_mfma_f32_32x32x16_bf16 v[112:127], v[168:171], v[100:103], v[112:127]
    ds_read_b64_tr_b16 v[164:165], v217 offset:32768
    ds_read_b64_tr_b16 v[166:167], v217 offset:33792
    s_waitcnt lgkmcnt(4)
    v_mfma_f32_32x32x16_bf16 v[128:143], v[172:175], v[100:103], v[128:143]
    ds_read_b64_tr_b16 v[168:169], v216 offset:40960
    ds_read_b64_tr_b16 v[170:171], v216 offset:41984
    s_waitcnt lgkmcnt(4)
    v_mfma_f32_32x32x16_bf16 v[112:127], v[160:163], v[104:107], v[112:127]
    ds_read_b64_tr_b16 v[172:173], v217 offset:40960
    ds_read_b64_tr_b16 v[174:175], v217 offset:41984
    s_waitcnt lgkmcnt(4)
    v_mfma_f32_32x32x16_bf16 v[128:143], v[164:167], v[104:107], v[128:143]
    s_waitcnt vmcnt(12)
    s_barrier
    v_add_u32 v216, 0x10000, v216
    ds_read_b64_tr_b16 v[160:161], v216 offset:0
    ds_read_b64_tr_b16 v[162:163], v216 offset:1024
    s_waitcnt lgkmcnt(4)
    v_mfma_f32_32x32x16_bf16 v[112:127], v[168:171], v[108:111], v[112:127]
    v_add_u32 v217, 0x10000, v217
    ds_read_b64_tr_b16 v[164:165], v217 offset:0
    ds_read_b64_tr_b16 v[166:167], v217 offset:1024
    s_waitcnt lgkmcnt(4)
    v_mfma_f32_32x32x16_bf16 v[128:143], v[172:175], v[108:111], v[128:143]
    ds_read_b64_tr_b16 v[168:169], v216 offset:8192
    ds_read_b64_tr_b16 v[170:171], v216 offset:9216
    s_waitcnt vmcnt(11)
    buffer_load_dword v199, v198, s[40:43], s59 offen sc1
    s_waitcnt vmcnt(8) lgkmcnt(4)
    v_mfma_f32_32x32x16_bf16 v[112:127], v[160:163], v[0:3], v[112:127]
    ds_read_b64_tr_b16 v[172:173], v217 offset:8192
    ds_read_b64_tr_b16 v[174:175], v217 offset:9216
    s_waitcnt lgkmcnt(4)
    v_mfma_f32_32x32x16_bf16 v[128:143], v[164:167], v[0:3], v[128:143]
    ds_read_b64_tr_b16 v[160:161], v216 offset:16384
    ds_read_b64_tr_b16 v[162:163], v216 offset:17408
    s_waitcnt vmcnt(7) lgkmcnt(4)
    v_mfma_f32_32x32x16_bf16 v[112:127], v[168:171], v[4:7], v[112:127]
    ds_read_b64_tr_b16 v[164:165], v217 offset:16384
    ds_read_b64_tr_b16 v[166:167], v217 offset:17408
    s_waitcnt lgkmcnt(4)
    v_mfma_f32_32x32x16_bf16 v[128:143], v[172:175], v[4:7], v[128:143]
    ds_read_b64_tr_b16 v[168:169], v216 offset:24576
    ds_read_b64_tr_b16 v[170:171], v216 offset:25600
    s_waitcnt vmcnt(6) lgkmcnt(4)
    v_mfma_f32_32x32x16_bf16 v[112:127], v[160:163], v[8:11], v[112:127]
    ds_read_b64_tr_b16 v[172:173], v217 offset:24576
    ds_read_b64_tr_b16 v[174:175], v217 offset:25600
    s_mov_b32 s98, 20001
    s_waitcnt vmcnt(1)
    s_cmp_lg_u32 s44, 0
    s_cbranch_scc1 .ok9
    v_cmp_ne_u32 vcc, 0, v197
    s_and_b32 s99, vcc_lo, vcc_hi
    s_and_b32 s99, s99, 0xc0c0c0c0
    s_cmp_eq_u32 s99, 0xc0c0c0c0
    s_cbranch_scc1 .ok9
    s_mov_b32 s98, 20000
.sp10:
    buffer_load_dword v197, v198, s[40:43], s59 offen sc1
    s_waitcnt vmcnt(1)
    v_cmp_ne_u32 vcc, 0, v199
    s_and_b32 s99, vcc_lo, vcc_hi
    s_and_b32 s99, s99, 0xc0c0c0c0
    s_cmp_eq_u32 s99, 0xc0c0c0c0
    s_cbranch_scc1 .ok9
    buffer_load_dword v199, v198, s[40:43], s59 offen sc1
    s_waitcnt vmcnt(1)
    v_cmp_ne_u32 vcc, 0, v197
    s_and_b32 s99, vcc_lo, vcc_hi
    s_and_b32 s99, s99, 0xc0c0c0c0
    s_cmp_eq_u32 s99, 0xc0c0c0c0
    s_cbranch_scc1 .ok9
    s_sub_u32 s98, s98, 1
    s_cmp_lg_u32 s98, 0
    s_cbranch_scc1 .sp10
.ok9:
    s_nop 1
    s_waitcnt lgkmcnt(4)
    v_mfma_f32_32x32x16_bf16 v[128:143], v[164:167], v[8:11], v[128:143]
    s_barrier
    ds_read_b64_tr_b16 v[160:161], v216 offset:32768
    ds_read_b64_tr_b16 v[162:163], v216 offset:33792
    s_add_u32 s94, s57, 12288
    buffer_load_dwordx4 v[24:27], v204, s[40:43], s94 offen
    s_add_u32 s94, s57, 13312
    buffer_load_dwordx4 v[28:31], v204, s[40:43], s94 offen
    s_waitcnt lgkmcnt(4)
    v_mfma_f32_32x32x16_bf16 v[112:127], v[168:171], v[12:15], v[112:127]
    ds_read_b64_tr_b16 v[164:165], v217 offset:32768
    ds_read_b64_tr_b16 v[166:167], v217 offset:33792
    s_waitcnt lgkmcnt(4)
    v_mfma_f32_32x32x16_bf16 v[128:143], v[172:175], v[12:15], v[128:143]
    ds_read_b64_tr_b16 v[168:169], v216 offset:40960
    ds_read_b64_tr_b16 v[170:171], v216 offset:41984
    s_waitcnt lgkmcnt(4)
    v_mfma_f32_32x32x16_bf16 v[112:127], v[160:163], v[16:19], v[112:127]
    ds_read_b64_tr_b16 v[172:173], v217 offset:40960
    ds_read_b64_tr_b16 v[174:175], v217 offset:41984
    s_waitcnt lgkmcnt(4)
    v_mfma_f32_32x32x16_bf16 v[128:143], v[164:167], v[16:19], v[128:143]
    ds_read_b64_tr_b16 v[160:161], v216 offset:49152
    ds_read_b64_tr_b16 v[162:163], v216 offset:50176
    s_waitcnt lgkmcnt(4)
    v_mfma_f32_32x32x16_bf16 v[112:127], v[168:171], v[20:23], v[112:127]
    ds_read_b64_tr_b16 v[164:165], v217 offset:49152
    ds_read_b64_tr_b16 v[166:167], v217 offset:50176
    s_waitcnt lgkmcnt(4)
    v_mfma_f32_32x32x16_bf16 v[128:143], v[172:175], v[20:23], v[128:143]
    ds_read_b64_tr_b16 v[168:169], v216 offset:57344
    ds_read_b64_tr_b16 v[170:171], v216 offset:58368
    s_waitcnt vmcnt(1) lgkmcnt(4)
    v_mfma_f32_32x32x16_bf16 v[112:127], v[160:163], v[24:27], v[112:127]
    ds_read_b64_tr_b16 v[172:173], v217 offset:57344
    ds_read_b64_tr_b16 v[174:175], v217 offset:58368
    s_waitcnt lgkmcnt(4)
    v_mfma_f32_32x32x16_bf16 v[128:143], v[164:167], v[24:27], v[128:143]
    s_waitcnt vmcnt(0) lgkmcnt(2)
    v_mfma_f32_32x32x16_bf16 v[112:127], v[168:171], v[28:31], v[112:127]
    s_waitcnt lgkmcnt(0)
    v_mfma_f32_32x32x16_bf16 v[128:143], v[172:175], v[28:31], v[128:143]
    v_bfe_u32 v228, v204, 4, 3
    v_lshrrev_b32 v229, 9, v204
    v_xor_b32 v228, v228, v229
    v_lshlrev_b32 v228, 4, v228
    v_and_b32 v229, 0x1f0, v204
    v_lshl_add_u32 v228, v229, 4, v228
    s_lshl_b32 s94, s45, 2
    s_lshr_b32 s94, 0x1083, s94
    s_and_b32 s94, s94, 15
    s_lshl_b32 s94, s94, 14
    s_add_u32 s94, s94, 0
    v_add_u32 v228, s94, v228
    v_xor_b32 v230, 32, v228
    v_xor_b32 v231, 64, v228
    v_xor_b32 v232, 96, v228
    v_and_b32 v233, 7, v220
    v_lshlrev_b32 v233, 4, v233
    v_lshlrev_b32 v229, 1, v221
    v_xor_b32 v233, v233, v229
    v_lshl_add_u32 v233, v220, 8, v233
    v_xor_b32 v234, 16, v233
    ds_write_b128 v228, v[112:115] offset:0
    ds_write_b128 v230, v[116:119] offset:0
    ds_write_b128 v231, v[120:123] offset:0
    ds_write_b128 v232, v[124:127] offset:0
    ds_write_b128 v228, v[128:131] offset:128
    ds_write_b128 v230, v[132:135] offset:128
    ds_write_b128 v231, v[136:139] offset:128
    ds_write_b128 v232, v[140:143] offset:128
    s_waitcnt lgkmcnt(0)
    s_barrier
    ds_read_b128 v[0:3], v233 offset:49152
    ds_read_b128 v[4:7], v234 offset:49152
    v_add_u32 v233, 0x20000, v233
    ds_read_b128 v[8:11], v233 offset:0
    v_add_u32 v234, 0x20000, v234
    ds_read_b128 v[12:15], v234 offset:0
    v_add_u32 v233, 0xfffe0000, v233
    ds_read_b128 v[16:19], v233 offset:0
    v_add_u32 v234, 0xfffe0000, v234
    ds_read_b128 v[20:23], v234 offset:0
    ds_read_b128 v[24:27], v233 offset:16384
    ds_read_b128 v[28:31], v234 offset:16384
    v_lshlrev_b32 v32, 16, v224
    v_and_b32 v33, 0xffff0000, v224
    v_lshlrev_b32 v34, 16, v225
    v_and_b32 v35, 0xffff0000, v225
    v_lshlrev_b32 v36, 16, v226
    v_and_b32 v37, 0xffff0000, v226
    v_lshlrev_b32 v38, 16, v227
    v_and_b32 v39, 0xffff0000, v227
    s_waitcnt lgkmcnt(7)
    v_add_f32 v32, v32, v0
    v_add_f32 v33, v33, v1
    v_add_f32 v34, v34, v2
    v_add_f32 v35, v35, v3
    s_waitcnt lgkmcnt(6)
    v_add_f32 v36, v36, v4
    v_add_f32 v37, v37, v5
    v_add_f32 v38, v38, v6
    v_add_f32 v39, v39, v7
    s_waitcnt lgkmcnt(5)
    v_add_f32 v32, v32, v8
    v_add_f32 v33, v33, v9
    v_add_f32 v34, v34, v10
    v_add_f32 v35, v35, v11
    s_waitcnt lgkmcnt(4)
    v_add_f32 v36, v36, v12
    v_add_f32 v37, v37, v13
    v_add_f32 v38, v38, v14
    v_add_f32 v39, v39, v15
    s_waitcnt lgkmcnt(3)
    v_add_f32 v32, v32, v16
    v_add_f32 v33, v33, v17
    v_add_f32 v34, v34, v18
    v_add_f32 v35, v35, v19
    s_waitcnt lgkmcnt(2)
    v_add_f32 v36, v36, v20
    v_add_f32 v37, v37, v21
    v_add_f32 v38, v38, v22
    v_add_f32 v39, v39, v23
    s_waitcnt lgkmcnt(1)
    v_add_f32 v32, v32, v24
    v_add_f32 v33, v33, v25
    v_add_f32 v34, v34, v26
    v_add_f32 v35, v35, v27
    s_waitcnt lgkmcnt(0)
    v_add_f32 v36, v36, v28
    v_add_f32 v37, v37, v29
    v_add_f32 v38, v38, v30
    v_add_f32 v39, v39, v31
    v_cvt_pk_bf16_f32 v40, v32, v33
    v_cvt_pk_bf16_f32 v41, v34, v35
    v_cvt_pk_bf16_f32 v42, v36, v37
    v_cvt_pk_bf16_f32 v43, v38, v39
    buffer_store_dwordx4 v[40:43], v222, s[32:35], s96 offen
    s_endpgm
.LM1:
    s_nop 4
    v_lshlrev_b32 v224, 4, v255
    v_lshlrev_b32 v225, 5, v222
    v_xor_b32 v224, v224, v225
    v_mul_u32_u24 v200, 3584, v223
    s_lshl_b32 s97, s51, 8
    v_add3_u32 v200, v200, v224, s97
    v_xor_b32 v201, 64, v200
    v_lshlrev_b32 v224, 4, v255
    v_lshlrev_b32 v225, 6, v222
    v_xor_b32 v224, v224, v225
    v_mul_u32_u24 v203, 896, v223
    s_lshl_b32 s97, s49, 7
    v_add3_u32 v203, v203, v224, s97
    v_bfe_u32 v230, v253, 4, 1
    v_lshrrev_b32 v231, 5, v253
    v_bfe_u32 v232, v253, 2, 2
    v_and_b32 v233, 3, v253
    s_add_u32 s92, s45, 0
    s_and_b32 s92, s92, 3
    s_add_u32 s93, s45, 1
    s_and_b32 s93, s93, 3
    s_add_u32 s94, s45, 2
    s_and_b32 s94, s94, 3
    s_add_u32 s95, s45, 3
    s_and_b32 s95, s95, 3
    v_bfe_u32 v224, v253, 1, 3
    v_xor_b32 v224, v224, v231
    v_lshlrev_b32 v224, 4, v224
    v_and_b32 v225, 31, v253
    v_lshl_add_u32 v234, v225, 7, v224
    s_lshl_b32 s96, s45, 12
    v_add_u32 v234, s96, v234
    v_lshlrev_b32 v206, 4, v225
    v_add_u32 v206, 0x25400, v206
    v_lshl_add_u32 v207, v231, 3, v206
    v_lshl_add_u32 v206, s45, 2, v206
    v_mov_b32 v224, 0x40000000
    v_cmp_eq_u32 vcc, 0, v253
    s_nop 1
    v_cndmask_b32 v205, v224, 0, vcc
    s_lshl_b32 s96, s92, 5
    v_xor_b32 v222, s96, v234
    s_lshl_b32 s96, s93, 5
    v_xor_b32 v223, s96, v234
    s_lshl_b32 s96, s94, 5
    v_xor_b32 v224, s96, v234
    s_lshl_b32 s96, s95, 5
    v_xor_b32 v225, s96, v234
    v_and_b32 v226, 7, v253
    v_lshlrev_b32 v227, 2, v230
    v_cmp_eq_u32 vcc, v226, v227
    v_mov_b32 v234, 0x3f803f80
    s_nop 0
    v_cndmask_b32 v176, 0, v234, vcc
    v_cndmask_b32 v177, 0, v234, vcc
    v_cndmask_b32 v178, 0, v234, vcc
    v_cndmask_b32 v179, 0, v234, vcc
    v_lshl_add_u32 v226, v231, 3, v232
    v_lshlrev_b32 v226, 7, v226
    v_lshl_add_u32 v226, v233, 3, v226
    v_lshrrev_b32 v227, 1, v232
    v_lshlrev_b32 v228, 1, v227
    v_xor_b32 v228, v228, v230
    v_xor_b32 v229, 2, v228
    v_lshl_add_u32 v229, v229, 5, v226
    s_lshl_b32 s92, s92, 11
    v_add_u32 v196, s92, v229
    s_lshl_b32 s93, s93, 11
    v_add_u32 v197, s93, v229
    s_lshl_b32 s94, s94, 11
    v_add_u32 v198, s94, v229
    s_lshl_b32 s95, s95, 11
    v_add_u32 v199, s95, v229
    v_lshl_add_u32 v229, v231, 2, v232
    v_lshlrev_b32 v229, 7, v229
    v_lshl_add_u32 v229, v233, 3, v229
    v_lshl_add_u32 v229, v228, 5, v229
    v_add_u32 v216, s92, v229
    v_xor_b32 v217, 64, v216
    v_lshl_or_b32 v228, v230, 1, v227
    v_xor_b32 v228, 2, v228
    v_lshl_add_u32 v228, v228, 5, v226
    v_lshl_add_u32 v228, v230, 13, v228
    v_add_u32 v188, s92, v228
    v_xor_b32 v189, 32, v188
    v_add_u32 v190, s93, v228
    v_xor_b32 v191, 32, v190
    v_add_u32 v192, s94, v228
    v_xor_b32 v193, 32, v192
    v_add_u32 v194, s95, v228
    v_xor_b32 v195, 32, v194
    s_lshl_b32 s96, s51, 3
    s_add_u32 s54, s54, s96
    s_add_u32 s54, s54, 2
    s_lshl_b32 s54, s54, 10
    s_lshl_b32 s96, s51, 2
    s_add_u32 s55, s55, s96
    s_add_u32 s55, s55, 0xa20040
    s_lshl_b32 s96, s62, 1
    s_add_u32 s96, s96, 1
    s_mul_i32 s57, s96, 147456
    s_lshl_b32 s59, s62, 7
    s_add_u32 s59, s59, 0xa24000
    s_lshl_b32 s56, s62, 8
    s_add_u32 s56, s56, 0xa20000
    s_lshl_b32 s97, s45, 10
    s_add_u32 s97, s97, s57
    s_lshl_b32 s85, s64, 7
    s_add_u32 s85, s85, s97
    s_lshl_b32 s86, s65, 7
    s_add_u32 s86, s86, s97
    s_lshl_b32 s87, s66, 7
    s_add_u32 s87, s87, s97
    s_lshl_b32 s88, s67, 7
    s_add_u32 s88, s88, s97
    s_lshl_b32 s89, s68, 7
    s_add_u32 s89, s89, s97
    s_lshl_b32 s90, s69, 7
    s_add_u32 s90, s90, s97
    s_lshl_b32 s91, s70, 7
    s_add_u32 s91, s91, s97
    s_bfe_u32 s96, s44, 0x10001
    s_add_u32 s96, s96, 8
    s_mul_i32 s96, s96, 28
    s_and_b32 s97, s44, 6
    s_lshl_b32 s97, s97, 3
    s_sub_u32 s96, s96, s97
    s_mul_i32 s58, s96, 896
    s_and_b32 s97, s44, 1
    s_mul_i32 s97, s97, 3584
    s_sub_u32 s63, s58, s97
    s_add_u32 s63, s63, 14336
    s_add_u32 m0, s53, 49152
    s_nop 0
    buffer_load_dwordx4 v220, s[4:7], s66 offen lds
    s_add_u32 m0, s53, 50176
    s_nop 0
    buffer_load_dwordx4 v221, s[4:7], s66 offen lds
    s_add_u32 m0, s53, 65536
    s_nop 0
    buffer_load_dwordx4 v220, s[4:7], s67 offen lds
    s_add_u32 m0, s53, 66560
    s_nop 0
    buffer_load_dwordx4 v221, s[4:7], s67 offen lds
    s_add_u32 m0, s52, 81920
    s_nop 0
    buffer_load_dwordx4 v202, s[8:11], s80 offen lds
    s_add_u32 m0, s52, 90112
    s_nop 0
    buffer_load_dwordx4 v202, s[8:11], s81 offen lds
    s_waitcnt vmcnt(6)
    s_barrier
    ds_read_b128 v[0:3], v222 offset:0
    ds_read_b64_tr_b16 v[160:161], v196 offset:32768
    ds_read_b64_tr_b16 v[162:163], v196 offset:33280
    ds_read_b128 v[4:7], v223 offset:0
    ds_read_b64_tr_b16 v[164:165], v197 offset:32768
    ds_read_b64_tr_b16 v[166:167], v197 offset:33280
    ds_read_b128 v[8:11], v224 offset:0
    ds_read_b64_tr_b16 v[168:169], v198 offset:32768
    ds_read_b64_tr_b16 v[170:171], v198 offset:33280
    s_waitcnt lgkmcnt(6)
    v_mfma_f32_32x32x16_bf16 v[144:159], v[160:163], v[0:3], 0
    v_mfma_f32_16x16x32_bf16 v[212:215], v[176:179], v[160:163], 0
    ds_read_b128 v[12:15], v225 offset:0
    ds_read_b64_tr_b16 v[172:173], v199 offset:32768
    ds_read_b64_tr_b16 v[174:175], v199 offset:33280
    s_add_u32 m0, s53, 98304
    s_nop 0
    buffer_load_dwordx4 v220, s[4:7], s68 offen lds
    v_mov_b32 v226, 0
    v_mov_b32 v227, 0
    v_mov_b32 v228, 0
    v_mov_b32 v229, 0
    s_waitcnt lgkmcnt(6)
    v_mfma_f32_32x32x16_bf16 v[144:159], v[164:167], v[4:7], v[144:159]
    ds_read_b128 v[16:19], v222 offset:16384
    ds_read_b64_tr_b16 v[160:161], v196 offset:40960
    ds_read_b64_tr_b16 v[162:163], v196 offset:41472
    s_add_u32 m0, s53, 99328
    s_nop 0
    buffer_load_dwordx4 v221, s[4:7], s68 offen lds
    s_waitcnt lgkmcnt(6)
    v_mfma_f32_32x32x16_bf16 v[144:159], v[168:171], v[8:11], v[144:159]
    ds_read_b128 v[20:23], v223 offset:16384
    ds_read_b64_tr_b16 v[164:165], v197 offset:40960
    ds_read_b64_tr_b16 v[166:167], v197 offset:41472
    s_add_u32 m0, s53, 114688
    s_nop 0
    buffer_load_dwordx4 v220, s[4:7], s69 offen lds
    v_dot2c_f32_bf16 v226, v8, v234
    v_dot2c_f32_bf16 v228, v8, v8
    v_dot2c_f32_bf16 v227, v9, v234
    v_dot2c_f32_bf16 v229, v9, v9
    v_dot2c_f32_bf16 v226, v10, v234
    v_dot2c_f32_bf16 v228, v10, v10
    s_waitcnt lgkmcnt(6)
    v_mfma_f32_32x32x16_bf16 v[144:159], v[172:175], v[12:15], v[144:159]
    ds_read_b128 v[24:27], v224 offset:16384
    ds_read_b64_tr_b16 v[168:169], v198 offset:40960
    ds_read_b64_tr_b16 v[170:171], v198 offset:41472
    s_add_u32 m0, s53, 115712
    s_nop 0
    buffer_load_dwordx4 v221, s[4:7], s69 offen lds
    v_dot2c_f32_bf16 v227, v11, v234
    v_dot2c_f32_bf16 v229, v11, v11
    v_dot2c_f32_bf16 v226, v12, v234
    v_dot2c_f32_bf16 v228, v12, v12
    v_dot2c_f32_bf16 v227, v13, v234
    v_dot2c_f32_bf16 v229, v13, v13
    s_waitcnt lgkmcnt(6)
    v_mfma_f32_32x32x16_bf16 v[144:159], v[160:163], v[16:19], v[144:159]
    v_mfma_f32_16x16x32_bf16 v[212:215], v[176:179], v[160:163], v[212:215]
    ds_read_b128 v[28:31], v225 offset:16384
    ds_read_b64_tr_b16 v[172:173], v199 offset:40960
    ds_read_b64_tr_b16 v[174:175], v199 offset:41472
    v_dot2c_f32_bf16 v226, v14, v234
    v_dot2c_f32_bf16 v228, v14, v14
    v_dot2c_f32_bf16 v227, v15, v234
    v_dot2c_f32_bf16 v229, v15, v15
    s_waitcnt lgkmcnt(6)
    v_mfma_f32_32x32x16_bf16 v[144:159], v[164:167], v[20:23], v[144:159]
    s_waitcnt vmcnt(4) lgkmcnt(0)
    s_barrier
    ds_read_b128 v[32:35], v222 offset:49152
    v_add_u32 v196, 0x10000, v196
    ds_read_b64_tr_b16 v[160:161], v196 offset:16384
    ds_read_b64_tr_b16 v[162:163], v196 offset:16896
    s_add_u32 m0, s52, 131072
    s_nop 0
    buffer_load_dwordx4 v202, s[8:11], s82 offen lds
    v_mfma_f32_32x32x16_bf16 v[144:159], v[168:171], v[24:27], v[144:159]
    ds_read_b128 v[36:39], v223 offset:49152
    v_add_u32 v197, 0x10000, v197
    ds_read_b64_tr_b16 v[164:165], v197 offset:16384
    ds_read_b64_tr_b16 v[166:167], v197 offset:16896
    s_add_u32 m0, s52, 139264
    s_nop 0
    buffer_load_dwordx4 v202, s[8:11], s83 offen lds
    v_dot2c_f32_bf16 v226, v24, v234
    v_dot2c_f32_bf16 v228, v24, v24
    v_dot2c_f32_bf16 v227, v25, v234
    v_dot2c_f32_bf16 v229, v25, v25
    v_dot2c_f32_bf16 v226, v26, v234
    v_dot2c_f32_bf16 v228, v26, v26
    v_mfma_f32_32x32x16_bf16 v[144:159], v[172:175], v[28:31], v[144:159]
    ds_read_b128 v[40:43], v224 offset:49152
    v_add_u32 v198, 0x10000, v198
    ds_read_b64_tr_b16 v[168:169], v198 offset:16384
    ds_read_b64_tr_b16 v[170:171], v198 offset:16896
    s_add_u32 m0, s53, 0
    s_nop 0
    buffer_load_dwordx4 v220, s[4:7], s70 offen lds
    v_dot2c_f32_bf16 v227, v27, v234
    v_dot2c_f32_bf16 v229, v27, v27
    v_dot2c_f32_bf16 v226, v28, v234
    v_dot2c_f32_bf16 v228, v28, v28
    v_dot2c_f32_bf16 v227, v29, v234
    v_dot2c_f32_bf16 v229, v29, v29
    s_waitcnt lgkmcnt(6)
    v_mfma_f32_32x32x16_bf16 v[144:159], v[160:163], v[32:35], v[144:159]
    v_mfma_f32_16x16x32_bf16 v[212:215], v[176:179], v[160:163], v[212:215]
    ds_read_b128 v[44:47], v225 offset:49152
    v_add_u32 v199, 0x10000, v199
    ds_read_b64_tr_b16 v[172:173], v199 offset:16384
    ds_read_b64_tr_b16 v[174:175], v199 offset:16896
    v_dot2c_f32_bf16 v226, v30, v234
    v_dot2c_f32_bf16 v228, v30, v30
    v_dot2c_f32_bf16 v227, v31, v234
    v_dot2c_f32_bf16 v229, v31, v31
    s_waitcnt lgkmcnt(6)
    v_mfma_f32_32x32x16_bf16 v[144:159], v[164:167], v[36:39], v[144:159]
    v_add_u32 v222, 0x10000, v222
    ds_read_b128 v[48:51], v222 offset:0
    ds_read_b64_tr_b16 v[160:161], v196 offset:24576
    ds_read_b64_tr_b16 v[162:163], v196 offset:25088
    s_add_u32 m0, s53, 1024
    s_nop 0
    buffer_load_dwordx4 v221, s[4:7], s70 offen lds
    s_waitcnt lgkmcnt(6)
    v_mfma_f32_32x32x16_bf16 v[144:159], v[168:171], v[40:43], v[144:159]
    v_add_u32 v223, 0x10000, v223
    ds_read_b128 v[52:55], v223 offset:0
    ds_read_b64_tr_b16 v[164:165], v197 offset:24576
    ds_read_b64_tr_b16 v[166:167], v197 offset:25088
    s_add_u32 m0, s52, 16384
    s_nop 0
    buffer_load_dwordx4 v202, s[8:11], s84 offen lds
    v_dot2c_f32_bf16 v226, v40, v234
    v_dot2c_f32_bf16 v228, v40, v40
    v_dot2c_f32_bf16 v227, v41, v234
    v_dot2c_f32_bf16 v229, v41, v41
    v_dot2c_f32_bf16 v226, v42, v234
    v_dot2c_f32_bf16 v228, v42, v42
    s_waitcnt lgkmcnt(6)
    v_mfma_f32_32x32x16_bf16 v[144:159], v[172:175], v[44:47], v[144:159]
    v_add_u32 v224, 0x10000, v224
    ds_read_b128 v[56:59], v224 offset:0
    ds_read_b64_tr_b16 v[168:169], v198 offset:24576
    ds_read_b64_tr_b16 v[170:171], v198 offset:25088
    s_add_u32 m0, s52, 32768
    s_nop 0
    buffer_load_dwordx4 v200, s[20:23], s71 offen lds
    v_dot2c_f32_bf16 v227, v43, v234
    v_dot2c_f32_bf16 v229, v43, v43
    v_dot2c_f32_bf16 v226, v44, v234
    v_dot2c_f32_bf16 v228, v44, v44
    v_dot2c_f32_bf16 v227, v45, v234
    v_dot2c_f32_bf16 v229, v45, v45
    s_waitcnt lgkmcnt(6)
    v_mfma_f32_32x32x16_bf16 v[144:159], v[160:163], v[48:51], v[144:159]
    v_mfma_f32_16x16x32_bf16 v[212:215], v[176:179], v[160:163], v[212:215]
    v_add_u32 v225, 0x10000, v225
    ds_read_b128 v[60:63], v225 offset:0
    ds_read_b64_tr_b16 v[172:173], v199 offset:24576
    ds_read_b64_tr_b16 v[174:175], v199 offset:25088
    s_add_u32 m0, s52, 40960
    s_nop 0
    buffer_load_dwordx4 v201, s[24:27], s71 offen lds
    v_dot2c_f32_bf16 v226, v46, v234
    v_dot2c_f32_bf16 v228, v46, v46
    v_dot2c_f32_bf16 v227, v47, v234
    v_dot2c_f32_bf16 v229, v47, v47
    s_waitcnt lgkmcnt(6)
    v_mfma_f32_32x32x16_bf16 v[144:159], v[164:167], v[52:55], v[144:159]
    s_waitcnt vmcnt(5) lgkmcnt(0)
    s_barrier
    ds_read_b128 v[64:67], v222 offset:32768
    v_add_u32 v196, 0x10000, v196
    ds_read_b64_tr_b16 v[160:161], v196 offset:0
    ds_read_b64_tr_b16 v[162:163], v196 offset:512
    s_add_u32 m0, s52, 49152
    s_nop 0
    buffer_load_dwordx4 v200, s[20:23], s72 offen lds
    v_mfma_f32_32x32x16_bf16 v[144:159], v[168:171], v[56:59], v[144:159]
    ds_read_b128 v[68:71], v223 offset:32768
    v_add_u32 v197, 0x10000, v197
    ds_read_b64_tr_b16 v[164:165], v197 offset:0
    ds_read_b64_tr_b16 v[166:167], v197 offset:512
    v_dot2c_f32_bf16 v226, v56, v234
    v_dot2c_f32_bf16 v228, v56, v56
    v_dot2c_f32_bf16 v227, v57, v234
    v_dot2c_f32_bf16 v229, v57, v57
    v_dot2c_f32_bf16 v226, v58, v234
    v_dot2c_f32_bf16 v228, v58, v58
    v_mfma_f32_32x32x16_bf16 v[144:159], v[172:175], v[60:63], v[144:159]
    ds_read_b128 v[72:75], v224 offset:32768
    v_add_u32 v198, 0x10000, v198
    ds_read_b64_tr_b16 v[168:169], v198 offset:0
    ds_read_b64_tr_b16 v[170:171], v198 offset:512
    s_add_u32 m0, s52, 57344
    s_nop 0
    buffer_load_dwordx4 v201, s[24:27], s72 offen lds
    v_dot2c_f32_bf16 v227, v59, v234
    v_dot2c_f32_bf16 v229, v59, v59
    v_dot2c_f32_bf16 v226, v60, v234
    v_dot2c_f32_bf16 v228, v60, v60
    v_dot2c_f32_bf16 v227, v61, v234
    v_dot2c_f32_bf16 v229, v61, v61
    s_waitcnt lgkmcnt(6)
    v_mfma_f32_32x32x16_bf16 v[144:159], v[160:163], v[64:67], v[144:159]
    v_mfma_f32_16x16x32_bf16 v[212:215], v[176:179], v[160:163], v[212:215]
    ds_read_b128 v[76:79], v225 offset:32768
    v_add_u32 v199, 0x10000, v199
    ds_read_b64_tr_b16 v[172:173], v199 offset:0
    ds_read_b64_tr_b16 v[174:175], v199 offset:512
    s_add_u32 m0, s52, 65536
    s_nop 0
    buffer_load_dwordx4 v200, s[20:23], s73 offen lds
    v_dot2c_f32_bf16 v226, v62, v234
    v_dot2c_f32_bf16 v228, v62, v62
    v_dot2c_f32_bf16 v227, v63, v234
    v_dot2c_f32_bf16 v229, v63, v63
    s_waitcnt lgkmcnt(6)
    v_mfma_f32_32x32x16_bf16 v[144:159], v[164:167], v[68:71], v[144:159]
    ds_read_b128 v[80:83], v222 offset:49152
    ds_read_b64_tr_b16 v[160:161], v196 offset:8192
    ds_read_b64_tr_b16 v[162:163], v196 offset:8704
    s_add_u32 m0, s52, 73728
    s_nop 0
    buffer_load_dwordx4 v201, s[24:27], s73 offen lds
    s_waitcnt lgkmcnt(6)
    v_mfma_f32_32x32x16_bf16 v[144:159], v[168:171], v[72:75], v[144:159]
    ds_read_b128 v[84:87], v223 offset:49152
    ds_read_b64_tr_b16 v[164:165], v197 offset:8192
    ds_read_b64_tr_b16 v[166:167], v197 offset:8704
    v_dot2c_f32_bf16 v226, v72, v234
    v_dot2c_f32_bf16 v228, v72, v72
    v_dot2c_f32_bf16 v227, v73, v234
    v_dot2c_f32_bf16 v229, v73, v73
    v_dot2c_f32_bf16 v226, v74, v234
    v_dot2c_f32_bf16 v228, v74, v74
    s_waitcnt lgkmcnt(6)
    v_mfma_f32_32x32x16_bf16 v[144:159], v[172:175], v[76:79], v[144:159]
    ds_read_b128 v[88:91], v224 offset:49152
    ds_read_b64_tr_b16 v[168:169], v198 offset:8192
    ds_read_b64_tr_b16 v[170:171], v198 offset:8704
    s_add_u32 m0, s52, 81920
    s_nop 0
    buffer_load_dwordx4 v200, s[20:23], s74 offen lds
    v_dot2c_f32_bf16 v227, v75, v234
    v_dot2c_f32_bf16 v229, v75, v75
    v_dot2c_f32_bf16 v226, v76, v234
    v_dot2c_f32_bf16 v228, v76, v76
    v_dot2c_f32_bf16 v227, v77, v234
    v_dot2c_f32_bf16 v229, v77, v77
    s_waitcnt lgkmcnt(6)
    v_mfma_f32_32x32x16_bf16 v[144:159], v[160:163], v[80:83], v[144:159]
    v_mfma_f32_16x16x32_bf16 v[212:215], v[176:179], v[160:163], v[212:215]
    ds_read_b128 v[92:95], v225 offset:49152
    ds_read_b64_tr_b16 v[172:173], v199 offset:8192
    ds_read_b64_tr_b16 v[174:175], v199 offset:8704
    s_add_u32 m0, s52, 90112
    s_nop 0
    buffer_load_dwordx4 v201, s[24:27], s74 offen lds
    v_dot2c_f32_bf16 v226, v78, v234
    v_dot2c_f32_bf16 v228, v78, v78
    v_dot2c_f32_bf16 v227, v79, v234
    v_dot2c_f32_bf16 v229, v79, v79
    s_waitcnt lgkmcnt(6)
    v_mfma_f32_32x32x16_bf16 v[144:159], v[164:167], v[84:87], v[144:159]
    s_waitcnt vmcnt(8) lgkmcnt(0)
    s_barrier
    v_add_u32 v222, 0xffff0000, v222
    ds_read_b128 v[96:99], v222 offset:0
    v_add_u32 v196, 0xfffe0000, v196
    ds_read_b64_tr_b16 v[160:161], v196 offset:16384
    ds_read_b64_tr_b16 v[162:163], v196 offset:16896
    s_add_u32 m0, s52, 98304
    s_nop 0
    buffer_load_dwordx4 v200, s[20:23], s75 offen lds
    v_mfma_f32_32x32x16_bf16 v[144:159], v[168:171], v[88:91], v[144:159]
    v_add_u32 v223, 0xffff0000, v223
    ds_read_b128 v[100:103], v223 offset:0
    v_add_u32 v197, 0xfffe0000, v197
    ds_read_b64_tr_b16 v[164:165], v197 offset:16384
    ds_read_b64_tr_b16 v[166:167], v197 offset:16896
    s_add_u32 m0, s52, 106496
    s_nop 0
    buffer_load_dwordx4 v201, s[24:27], s75 offen lds
    s_add_u32 m0, s52, 114688
    s_nop 0
    buffer_load_dwordx4 v200, s[20:23], s76 offen lds
    v_dot2c_f32_bf16 v226, v88, v234
    v_dot2c_f32_bf16 v228, v88, v88
    v_dot2c_f32_bf16 v227, v89, v234
    v_dot2c_f32_bf16 v229, v89, v89
    v_dot2c_f32_bf16 v226, v90, v234
    v_dot2c_f32_bf16 v228, v90, v90
    v_mfma_f32_32x32x16_bf16 v[144:159], v[172:175], v[92:95], v[144:159]
    v_add_u32 v224, 0xffff0000, v224
    ds_read_b128 v[104:107], v224 offset:0
    v_add_u32 v198, 0xfffe0000, v198
    ds_read_b64_tr_b16 v[168:169], v198 offset:16384
    ds_read_b64_tr_b16 v[170:171], v198 offset:16896
    s_add_u32 m0, s52, 122880
    s_nop 0
    buffer_load_dwordx4 v201, s[24:27], s76 offen lds
    v_dot2c_f32_bf16 v227, v91, v234
    v_dot2c_f32_bf16 v229, v91, v91
    v_dot2c_f32_bf16 v226, v92, v234
    v_dot2c_f32_bf16 v228, v92, v92
    v_dot2c_f32_bf16 v227, v93, v234
    v_dot2c_f32_bf16 v229, v93, v93
    s_waitcnt lgkmcnt(6)
    v_mfma_f32_32x32x16_bf16 v[144:159], v[160:163], v[96:99], v[144:159]
    v_mfma_f32_16x16x32_bf16 v[212:215], v[176:179], v[160:163], v[212:215]
    v_add_u32 v225, 0xffff0000, v225
    ds_read_b128 v[108:111], v225 offset:0
    v_add_u32 v199, 0xfffe0000, v199
    ds_read_b64_tr_b16 v[172:173], v199 offset:16384
    ds_read_b64_tr_b16 v[174:175], v199 offset:16896
    s_add_u32 m0, s52, 131072
    s_nop 0
    buffer_load_dwordx4 v200, s[20:23], s77 offen lds
    s_add_u32 m0, s52, 139264
    s_nop 0
    buffer_load_dwordx4 v201, s[24:27], s77 offen lds
    v_dot2c_f32_bf16 v226, v94, v234
    v_dot2c_f32_bf16 v228, v94, v94
    v_dot2c_f32_bf16 v227, v95, v234
    v_dot2c_f32_bf16 v229, v95, v95
    s_waitcnt lgkmcnt(6)
    v_mfma_f32_32x32x16_bf16 v[144:159], v[164:167], v[100:103], v[144:159]
    s_waitcnt vmcnt(12) lgkmcnt(0)
    s_barrier
    ds_read_b64_tr_b16 v[160:161], v188 offset:32768
    ds_read_b64_tr_b16 v[162:163], v188 offset:33280
    v_mfma_f32_32x32x16_bf16 v[144:159], v[168:171], v[104:107], v[144:159]
    ds_read_b64_tr_b16 v[164:165], v189 offset:32768
    ds_read_b64_tr_b16 v[166:167], v189 offset:33280
    v_add_u32 v200, 128, v200
    v_add_u32 v201, 128, v201
    s_add_u32 m0, s52, 0
    s_nop 0
    buffer_load_dwordx4 v200, s[20:23], s71 offen lds
    v_dot2c_f32_bf16 v226, v104, v234
    v_dot2c_f32_bf16 v228, v104, v104
    v_dot2c_f32_bf16 v227, v105, v234
    v_dot2c_f32_bf16 v229, v105, v105
    v_dot2c_f32_bf16 v226, v106, v234
    v_dot2c_f32_bf16 v228, v106, v106
    v_mfma_f32_32x32x16_bf16 v[144:159], v[172:175], v[108:111], v[144:159]
    ds_read_b64_tr_b16 v[168:169], v190 offset:32768
    ds_read_b64_tr_b16 v[170:171], v190 offset:33280
    v_dot2c_f32_bf16 v227, v107, v234
    v_dot2c_f32_bf16 v229, v107, v107
    v_dot2c_f32_bf16 v226, v108, v234
    v_dot2c_f32_bf16 v228, v108, v108
    v_dot2c_f32_bf16 v227, v109, v234
    v_dot2c_f32_bf16 v229, v109, v109
    s_waitcnt lgkmcnt(4)
    v_mfma_f32_32x32x16_bf16 v[112:127], v[160:163], v[0:3], 0
    v_mfma_f32_16x16x32_bf16 v[180:183], v[176:179], v[160:163], 0
    ds_read_b64_tr_b16 v[172:173], v191 offset:32768
    ds_read_b64_tr_b16 v[174:175], v191 offset:33280
    s_add_u32 m0, s52, 8192
    s_nop 0
    buffer_load_dwordx4 v201, s[24:27], s71 offen lds
    v_dot2c_f32_bf16 v226, v110, v234
    v_dot2c_f32_bf16 v228, v110, v110
    v_dot2c_f32_bf16 v227, v111, v234
    v_dot2c_f32_bf16 v229, v111, v111
    s_nop 1
    v_add_f32 v226, v226, v227
    v_add_f32 v227, v228, v229
    s_waitcnt lgkmcnt(4)
    v_mfma_f32_32x32x16_bf16 v[128:143], v[164:167], v[0:3], 0
    v_mfma_f32_16x16x32_bf16 v[184:187], v[176:179], v[164:167], 0
    ds_read_b64_tr_b16 v[160:161], v192 offset:32768
    ds_read_b64_tr_b16 v[162:163], v192 offset:33280
    v_and_b32 v230, 0x1f0, v204
    v_lshlrev_b32 v230, 1, v230
    s_lshl_b32 s94, s45, 10
    s_add_u32 s94, s94, 147456
    v_add_u32 v230, s94, v230
    v_lshrrev_b32 v231, 9, v204
    v_lshl_add_u32 v231, v231, 3, v230
    s_waitcnt lgkmcnt(4)
    v_mfma_f32_32x32x16_bf16 v[112:127], v[168:171], v[4:7], v[112:127]
    ds_read_b64_tr_b16 v[164:165], v193 offset:32768
    ds_read_b64_tr_b16 v[166:167], v193 offset:33280
    s_add_u32 m0, s52, 16384
    s_nop 0
    buffer_load_dwordx4 v200, s[20:23], s72 offen lds
    ds_write_b64 v231, v[226:227] offset:16
    s_waitcnt lgkmcnt(5)
    v_mfma_f32_32x32x16_bf16 v[128:143], v[172:175], v[4:7], v[128:143]
    ds_read_b64_tr_b16 v[168:169], v194 offset:32768
    ds_read_b64_tr_b16 v[170:171], v194 offset:33280
    s_waitcnt lgkmcnt(5)
    v_mfma_f32_32x32x16_bf16 v[112:127], v[160:163], v[8:11], v[112:127]
    ds_read_b64_tr_b16 v[172:173], v195 offset:32768
    ds_read_b64_tr_b16 v[174:175], v195 offset:33280
    s_add_u32 m0, s52, 24576
    s_nop 0
    buffer_load_dwordx4 v201, s[24:27], s72 offen lds
    ds_write_b32 v206, v212 offset:0
    s_waitcnt lgkmcnt(6)
    v_mfma_f32_32x32x16_bf16 v[128:143], v[164:167], v[8:11], v[128:143]
    s_waitcnt vmcnt(14) lgkmcnt(0)
    s_barrier
    ds_read_b64_tr_b16 v[160:161], v188 offset:49152
    ds_read_b64_tr_b16 v[162:163], v188 offset:49664
    ds_read_b128 v[220:223], v230
    ds_read_b128 v[224:227], v230 offset:16
    v_mfma_f32_32x32x16_bf16 v[112:127], v[168:171], v[12:15], v[112:127]
    ds_read_b64_tr_b16 v[164:165], v189 offset:49152
    ds_read_b64_tr_b16 v[166:167], v189 offset:49664
    v_mfma_f32_32x32x16_bf16 v[128:143], v[172:175], v[12:15], v[128:143]
    ds_read_b64_tr_b16 v[168:169], v190 offset:49152
    ds_read_b64_tr_b16 v[170:171], v190 offset:49664
    s_waitcnt lgkmcnt(5)
    v_add_f32 v220, v220, v222
    v_add_f32 v221, v221, v223
    s_waitcnt lgkmcnt(4)
    v_add_f32 v224, v224, v226
    v_add_f32 v225, v225, v227
    v_add_f32 v220, v220, v224
    v_add_f32 v221, v221, v225
    v_mul_f32 v208, 0xbb124925, v220
    v_mul_f32 v221, 0x3b124925, v221
    v_fma_f32 v221, -v208, v208, v221
    v_max_f32 v221, 0, v221
    v_mfma_f32_32x32x16_bf16 v[112:127], v[160:163], v[16:19], v[112:127]
    v_mfma_f32_16x16x32_bf16 v[180:183], v[176:179], v[160:163], v[180:183]
    ds_read_b64_tr_b16 v[172:173], v191 offset:49152
    ds_read_b64_tr_b16 v[174:175], v191 offset:49664
    v_add_f32 v221, 0x3727c5ac, v221
    v_rsq_f32 v209, v221
    v_rcp_f32 v210, v221
    s_nop 0
    v_mul_f32 v211, 0x3fb8aa3b, v209
    ds_read_b64 v[228:229], v207 offset:0
    s_waitcnt lgkmcnt(5)
    v_mfma_f32_32x32x16_bf16 v[128:143], v[164:167], v[16:19], v[128:143]
    v_mfma_f32_16x16x32_bf16 v[184:187], v[176:179], v[164:167], v[184:187]
    ds_read_b64_tr_b16 v[160:161], v192 offset:49152
    ds_read_b64_tr_b16 v[162:163], v192 offset:49664
    s_waitcnt lgkmcnt(5)
    v_mfma_f32_32x32x16_bf16 v[112:127], v[168:171], v[20:23], v[112:127]
    ds_read_b64_tr_b16 v[164:165], v193 offset:49152
    ds_read_b64_tr_b16 v[166:167], v193 offset:49664
    s_waitcnt lgkmcnt(4)
    v_add_f32 v228, v228, v229
    v_mfma_f32_32x32x16_bf16 v[128:143], v[172:175], v[20:23], v[128:143]
    ds_read_b64_tr_b16 v[168:169], v194 offset:49152
    ds_read_b64_tr_b16 v[170:171], v194 offset:49664
    v_mfma_f32_32x32x2_f32 v[144:159], v228, v208, v[144:159]
    s_waitcnt lgkmcnt(4)
    v_mfma_f32_32x32x16_bf16 v[112:127], v[160:163], v[24:27], v[112:127]
    ds_read_b64_tr_b16 v[172:173], v195 offset:49152
    ds_read_b64_tr_b16 v[174:175], v195 offset:49664
    s_waitcnt lgkmcnt(4)
    v_mfma_f32_32x32x16_bf16 v[128:143], v[164:167], v[24:27], v[128:143]
    s_waitcnt vmcnt(12)
    s_barrier
    v_add_u32 v188, 0x10000, v188
    ds_read_b64_tr_b16 v[160:161], v188 offset:0
    ds_read_b64_tr_b16 v[162:163], v188 offset:512
    s_waitcnt lgkmcnt(4)
    v_mfma_f32_32x32x16_bf16 v[112:127], v[168:171], v[28:31], v[112:127]
    v_add_u32 v189, 0x10000, v189
    ds_read_b64_tr_b16 v[164:165], v189 offset:0
    ds_read_b64_tr_b16 v[166:167], v189 offset:512
    s_waitcnt lgkmcnt(4)
    v_mfma_f32_32x32x16_bf16 v[128:143], v[172:175], v[28:31], v[128:143]
    v_add_u32 v190, 0x10000, v190
    ds_read_b64_tr_b16 v[168:169], v190 offset:0
    ds_read_b64_tr_b16 v[170:171], v190 offset:512
    s_add_u32 m0, s52, 32768
    s_nop 0
    buffer_load_dwordx4 v200, s[20:23], s73 offen lds
    v_mul_f32 v144, v144, v209
    v_mul_f32 v145, v145, v209
    v_mul_f32 v146, v146, v209
    v_mul_f32 v147, v147, v209
    v_mul_f32 v148, v148, v209
    v_mul_f32 v149, v149, v209
    v_mul_f32 v150, v150, v209
    v_mul_f32 v151, v151, v209
    v_mul_f32 v152, v152, v209
    v_mul_f32 v153, v153, v209
    s_waitcnt lgkmcnt(4)
    v_mfma_f32_32x32x16_bf16 v[112:127], v[160:163], v[32:35], v[112:127]
    v_mfma_f32_16x16x32_bf16 v[180:183], v[176:179], v[160:163], v[180:183]
    v_add_u32 v191, 0x10000, v191
    ds_read_b64_tr_b16 v[172:173], v191 offset:0
    ds_read_b64_tr_b16 v[174:175], v191 offset:512
    v_mul_f32 v154, v154, v209
    v_mul_f32 v155, v155, v209
    v_mul_f32 v156, v156, v209
    v_mul_f32 v157, v157, v209
    v_mul_f32 v158, v158, v209
    v_mul_f32 v159, v159, v209
    v_cndmask_b32 v156, v156, 1.0, s[60:61]
    v_cvt_pk_bf16_f32 v144, v144, v145
    v_cvt_pk_bf16_f32 v145, v146, v147
    v_cvt_pk_bf16_f32 v146, v148, v149
    s_waitcnt lgkmcnt(4)
    v_mfma_f32_32x32x16_bf16 v[128:143], v[164:167], v[32:35], v[128:143]
    v_mfma_f32_16x16x32_bf16 v[184:187], v[176:179], v[164:167], v[184:187]
    v_add_u32 v192, 0x10000, v192
    ds_read_b64_tr_b16 v[160:161], v192 offset:0
    ds_read_b64_tr_b16 v[162:163], v192 offset:512
    v_cvt_pk_bf16_f32 v147, v150, v151
    v_cvt_pk_bf16_f32 v148, v152, v153
    v_cvt_pk_bf16_f32 v149, v154, v155
    v_cvt_pk_bf16_f32 v150, v156, v157
    v_cvt_pk_bf16_f32 v151, v158, v159
    v_bfe_u32 v252, v204, 6, 1
    v_bfe_u32 v253, v204, 7, 1
    v_lshl_or_b32 v252, v253, 2, v252
    v_lshrrev_b32 v253, 9, v204
    v_xor_b32 v252, v252, v253
    s_waitcnt lgkmcnt(4)
    v_mfma_f32_32x32x16_bf16 v[112:127], v[168:171], v[36:39], v[112:127]
    v_add_u32 v193, 0x10000, v193
    ds_read_b64_tr_b16 v[164:165], v193 offset:0
    ds_read_b64_tr_b16 v[166:167], v193 offset:512
    v_lshlrev_b32 v252, 3, v252
    v_and_b32 v253, 0x1f0, v204
    v_lshl_add_u32 v252, v253, 2, v252
    s_lshl_b32 s94, s45, 11
    s_add_u32 s94, s94, 155648
    v_add_u32 v252, s94, v252
    ds_write_b64 v252, v[144:145]
    v_xor_b32 v253, 16, v252
    ds_write_b64 v253, v[146:147]
    v_xor_b32 v253, 32, v252
    ds_write_b64 v253, v[148:149]
    s_waitcnt lgkmcnt(7)
    v_mfma_f32_32x32x16_bf16 v[128:143], v[172:175], v[36:39], v[128:143]
    v_add_u32 v194, 0x10000, v194
    ds_read_b64_tr_b16 v[168:169], v194 offset:0
    ds_read_b64_tr_b16 v[170:171], v194 offset:512
    s_add_u32 m0, s52, 40960
    s_nop 0
    buffer_load_dwordx4 v201, s[24:27], s73 offen lds
    v_xor_b32 v253, 48, v252
    ds_write_b64 v253, v[150:151]
    s_waitcnt lgkmcnt(8)
    v_mfma_f32_32x32x16_bf16 v[112:127], v[160:163], v[40:43], v[112:127]
    v_add_u32 v195, 0x10000, v195
    ds_read_b64_tr_b16 v[172:173], v195 offset:0
    ds_read_b64_tr_b16 v[174:175], v195 offset:512
    s_waitcnt lgkmcnt(8)
    v_mfma_f32_32x32x16_bf16 v[128:143], v[164:167], v[40:43], v[128:143]
    s_waitcnt vmcnt(12) lgkmcnt(2)
    s_barrier
    ds_read_b64_tr_b16 v[160:161], v188 offset:16384
    ds_read_b64_tr_b16 v[162:163], v188 offset:16896
    v_mfma_f32_32x32x16_bf16 v[112:127], v[168:171], v[44:47], v[112:127]
    ds_read_b64_tr_b16 v[164:165], v189 offset:16384
    ds_read_b64_tr_b16 v[166:167], v189 offset:16896
    s_waitcnt lgkmcnt(4)
    v_mfma_f32_32x32x16_bf16 v[128:143], v[172:175], v[44:47], v[128:143]
    ds_read_b64_tr_b16 v[168:169], v190 offset:16384
    ds_read_b64_tr_b16 v[170:171], v190 offset:16896
    s_waitcnt lgkmcnt(4)
    v_mfma_f32_32x32x16_bf16 v[112:127], v[160:163], v[48:51], v[112:127]
    v_mfma_f32_16x16x32_bf16 v[180:183], v[176:179], v[160:163], v[180:183]
    ds_read_b64_tr_b16 v[172:173], v191 offset:16384
    ds_read_b64_tr_b16 v[174:175], v191 offset:16896
    s_waitcnt lgkmcnt(4)
    v_mfma_f32_32x32x16_bf16 v[128:143], v[164:167], v[48:51], v[128:143]
    v_mfma_f32_16x16x32_bf16 v[184:187], v[176:179], v[164:167], v[184:187]
    ds_read_b64_tr_b16 v[160:161], v192 offset:16384
    ds_read_b64_tr_b16 v[162:163], v192 offset:16896
    s_waitcnt lgkmcnt(4)
    v_mfma_f32_32x32x16_bf16 v[112:127], v[168:171], v[52:55], v[112:127]
    ds_read_b64_tr_b16 v[164:165], v193 offset:16384
    ds_read_b64_tr_b16 v[166:167], v193 offset:16896
    s_waitcnt lgkmcnt(4)
    v_mfma_f32_32x32x16_bf16 v[128:143], v[172:175], v[52:55], v[128:143]
    ds_read_b64_tr_b16 v[168:169], v194 offset:16384
    ds_read_b64_tr_b16 v[170:171], v194 offset:16896
    s_waitcnt lgkmcnt(4)
    v_mfma_f32_32x32x16_bf16 v[112:127], v[160:163], v[56:59], v[112:127]
    ds_read_b64_tr_b16 v[172:173], v195 offset:16384
    ds_read_b64_tr_b16 v[174:175], v195 offset:16896
    s_waitcnt lgkmcnt(4)
    v_mfma_f32_32x32x16_bf16 v[128:143], v[164:167], v[56:59], v[128:143]
    s_waitcnt vmcnt(10)
    s_barrier
    ds_read_b64_tr_b16 v[160:161], v188 offset:32768
    ds_read_b64_tr_b16 v[162:163], v188 offset:33280
    s_waitcnt lgkmcnt(4)
    v_mfma_f32_32x32x16_bf16 v[112:127], v[168:171], v[60:63], v[112:127]
    ds_read_b64_tr_b16 v[164:165], v189 offset:32768
    ds_read_b64_tr_b16 v[166:167], v189 offset:33280
    s_waitcnt lgkmcnt(4)
    v_mfma_f32_32x32x16_bf16 v[128:143], v[172:175], v[60:63], v[128:143]
    ds_read_b64_tr_b16 v[168:169], v190 offset:32768
    ds_read_b64_tr_b16 v[170:171], v190 offset:33280
    s_add_u32 m0, s52, 65536
    s_nop 0
    buffer_load_dwordx4 v200, s[20:23], s74 offen lds
    s_waitcnt lgkmcnt(4)
    v_mfma_f32_32x32x16_bf16 v[112:127], v[160:163], v[64:67], v[112:127]
    v_mfma_f32_16x16x32_bf16 v[180:183], v[176:179], v[160:163], v[180:183]
    ds_read_b64_tr_b16 v[172:173], v191 offset:32768
    ds_read_b64_tr_b16 v[174:175], v191 offset:33280
    s_waitcnt lgkmcnt(4)
    v_mfma_f32_32x32x16_bf16 v[128:143], v[164:167], v[64:67], v[128:143]
    v_mfma_f32_16x16x32_bf16 v[184:187], v[176:179], v[164:167], v[184:187]
    ds_read_b64_tr_b16 v[160:161], v192 offset:32768
    ds_read_b64_tr_b16 v[162:163], v192 offset:33280
    s_waitcnt lgkmcnt(4)
    v_mfma_f32_32x32x16_bf16 v[112:127], v[168:171], v[68:71], v[112:127]
    ds_read_b64_tr_b16 v[164:165], v193 offset:32768
    ds_read_b64_tr_b16 v[166:167], v193 offset:33280
    s_waitcnt lgkmcnt(4)
    v_mfma_f32_32x32x16_bf16 v[128:143], v[172:175], v[68:71], v[128:143]
    ds_read_b64_tr_b16 v[168:169], v194 offset:32768
    ds_read_b64_tr_b16 v[170:171], v194 offset:33280
    s_add_u32 m0, s52, 73728
    s_nop 0
    buffer_load_dwordx4 v201, s[24:27], s74 offen lds
    s_waitcnt lgkmcnt(4)
    v_mfma_f32_32x32x16_bf16 v[112:127], v[160:163], v[72:75], v[112:127]
    ds_read_b64_tr_b16 v[172:173], v195 offset:32768
    ds_read_b64_tr_b16 v[174:175], v195 offset:33280
    s_waitcnt lgkmcnt(4)
    v_mfma_f32_32x32x16_bf16 v[128:143], v[164:167], v[72:75], v[128:143]
    s_waitcnt vmcnt(10)
    s_barrier
    ds_read_b64_tr_b16 v[160:161], v188 offset:49152
    ds_read_b64_tr_b16 v[162:163], v188 offset:49664
    v_lshrrev_b32 v248, 8, v204
    v_bfe_u32 v249, v204, 6, 2
    v_bfe_u32 v250, v204, 4, 2
    v_and_b32 v245, 1, v248
    v_lshlrev_b32 v245, 2, v245
    v_xor_b32 v244, v249, v245
    v_lshrrev_b32 v246, 1, v250
    v_lshl_add_u32 v246, s45, 1, v246
    v_xor_b32 v244, v244, v246
    v_lshlrev_b32 v244, 4, v244
    s_waitcnt lgkmcnt(4)
    v_mfma_f32_32x32x16_bf16 v[112:127], v[168:171], v[76:79], v[112:127]
    ds_read_b64_tr_b16 v[164:165], v189 offset:49152
    ds_read_b64_tr_b16 v[166:167], v189 offset:49664
    v_and_b32 v246, 1, v250
    v_lshl_add_u32 v244, v246, 3, v244
    v_lshl_add_u32 v248, v248, 3, v249
    v_lshl_add_u32 v244, v248, 7, v244
    v_add_u32 v244, 0xc000, v244
    v_or_b32 v246, 4, v250
    v_xor_b32 v246, v246, v245
    v_lshlrev_b32 v246, 3, v246
    v_lshl_add_u32 v246, v248, 6, v246
    v_add_u32 v246, 0x26000, v246
    s_waitcnt lgkmcnt(4)
    v_mfma_f32_32x32x16_bf16 v[128:143], v[172:175], v[76:79], v[128:143]
    ds_read_b64_tr_b16 v[168:169], v190 offset:49152
    ds_read_b64_tr_b16 v[170:171], v190 offset:49664
    s_add_u32 m0, s52, 81920
    s_nop 0
    buffer_load_dwordx4 v200, s[20:23], s75 offen lds
    v_xor_b32 v245, 64, v244
    v_xor_b32 v247, 8, v246
    ds_read_b64_tr_b16 v[220:221], v244 offset:0
    ds_read_b64_tr_b16 v[222:223], v245 offset:512
    ds_read_b64_tr_b16 v[224:225], v246 offset:0
    ds_read_b64_tr_b16 v[226:227], v247 offset:256
    ds_read_b64_tr_b16 v[228:229], v244 offset:4096
    ds_read_b64_tr_b16 v[230:231], v245 offset:4608
    ds_read_b64_tr_b16 v[232:233], v246 offset:2048
    ds_read_b64_tr_b16 v[234:235], v247 offset:2304
    s_waitcnt lgkmcnt(12)
    v_mfma_f32_32x32x16_bf16 v[112:127], v[160:163], v[80:83], v[112:127]
    v_mfma_f32_16x16x32_bf16 v[180:183], v[176:179], v[160:163], v[180:183]
    ds_read_b64_tr_b16 v[172:173], v191 offset:49152
    ds_read_b64_tr_b16 v[174:175], v191 offset:49664
    s_waitcnt lgkmcnt(12)
    v_mfma_f32_32x32x16_bf16 v[128:143], v[164:167], v[80:83], v[128:143]
    v_mfma_f32_16x16x32_bf16 v[184:187], v[176:179], v[164:167], v[184:187]
    ds_read_b64_tr_b16 v[160:161], v192 offset:49152
    ds_read_b64_tr_b16 v[162:163], v192 offset:49664
    s_waitcnt lgkmcnt(8)
    v_mfma_f32_16x16x32_bf16 v[236:239], v[220:223], v[224:227], 0
    s_waitcnt lgkmcnt(4)
    v_mfma_f32_16x16x32_bf16 v[236:239], v[228:231], v[232:235], v[236:239]
    ds_read_b64_tr_b16 v[220:221], v244 offset:8192
    ds_read_b64_tr_b16 v[222:223], v245 offset:8704
    ds_read_b64_tr_b16 v[224:225], v246 offset:4096
    ds_read_b64_tr_b16 v[226:227], v247 offset:4352
    ds_read_b64_tr_b16 v[228:229], v244 offset:12288
    ds_read_b64_tr_b16 v[230:231], v245 offset:12800
    ds_read_b64_tr_b16 v[232:233], v246 offset:6144
    ds_read_b64_tr_b16 v[234:235], v247 offset:6400
    v_mfma_f32_32x32x16_bf16 v[112:127], v[168:171], v[84:87], v[112:127]
    ds_read_b64_tr_b16 v[164:165], v193 offset:49152
    ds_read_b64_tr_b16 v[166:167], v193 offset:49664
    s_waitcnt lgkmcnt(12)
    v_mfma_f32_32x32x16_bf16 v[128:143], v[172:175], v[84:87], v[128:143]
    ds_read_b64_tr_b16 v[168:169], v194 offset:49152
    ds_read_b64_tr_b16 v[170:171], v194 offset:49664
    s_add_u32 m0, s52, 90112
    s_nop 0
    buffer_load_dwordx4 v201, s[24:27], s75 offen lds
    s_waitcnt lgkmcnt(8)
    v_mfma_f32_16x16x32_bf16 v[236:239], v[220:223], v[224:227], v[236:239]
    s_waitcnt lgkmcnt(4)
    v_mfma_f32_16x16x32_bf16 v[236:239], v[228:231], v[232:235], v[236:239]
    v_lshrrev_b32 v248, 8, v204
    v_bfe_u32 v250, v204, 4, 4
    v_lshlrev_b32 v250, 2, v250
    v_lshl_add_u32 v248, v248, 9, v250
    s_lshl_b32 s94, s50, 13
    s_lshl_b32 s95, s45, 11
    s_add_u32 s94, s94, s95
    s_add_u32 s94, s94, 10485824
    v_mfma_f32_32x32x16_bf16 v[112:127], v[160:163], v[88:91], v[112:127]
    ds_read_b64_tr_b16 v[172:173], v195 offset:49152
    ds_read_b64_tr_b16 v[174:175], v195 offset:49664
    s_waitcnt lgkmcnt(4)
    v_mfma_f32_32x32x16_bf16 v[128:143], v[164:167], v[88:91], v[128:143]
    s_waitcnt vmcnt(10)
    s_barrier
    v_add_u32 v188, 0x10000, v188
    ds_read_b64_tr_b16 v[160:161], v188 offset:0
    ds_read_b64_tr_b16 v[162:163], v188 offset:512
    buffer_atomic_add_f32 v236, v248, s[40:43], s94 offen offset:0
    buffer_atomic_add_f32 v237, v248, s[40:43], s94 offen offset:128
    buffer_atomic_add_f32 v238, v248, s[40:43], s94 offen offset:256
    buffer_atomic_add_f32 v239, v248, s[40:43], s94 offen offset:384
    s_waitcnt lgkmcnt(4)
    v_mfma_f32_32x32x16_bf16 v[112:127], v[168:171], v[92:95], v[112:127]
    v_add_u32 v189, 0x10000, v189
    ds_read_b64_tr_b16 v[164:165], v189 offset:0
    ds_read_b64_tr_b16 v[166:167], v189 offset:512
    s_waitcnt lgkmcnt(4)
    v_mfma_f32_32x32x16_bf16 v[128:143], v[172:175], v[92:95], v[128:143]
    v_add_u32 v190, 0x10000, v190
    ds_read_b64_tr_b16 v[168:169], v190 offset:0
    ds_read_b64_tr_b16 v[170:171], v190 offset:512
    s_add_u32 m0, s52, 98304
    s_nop 0
    buffer_load_dwordx4 v200, s[20:23], s76 offen lds
    s_waitcnt lgkmcnt(4)
    v_mfma_f32_32x32x16_bf16 v[112:127], v[160:163], v[96:99], v[112:127]
    v_mfma_f32_16x16x32_bf16 v[180:183], v[176:179], v[160:163], v[180:183]
    v_add_u32 v191, 0x10000, v191
    ds_read_b64_tr_b16 v[172:173], v191 offset:0
    ds_read_b64_tr_b16 v[174:175], v191 offset:512
    s_waitcnt lgkmcnt(4)
    v_mfma_f32_32x32x16_bf16 v[128:143], v[164:167], v[96:99], v[128:143]
    v_mfma_f32_16x16x32_bf16 v[184:187], v[176:179], v[164:167], v[184:187]
    v_add_u32 v192, 0x10000, v192
    ds_read_b64_tr_b16 v[160:161], v192 offset:0
    ds_read_b64_tr_b16 v[162:163], v192 offset:512
    s_waitcnt lgkmcnt(4)
    v_mfma_f32_32x32x16_bf16 v[112:127], v[168:171], v[100:103], v[112:127]
    v_add_u32 v193, 0x10000, v193
    ds_read_b64_tr_b16 v[164:165], v193 offset:0
    ds_read_b64_tr_b16 v[166:167], v193 offset:512
    s_waitcnt lgkmcnt(4)
    v_mfma_f32_32x32x16_bf16 v[128:143], v[172:175], v[100:103], v[128:143]
    v_add_u32 v194, 0x10000, v194
    ds_read_b64_tr_b16 v[168:169], v194 offset:0
    ds_read_b64_tr_b16 v[170:171], v194 offset:512
    s_add_u32 m0, s52, 106496
    s_nop 0
    buffer_load_dwordx4 v201, s[24:27], s76 offen lds
    ds_write_b32 v206, v180 offset:2048
    ds_write_b32 v206, v184 offset:2560
    s_waitcnt lgkmcnt(6)
    v_mfma_f32_32x32x16_bf16 v[112:127], v[160:163], v[104:107], v[112:127]
    v_add_u32 v195, 0x10000, v195
    ds_read_b64_tr_b16 v[172:173], v195 offset:0
    ds_read_b64_tr_b16 v[174:175], v195 offset:512
    s_waitcnt lgkmcnt(6)
    v_mfma_f32_32x32x16_bf16 v[128:143], v[164:167], v[104:107], v[128:143]
    s_waitcnt vmcnt(14) lgkmcnt(2)
    s_barrier
    v_add_u32 v188, 0xfffe0000, v188
    ds_read_b64_tr_b16 v[160:161], v188 offset:0
    ds_read_b64_tr_b16 v[162:163], v188 offset:512
    ds_read_b64 v[228:229], v207 offset:2048
    ds_read_b64 v[230:231], v207 offset:2560
    v_mfma_f32_32x32x16_bf16 v[112:127], v[168:171], v[108:111], v[112:127]
    v_add_u32 v189, 0xfffe0000, v189
    ds_read_b64_tr_b16 v[164:165], v189 offset:0
    ds_read_b64_tr_b16 v[166:167], v189 offset:512
    s_add_u32 m0, s52, 114688
    s_nop 0
    buffer_load_dwordx4 v200, s[20:23], s77 offen lds
    s_waitcnt lgkmcnt(6)
    v_mfma_f32_32x32x16_bf16 v[128:143], v[172:175], v[108:111], v[128:143]
    v_add_u32 v190, 0xfffe0000, v190
    ds_read_b64_tr_b16 v[168:169], v190 offset:0
    ds_read_b64_tr_b16 v[170:171], v190 offset:512
    s_waitcnt lgkmcnt(5)
    v_add_f32 v228, v228, v229
    s_waitcnt lgkmcnt(4)
    v_add_f32 v230, v230, v231
    v_mfma_f32_32x32x16_bf16 v[144:159], v[160:163], v[0:3], 0
    v_mfma_f32_16x16x32_bf16 v[180:183], v[176:179], v[160:163], 0
    v_add_u32 v191, 0xfffe0000, v191
    ds_read_b64_tr_b16 v[172:173], v191 offset:0
    ds_read_b64_tr_b16 v[174:175], v191 offset:512
    s_add_u32 m0, s52, 122880
    s_nop 0
    buffer_load_dwordx4 v201, s[24:27], s77 offen lds
    v_mfma_f32_32x32x2_f32 v[112:127], v228, v208, v[112:127]
    s_waitcnt lgkmcnt(4)
    v_mfma_f32_32x32x16_bf16 v[236:251], v[164:167], v[0:3], 0
    v_mfma_f32_16x16x32_bf16 v[184:187], v[176:179], v[164:167], 0
    v_add_u32 v192, 0xfffe0000, v192
    ds_read_b64_tr_b16 v[160:161], v192 offset:0
    ds_read_b64_tr_b16 v[162:163], v192 offset:512
    v_mfma_f32_32x32x2_f32 v[128:143], v230, v208, v[128:143]
    s_waitcnt lgkmcnt(4)
    v_mfma_f32_32x32x16_bf16 v[144:159], v[168:171], v[4:7], v[144:159]
    v_add_u32 v193, 0xfffe0000, v193
    ds_read_b64_tr_b16 v[164:165], v193 offset:0
    ds_read_b64_tr_b16 v[166:167], v193 offset:512
    s_add_u32 s92, s71, 0
    s_add_u32 m0, s52, 49152
    s_nop 0
    buffer_load_dwordx4 v203, s[28:31], s92 offen lds
    s_lshl_b32 s95, s50, 9
    s_lshl_b32 s94, s47, 5
    s_add_u32 s95, s95, s94
    s_lshl_b32 s94, s44, 2
    s_add_u32 s95, s95, s94
    s_add_u32 s95, s95, 10637312
    v_mov_b32 v255, 1
    s_waitcnt vmcnt(5)
    buffer_store_dword v255, v205, s[40:43], s95 offen sc1
    s_waitcnt lgkmcnt(4)
    v_mfma_f32_32x32x16_bf16 v[236:251], v[172:175], v[4:7], v[236:251]
    v_add_u32 v194, 0xfffe0000, v194
    ds_read_b64_tr_b16 v[168:169], v194 offset:0
    ds_read_b64_tr_b16 v[170:171], v194 offset:512
    s_waitcnt lgkmcnt(4)
    v_mfma_f32_32x32x16_bf16 v[144:159], v[160:163], v[8:11], v[144:159]
    v_add_u32 v195, 0xfffe0000, v195
    ds_read_b64_tr_b16 v[172:173], v195 offset:0
    ds_read_b64_tr_b16 v[174:175], v195 offset:512
    s_add_u32 s93, s71, 114688
    s_add_u32 m0, s52, 57344
    s_nop 0
    buffer_load_dwordx4 v203, s[28:31], s93 offen lds
    s_waitcnt lgkmcnt(4)
    v_mfma_f32_32x32x16_bf16 v[236:251], v[164:167], v[8:11], v[236:251]
    s_barrier
    ds_read_b64_tr_b16 v[160:161], v188 offset:16384
    ds_read_b64_tr_b16 v[162:163], v188 offset:16896
    s_waitcnt lgkmcnt(4)
    v_mfma_f32_32x32x16_bf16 v[144:159], v[168:171], v[12:15], v[144:159]
    ds_read_b64_tr_b16 v[164:165], v189 offset:16384
    ds_read_b64_tr_b16 v[166:167], v189 offset:16896
    v_max_f32 v112, 0, v112
    v_mul_f32 v120, v120, v210
    v_mul_f32 v121, v121, v210
    v_max_f32 v113, 0, v113
    v_max_f32 v114, 0, v114
    v_mul_f32 v122, v122, v210
    v_mul_f32 v123, v123, v210
    v_max_f32 v115, 0, v115
    v_max_f32 v116, 0, v116
    v_mul_f32 v124, v124, v210
    v_mul_f32 v125, v125, v210
    v_max_f32 v117, 0, v117
    s_waitcnt lgkmcnt(4)
    v_mfma_f32_32x32x16_bf16 v[236:251], v[172:175], v[12:15], v[236:251]
    ds_read_b64_tr_b16 v[168:169], v190 offset:16384
    ds_read_b64_tr_b16 v[170:171], v190 offset:16896
    s_add_u32 s92, s72, 0
    s_add_u32 m0, s52, 131072
    s_nop 0
    buffer_load_dwordx4 v203, s[28:31], s92 offen lds
    v_max_f32 v118, 0, v118
    v_mul_f32 v126, v126, v210
    v_mul_f32 v127, v127, v210
    v_max_f32 v119, 0, v119
    v_mul_f32 v112, v112, v120
    v_mul_f32 v113, v113, v121
    v_mul_f32 v114, v114, v122
    v_mul_f32 v115, v115, v123
    v_mul_f32 v116, v116, v124
    v_mul_f32 v117, v117, v125
    v_mul_f32 v118, v118, v126
    v_mul_f32 v119, v119, v127
    s_waitcnt lgkmcnt(4)
    v_mfma_f32_32x32x16_bf16 v[144:159], v[160:163], v[16:19], v[144:159]
    v_mfma_f32_16x16x32_bf16 v[180:183], v[176:179], v[160:163], v[180:183]
    ds_read_b64_tr_b16 v[172:173], v191 offset:16384
    ds_read_b64_tr_b16 v[174:175], v191 offset:16896
    v_cvt_pk_bf16_f32 v112, v112, v113
    v_cvt_pk_bf16_f32 v113, v114, v115
    v_cvt_pk_bf16_f32 v114, v116, v117
    v_cvt_pk_bf16_f32 v115, v118, v119
    s_add_u32 s94, s54, 0
    buffer_store_dwordx4 v[112:115], v204, s[40:43], s94 offen sc1
    v_max_f32 v128, 0, v128
    v_mul_f32 v136, v136, v210
    v_mul_f32 v137, v137, v210
    v_max_f32 v129, 0, v129
    v_max_f32 v130, 0, v130
    v_mul_f32 v138, v138, v210
    v_mul_f32 v139, v139, v210
    s_waitcnt lgkmcnt(4)
    v_mfma_f32_32x32x16_bf16 v[236:251], v[164:167], v[16:19], v[236:251]
    v_mfma_f32_16x16x32_bf16 v[184:187], v[176:179], v[164:167], v[184:187]
    ds_read_b64_tr_b16 v[160:161], v192 offset:16384
    ds_read_b64_tr_b16 v[162:163], v192 offset:16896
    v_max_f32 v131, 0, v131
    v_max_f32 v132, 0, v132
    v_mul_f32 v140, v140, v210
    v_mul_f32 v141, v141, v210
    v_max_f32 v133, 0, v133
    v_max_f32 v134, 0, v134
    v_mul_f32 v142, v142, v210
    v_mul_f32 v143, v143, v210
    v_max_f32 v135, 0, v135
    v_mul_f32 v128, v128, v136
    v_mul_f32 v129, v129, v137
    v_mul_f32 v130, v130, v138
    s_waitcnt lgkmcnt(4)
    v_mfma_f32_32x32x16_bf16 v[144:159], v[168:171], v[20:23], v[144:159]
    ds_read_b64_tr_b16 v[164:165], v193 offset:16384
    ds_read_b64_tr_b16 v[166:167], v193 offset:16896
    v_mul_f32 v131, v131, v139
    v_mul_f32 v132, v132, v140
    v_mul_f32 v133, v133, v141
    v_mul_f32 v134, v134, v142
    v_mul_f32 v135, v135, v143
    v_cvt_pk_bf16_f32 v128, v128, v129
    v_cvt_pk_bf16_f32 v129, v130, v131
    v_cvt_pk_bf16_f32 v130, v132, v133
    v_cvt_pk_bf16_f32 v131, v134, v135
    s_add_u32 s94, s54, 1024
    buffer_store_dwordx4 v[128:131], v204, s[40:43], s94 offen sc1
    v_lshrrev_b32 v220, 7, v204
    v_lshl_add_u32 v220, s44, 3, v220
    s_waitcnt lgkmcnt(4)
    v_mfma_f32_32x32x16_bf16 v[236:251], v[172:175], v[20:23], v[236:251]
    ds_read_b64_tr_b16 v[168:169], v194 offset:16384
    ds_read_b64_tr_b16 v[170:171], v194 offset:16896
    s_add_u32 s93, s72, 114688
    s_add_u32 m0, s52, 139264
    s_nop 0
    buffer_load_dwordx4 v203, s[28:31], s93 offen lds
    v_and_b32 v221, 0x70, v204
    v_mul_u32_u24 v222, 896, v220
    v_add_u32 v222, v222, v221
    s_mul_i32 s96, s62, 57344
    s_lshl_b32 s97, s49, 7
    s_add_u32 s96, s96, s97
    buffer_load_dwordx4 v[224:227], v222, s[4:7], s96 offen
    s_lshr_b32 s94, s45, 1
    s_lshl_b32 s94, s94, 3
    s_and_b32 s95, s45, 1
    s_add_u32 s94, s94, s95
    s_lshl_b32 s94, s94, 11
    s_add_u32 s57, s57, s94
    s_add_u32 s57, s57, 114688
    s_waitcnt lgkmcnt(4)
    v_mfma_f32_32x32x16_bf16 v[144:159], v[160:163], v[24:27], v[144:159]
    ds_read_b64_tr_b16 v[172:173], v195 offset:16384
    ds_read_b64_tr_b16 v[174:175], v195 offset:16896
    s_waitcnt lgkmcnt(4)
    v_mfma_f32_32x32x16_bf16 v[236:251], v[164:167], v[24:27], v[236:251]
    s_barrier
    ds_read_b64_tr_b16 v[160:161], v188 offset:32768
    ds_read_b64_tr_b16 v[162:163], v188 offset:33280
    s_waitcnt lgkmcnt(4)
    v_mfma_f32_32x32x16_bf16 v[144:159], v[168:171], v[28:31], v[144:159]
    ds_read_b64_tr_b16 v[164:165], v189 offset:32768
    ds_read_b64_tr_b16 v[166:167], v189 offset:33280
    s_waitcnt lgkmcnt(4)
    v_mfma_f32_32x32x16_bf16 v[236:251], v[172:175], v[28:31], v[236:251]
    ds_read_b64_tr_b16 v[168:169], v190 offset:32768
    ds_read_b64_tr_b16 v[170:171], v190 offset:33280
    s_add_u32 s92, s73, 0
    s_add_u32 m0, s52, 0
    s_nop 0
    buffer_load_dwordx4 v203, s[28:31], s92 offen lds
    s_waitcnt lgkmcnt(4)
    v_mfma_f32_32x32x16_bf16 v[144:159], v[160:163], v[32:35], v[144:159]
    v_mfma_f32_16x16x32_bf16 v[180:183], v[176:179], v[160:163], v[180:183]
    ds_read_b64_tr_b16 v[172:173], v191 offset:32768
    ds_read_b64_tr_b16 v[174:175], v191 offset:33280
    s_waitcnt lgkmcnt(4)
    v_mfma_f32_32x32x16_bf16 v[236:251], v[164:167], v[32:35], v[236:251]
    v_mfma_f32_16x16x32_bf16 v[184:187], v[176:179], v[164:167], v[184:187]
    ds_read_b64_tr_b16 v[160:161], v192 offset:32768
    ds_read_b64_tr_b16 v[162:163], v192 offset:33280
    s_waitcnt lgkmcnt(4)
    v_mfma_f32_32x32x16_bf16 v[144:159], v[168:171], v[36:39], v[144:159]
    ds_read_b64_tr_b16 v[164:165], v193 offset:32768
    ds_read_b64_tr_b16 v[166:167], v193 offset:33280
    s_waitcnt lgkmcnt(4)
    v_mfma_f32_32x32x16_bf16 v[236:251], v[172:175], v[36:39], v[236:251]
    ds_read_b64_tr_b16 v[168:169], v194 offset:32768
    ds_read_b64_tr_b16 v[170:171], v194 offset:33280
    s_add_u32 s93, s73, 114688
    s_add_u32 m0, s52, 8192
    s_nop 0
    buffer_load_dwordx4 v203, s[28:31], s93 offen lds
    s_waitcnt lgkmcnt(4)
    v_mfma_f32_32x32x16_bf16 v[144:159], v[160:163], v[40:43], v[144:159]
    ds_read_b64_tr_b16 v[172:173], v195 offset:32768
    ds_read_b64_tr_b16 v[174:175], v195 offset:33280
    s_waitcnt lgkmcnt(4)
    v_mfma_f32_32x32x16_bf16 v[236:251], v[164:167], v[40:43], v[236:251]
    s_barrier
    v_add_u32 v188, 0x10000, v188
    ds_read_b64_tr_b16 v[160:161], v188 offset:0
    ds_read_b64_tr_b16 v[162:163], v188 offset:512
    s_add_u32 s95, s55, 0
    v_mov_b32 v255, 1
    s_waitcnt vmcnt(4)
    buffer_store_dword v255, v205, s[40:43], s95 offen sc1
    s_waitcnt lgkmcnt(4)
    v_mfma_f32_32x32x16_bf16 v[144:159], v[168:171], v[44:47], v[144:159]
    v_add_u32 v189, 0x10000, v189
    ds_read_b64_tr_b16 v[164:165], v189 offset:0
    ds_read_b64_tr_b16 v[166:167], v189 offset:512
    s_waitcnt lgkmcnt(4)
    v_mfma_f32_32x32x16_bf16 v[236:251], v[172:175], v[44:47], v[236:251]
    v_add_u32 v190, 0x10000, v190
    ds_read_b64_tr_b16 v[168:169], v190 offset:0
    ds_read_b64_tr_b16 v[170:171], v190 offset:512
    s_add_u32 s92, s74, 0
    s_add_u32 m0, s52, 16384
    s_nop 0
    buffer_load_dwordx4 v203, s[28:31], s92 offen lds
    s_waitcnt lgkmcnt(4)
    v_mfma_f32_32x32x16_bf16 v[144:159], v[160:163], v[48:51], v[144:159]
    v_mfma_f32_16x16x32_bf16 v[180:183], v[176:179], v[160:163], v[180:183]
    v_add_u32 v191, 0x10000, v191
    ds_read_b64_tr_b16 v[172:173], v191 offset:0
    ds_read_b64_tr_b16 v[174:175], v191 offset:512
    s_waitcnt lgkmcnt(4)
    v_mfma_f32_32x32x16_bf16 v[236:251], v[164:167], v[48:51], v[236:251]
    v_mfma_f32_16x16x32_bf16 v[184:187], v[176:179], v[164:167], v[184:187]
    v_add_u32 v192, 0x10000, v192
    ds_read_b64_tr_b16 v[160:161], v192 offset:0
    ds_read_b64_tr_b16 v[162:163], v192 offset:512
    s_waitcnt lgkmcnt(4)
    v_mfma_f32_32x32x16_bf16 v[144:159], v[168:171], v[52:55], v[144:159]
    v_add_u32 v193, 0x10000, v193
    ds_read_b64_tr_b16 v[164:165], v193 offset:0
    ds_read_b64_tr_b16 v[166:167], v193 offset:512
    s_waitcnt lgkmcnt(4)
    v_mfma_f32_32x32x16_bf16 v[236:251], v[172:175], v[52:55], v[236:251]
    v_add_u32 v194, 0x10000, v194
    ds_read_b64_tr_b16 v[168:169], v194 offset:0
    ds_read_b64_tr_b16 v[170:171], v194 offset:512
    s_add_u32 s93, s74, 114688
    s_add_u32 m0, s52, 24576
    s_nop 0
    buffer_load_dwordx4 v203, s[28:31], s93 offen lds
    s_waitcnt lgkmcnt(4)
    v_mfma_f32_32x32x16_bf16 v[144:159], v[160:163], v[56:59], v[144:159]
    v_add_u32 v195, 0x10000, v195
    ds_read_b64_tr_b16 v[172:173], v195 offset:0
    ds_read_b64_tr_b16 v[174:175], v195 offset:512
    s_waitcnt lgkmcnt(4)
    v_mfma_f32_32x32x16_bf16 v[236:251], v[164:167], v[56:59], v[236:251]
    s_barrier
    ds_read_b64_tr_b16 v[160:161], v188 offset:16384
    ds_read_b64_tr_b16 v[162:163], v188 offset:16896
    s_waitcnt lgkmcnt(4)
    v_mfma_f32_32x32x16_bf16 v[144:159], v[168:171], v[60:63], v[144:159]
    ds_read_b64_tr_b16 v[164:165], v189 offset:16384
    ds_read_b64_tr_b16 v[166:167], v189 offset:16896
    s_waitcnt lgkmcnt(4)
    v_mfma_f32_32x32x16_bf16 v[236:251], v[172:175], v[60:63], v[236:251]
    ds_read_b64_tr_b16 v[168:169], v190 offset:16384
    ds_read_b64_tr_b16 v[170:171], v190 offset:16896
    s_add_u32 s92, s75, 0
    s_add_u32 m0, s52, 32768
    s_nop 0
    buffer_load_dwordx4 v203, s[28:31], s92 offen lds
    s_waitcnt lgkmcnt(4)
    v_mfma_f32_32x32x16_bf16 v[144:159], v[160:163], v[64:67], v[144:159]
    v_mfma_f32_16x16x32_bf16 v[180:183], v[176:179], v[160:163], v[180:183]
    ds_read_b64_tr_b16 v[172:173], v191 offset:16384
    ds_read_b64_tr_b16 v[174:175], v191 offset:16896
    s_waitcnt lgkmcnt(4)
    v_mfma_f32_32x32x16_bf16 v[236:251], v[164:167], v[64:67], v[236:251]
    v_mfma_f32_16x16x32_bf16 v[184:187], v[176:179], v[164:167], v[184:187]
    ds_read_b64_tr_b16 v[160:161], v192 offset:16384
    ds_read_b64_tr_b16 v[162:163], v192 offset:16896
    s_waitcnt lgkmcnt(4)
    v_mfma_f32_32x32x16_bf16 v[144:159], v[168:171], v[68:71], v[144:159]
    ds_read_b64_tr_b16 v[164:165], v193 offset:16384
    ds_read_b64_tr_b16 v[166:167], v193 offset:16896
    s_waitcnt lgkmcnt(4)
    v_mfma_f32_32x32x16_bf16 v[236:251], v[172:175], v[68:71], v[236:251]
    ds_read_b64_tr_b16 v[168:169], v194 offset:16384
    ds_read_b64_tr_b16 v[170:171], v194 offset:16896
    s_add_u32 s93, s75, 114688
    s_add_u32 m0, s52, 40960
    s_nop 0
    buffer_load_dwordx4 v203, s[28:31], s93 offen lds
    s_waitcnt lgkmcnt(4)
    v_mfma_f32_32x32x16_bf16 v[144:159], v[160:163], v[72:75], v[144:159]
    ds_read_b64_tr_b16 v[172:173], v195 offset:16384
    ds_read_b64_tr_b16 v[174:175], v195 offset:16896
    s_waitcnt lgkmcnt(4)
    v_mfma_f32_32x32x16_bf16 v[236:251], v[164:167], v[72:75], v[236:251]
    s_barrier
    ds_read_b64_tr_b16 v[160:161], v188 offset:32768
    ds_read_b64_tr_b16 v[162:163], v188 offset:33280
    s_waitcnt lgkmcnt(4)
    v_mfma_f32_32x32x16_bf16 v[144:159], v[168:171], v[76:79], v[144:159]
    ds_read_b64_tr_b16 v[164:165], v189 offset:32768
    ds_read_b64_tr_b16 v[166:167], v189 offset:33280
    s_waitcnt lgkmcnt(4)
    v_mfma_f32_32x32x16_bf16 v[236:251], v[172:175], v[76:79], v[236:251]
    ds_read_b64_tr_b16 v[168:169], v190 offset:32768
    ds_read_b64_tr_b16 v[170:171], v190 offset:33280
    s_add_u32 s92, s76, 0
    s_add_u32 m0, s52, 65536
    s_nop 0
    buffer_load_dwordx4 v203, s[28:31], s92 offen lds
    s_waitcnt lgkmcnt(4)
    v_mfma_f32_32x32x16_bf16 v[144:159], v[160:163], v[80:83], v[144:159]
    v_mfma_f32_16x16x32_bf16 v[180:183], v[176:179], v[160:163], v[180:183]
    ds_read_b64_tr_b16 v[172:173], v191 offset:32768
    ds_read_b64_tr_b16 v[174:175], v191 offset:33280
    s_waitcnt lgkmcnt(4)
    v_mfma_f32_32x32x16_bf16 v[236:251], v[164:167], v[80:83], v[236:251]
    v_mfma_f32_16x16x32_bf16 v[184:187], v[176:179], v[164:167], v[184:187]
    ds_read_b64_tr_b16 v[160:161], v192 offset:32768
    ds_read_b64_tr_b16 v[162:163], v192 offset:33280
    s_waitcnt lgkmcnt(4)
    v_mfma_f32_32x32x16_bf16 v[144:159], v[168:171], v[84:87], v[144:159]
    ds_read_b64_tr_b16 v[164:165], v193 offset:32768
    ds_read_b64_tr_b16 v[166:167], v193 offset:33280
    s_waitcnt lgkmcnt(4)
    v_mfma_f32_32x32x16_bf16 v[236:251], v[172:175], v[84:87], v[236:251]
    ds_read_b64_tr_b16 v[168:169], v194 offset:32768
    ds_read_b64_tr_b16 v[170:171], v194 offset:33280
    s_add_u32 s93, s76, 114688
    s_add_u32 m0, s52, 73728
    s_nop 0
    buffer_load_dwordx4 v203, s[28:31], s93 offen lds
    s_waitcnt lgkmcnt(4)
    v_mfma_f32_32x32x16_bf16 v[144:159], v[160:163], v[88:91], v[144:159]
    ds_read_b64_tr_b16 v[172:173], v195 offset:32768
    ds_read_b64_tr_b16 v[174:175], v195 offset:33280
    s_waitcnt lgkmcnt(4)
    v_mfma_f32_32x32x16_bf16 v[236:251], v[164:167], v[88:91], v[236:251]
    s_barrier
    ds_read_b64_tr_b16 v[160:161], v188 offset:49152
    ds_read_b64_tr_b16 v[162:163], v188 offset:49664
    s_add_u32 s94, s85, 0
    buffer_load_dwordx4 v[0:3], v204, s[40:43], s94 offen
    s_waitcnt lgkmcnt(4)
    v_mfma_f32_32x32x16_bf16 v[144:159], v[168:171], v[92:95], v[144:159]
    ds_read_b64_tr_b16 v[164:165], v189 offset:49152
    ds_read_b64_tr_b16 v[166:167], v189 offset:49664
    s_add_u32 s94, s85, 8192
    buffer_load_dwordx4 v[4:7], v204, s[40:43], s94 offen
    s_waitcnt lgkmcnt(4)
    v_mfma_f32_32x32x16_bf16 v[236:251], v[172:175], v[92:95], v[236:251]
    ds_read_b64_tr_b16 v[168:169], v190 offset:49152
    ds_read_b64_tr_b16 v[170:171], v190 offset:49664
    s_add_u32 s92, s77, 0
    s_add_u32 m0, s52, 81920
    s_nop 0
    buffer_load_dwordx4 v203, s[28:31], s92 offen lds
    s_add_u32 s94, s86, 0
    buffer_load_dwordx4 v[8:11], v204, s[40:43], s94 offen
    s_waitcnt lgkmcnt(4)
    v_mfma_f32_32x32x16_bf16 v[144:159], v[160:163], v[96:99], v[144:159]
    v_mfma_f32_16x16x32_bf16 v[180:183], v[176:179], v[160:163], v[180:183]
    ds_read_b64_tr_b16 v[172:173], v191 offset:49152
    ds_read_b64_tr_b16 v[174:175], v191 offset:49664
    s_add_u32 s94, s86, 8192
    buffer_load_dwordx4 v[12:15], v204, s[40:43], s94 offen
    s_waitcnt lgkmcnt(4)
    v_mfma_f32_32x32x16_bf16 v[236:251], v[164:167], v[96:99], v[236:251]
    v_mfma_f32_16x16x32_bf16 v[184:187], v[176:179], v[164:167], v[184:187]
    ds_read_b64_tr_b16 v[160:161], v192 offset:49152
    ds_read_b64_tr_b16 v[162:163], v192 offset:49664
    s_add_u32 s94, s87, 0
    buffer_load_dwordx4 v[16:19], v204, s[40:43], s94 offen
    s_waitcnt lgkmcnt(4)
    v_mfma_f32_32x32x16_bf16 v[144:159], v[168:171], v[100:103], v[144:159]
    ds_read_b64_tr_b16 v[164:165], v193 offset:49152
    ds_read_b64_tr_b16 v[166:167], v193 offset:49664
    s_add_u32 s94, s87, 8192
    buffer_load_dwordx4 v[20:23], v204, s[40:43], s94 offen
    s_waitcnt lgkmcnt(4)
    v_mfma_f32_32x32x16_bf16 v[236:251], v[172:175], v[100:103], v[236:251]
    ds_read_b64_tr_b16 v[168:169], v194 offset:49152
    ds_read_b64_tr_b16 v[170:171], v194 offset:49664
    s_add_u32 s93, s77, 114688
    s_add_u32 m0, s52, 90112
    s_nop 0
    buffer_load_dwordx4 v203, s[28:31], s93 offen lds
    s_waitcnt lgkmcnt(4)
    v_mfma_f32_32x32x16_bf16 v[144:159], v[160:163], v[104:107], v[144:159]
    ds_read_b64_tr_b16 v[172:173], v195 offset:49152
    ds_read_b64_tr_b16 v[174:175], v195 offset:49664
    s_waitcnt lgkmcnt(4)
    v_mfma_f32_32x32x16_bf16 v[236:251], v[164:167], v[104:107], v[236:251]
    ds_write_b32 v206, v180 offset:0
    ds_write_b32 v206, v184 offset:512
    s_waitcnt vmcnt(18) lgkmcnt(0)
    s_barrier
    ds_read_b64_tr_b16 v[160:161], v216 offset:49152
    ds_read_b64_tr_b16 v[162:163], v216 offset:50176
    ds_read_b64 v[228:229], v207 offset:0
    ds_read_b64 v[230:231], v207 offset:512
    v_mfma_f32_32x32x16_bf16 v[144:159], v[168:171], v[108:111], v[144:159]
    ds_read_b64_tr_b16 v[164:165], v217 offset:49152
    ds_read_b64_tr_b16 v[166:167], v217 offset:50176
    v_mfma_f32_32x32x16_bf16 v[236:251], v[172:175], v[108:111], v[236:251]
    ds_read_b64_tr_b16 v[168:169], v216 offset:57344
    ds_read_b64_tr_b16 v[170:171], v216 offset:58368
    s_add_u32 s92, s71, 57344
    s_add_u32 m0, s52, 98304
    s_nop 0
    buffer_load_dwordx4 v203, s[28:31], s92 offen lds
    s_waitcnt lgkmcnt(5)
    v_add_f32 v228, v228, v229
    s_waitcnt lgkmcnt(4)
    v_add_f32 v230, v230, v231
    v_mfma_f32_32x32x2_f32 v[144:159], v228, v208, v[144:159]
    s_nop 0
    v_mfma_f32_32x32x2_f32 v[236:251], v230, v208, v[236:251]
    s_nop 15
    s_nop 1
    v_max_f32 v144, 0, v144
    v_mul_f32 v152, v152, v210
    v_mul_f32 v153, v153, v210
    v_max_f32 v145, 0, v145
    v_max_f32 v146, 0, v146
    v_mul_f32 v154, v154, v210
    v_mul_f32 v155, v155, v210
    v_max_f32 v147, 0, v147
    v_max_f32 v148, 0, v148
    v_mul_f32 v156, v156, v210
    v_mul_f32 v157, v157, v210
    v_max_f32 v149, 0, v149
    v_max_f32 v150, 0, v150
    v_mul_f32 v158, v158, v210
    v_mul_f32 v159, v159, v210
    v_max_f32 v151, 0, v151
    v_mul_f32 v144, v144, v152
    v_mul_f32 v145, v145, v153
    v_mul_f32 v146, v146, v154
    v_mul_f32 v147, v147, v155
    v_mul_f32 v148, v148, v156
    v_mul_f32 v149, v149, v157
    v_mul_f32 v150, v150, v158
    v_mul_f32 v151, v151, v159
    v_cvt_pk_bf16_f32 v144, v144, v145
    v_cvt_pk_bf16_f32 v145, v146, v147
    v_cvt_pk_bf16_f32 v146, v148, v149
    v_cvt_pk_bf16_f32 v147, v150, v151
    s_add_u32 s94, s54, 4096
    buffer_store_dwordx4 v[144:147], v204, s[40:43], s94 offen sc1
    v_max_f32 v236, 0, v236
    v_mul_f32 v244, v244, v210
    v_mul_f32 v245, v245, v210
    v_max_f32 v237, 0, v237
    v_max_f32 v238, 0, v238
    v_mul_f32 v246, v246, v210
    v_mul_f32 v247, v247, v210
    v_max_f32 v239, 0, v239
    v_max_f32 v240, 0, v240
    v_mul_f32 v248, v248, v210
    v_mul_f32 v249, v249, v210
    v_max_f32 v241, 0, v241
    v_max_f32 v242, 0, v242
    v_mul_f32 v250, v250, v210
    v_mul_f32 v251, v251, v210
    v_max_f32 v243, 0, v243
    v_mul_f32 v236, v236, v244
    v_mul_f32 v237, v237, v245
    v_mul_f32 v238, v238, v246
    v_mul_f32 v239, v239, v247
    v_mul_f32 v240, v240, v248
    v_mul_f32 v241, v241, v249
    v_mul_f32 v242, v242, v250
    v_mul_f32 v243, v243, v251
    v_cvt_pk_bf16_f32 v236, v236, v237
    v_cvt_pk_bf16_f32 v237, v238, v239
    v_cvt_pk_bf16_f32 v238, v240, v241
    v_cvt_pk_bf16_f32 v239, v242, v243
    s_add_u32 s94, s54, 5120
    buffer_store_dwordx4 v[236:239], v204, s[40:43], s94 offen sc1
    s_waitcnt vmcnt(10)
    v_mfma_f32_32x32x16_bf16 v[112:127], v[160:163], v[0:3], 0
    ds_read_b64_tr_b16 v[172:173], v217 offset:57344
    ds_read_b64_tr_b16 v[174:175], v217 offset:58368
    s_waitcnt lgkmcnt(4)
    v_mfma_f32_32x32x16_bf16 v[128:143], v[164:167], v[0:3], 0
    v_add_u32 v216, 0x20000, v216
    ds_read_b64_tr_b16 v[160:161], v216 offset:0
    ds_read_b64_tr_b16 v[162:163], v216 offset:1024
    s_waitcnt vmcnt(9) lgkmcnt(4)
    v_mfma_f32_32x32x16_bf16 v[112:127], v[168:171], v[4:7], v[112:127]
    v_add_u32 v217, 0x20000, v217
    ds_read_b64_tr_b16 v[164:165], v217 offset:0
    ds_read_b64_tr_b16 v[166:167], v217 offset:1024
    s_add_u32 s95, s55, 8192
    v_mov_b32 v255, 1
    s_waitcnt vmcnt(0)
    buffer_store_dword v255, v205, s[40:43], s95 offen sc1
    s_add_u32 s94, s88, 0
    buffer_load_dwordx4 v[24:27], v204, s[40:43], s94 offen
    s_waitcnt lgkmcnt(4)
    v_mfma_f32_32x32x16_bf16 v[128:143], v[172:175], v[4:7], v[128:143]
    ds_read_b64_tr_b16 v[168:169], v216 offset:8192
    ds_read_b64_tr_b16 v[170:171], v216 offset:9216
    s_add_u32 s93, s71, 172032
    s_add_u32 m0, s52, 106496
    s_nop 0
    buffer_load_dwordx4 v203, s[28:31], s93 offen lds
    s_add_u32 s94, s88, 8192
    buffer_load_dwordx4 v[28:31], v204, s[40:43], s94 offen
    s_waitcnt lgkmcnt(4)
    v_mfma_f32_32x32x16_bf16 v[112:127], v[160:163], v[8:11], v[112:127]
    ds_read_b64_tr_b16 v[172:173], v217 offset:8192
    ds_read_b64_tr_b16 v[174:175], v217 offset:9216
    s_add_u32 s94, s89, 0
    buffer_load_dwordx4 v[32:35], v204, s[40:43], s94 offen
    s_waitcnt lgkmcnt(4)
    v_mfma_f32_32x32x16_bf16 v[128:143], v[164:167], v[8:11], v[128:143]
    s_barrier
    v_add_u32 v216, 0xfffe0000, v216
    ds_read_b64_tr_b16 v[160:161], v216 offset:0
    ds_read_b64_tr_b16 v[162:163], v216 offset:1024
    s_add_u32 s94, s89, 8192
    buffer_load_dwordx4 v[36:39], v204, s[40:43], s94 offen
    s_waitcnt lgkmcnt(4)
    v_mfma_f32_32x32x16_bf16 v[112:127], v[168:171], v[12:15], v[112:127]
    v_add_u32 v217, 0xfffe0000, v217
    ds_read_b64_tr_b16 v[164:165], v217 offset:0
    ds_read_b64_tr_b16 v[166:167], v217 offset:1024
    s_add_u32 s94, s90, 0
    buffer_load_dwordx4 v[40:43], v204, s[40:43], s94 offen
    s_waitcnt lgkmcnt(4)
    v_mfma_f32_32x32x16_bf16 v[128:143], v[172:175], v[12:15], v[128:143]
    ds_read_b64_tr_b16 v[168:169], v216 offset:8192
    ds_read_b64_tr_b16 v[170:171], v216 offset:9216
    s_add_u32 s92, s72, 57344
    s_add_u32 m0, s52, 114688
    s_nop 0
    buffer_load_dwordx4 v203, s[28:31], s92 offen lds
    s_add_u32 s94, s90, 8192
    buffer_load_dwordx4 v[44:47], v204, s[40:43], s94 offen
    s_waitcnt lgkmcnt(4)
    v_mfma_f32_32x32x16_bf16 v[112:127], v[160:163], v[16:19], v[112:127]
    ds_read_b64_tr_b16 v[172:173], v217 offset:8192
    ds_read_b64_tr_b16 v[174:175], v217 offset:9216
    s_add_u32 s94, s91, 0
    buffer_load_dwordx4 v[48:51], v204, s[40:43], s94 offen
    s_waitcnt lgkmcnt(4)
    v_mfma_f32_32x32x16_bf16 v[128:143], v[164:167], v[16:19], v[128:143]
    ds_read_b64_tr_b16 v[160:161], v216 offset:16384
    ds_read_b64_tr_b16 v[162:163], v216 offset:17408
    s_add_u32 s94, s91, 8192
    buffer_load_dwordx4 v[52:55], v204, s[40:43], s94 offen
    s_waitcnt lgkmcnt(4)
    v_mfma_f32_32x32x16_bf16 v[112:127], v[168:171], v[20:23], v[112:127]
    ds_read_b64_tr_b16 v[164:165], v217 offset:16384
    ds_read_b64_tr_b16 v[166:167], v217 offset:17408
    s_waitcnt lgkmcnt(4)
    v_mfma_f32_32x32x16_bf16 v[128:143], v[172:175], v[20:23], v[128:143]
    ds_read_b64_tr_b16 v[168:169], v216 offset:24576
    ds_read_b64_tr_b16 v[170:171], v216 offset:25600
    s_add_u32 s93, s72, 172032
    s_add_u32 m0, s52, 122880
    s_nop 0
    buffer_load_dwordx4 v203, s[28:31], s93 offen lds
    s_waitcnt vmcnt(10) lgkmcnt(4)
    v_mfma_f32_32x32x16_bf16 v[112:127], v[160:163], v[24:27], v[112:127]
    ds_read_b64_tr_b16 v[172:173], v217 offset:24576
    ds_read_b64_tr_b16 v[174:175], v217 offset:25600
    s_waitcnt lgkmcnt(4)
    v_mfma_f32_32x32x16_bf16 v[128:143], v[164:167], v[24:27], v[128:143]
    s_barrier
    ds_read_b64_tr_b16 v[160:161], v216 offset:32768
    ds_read_b64_tr_b16 v[162:163], v216 offset:33792
    s_waitcnt vmcnt(8) lgkmcnt(4)
    v_mfma_f32_32x32x16_bf16 v[112:127], v[168:171], v[28:31], v[112:127]
    ds_read_b64_tr_b16 v[164:165], v217 offset:32768
    ds_read_b64_tr_b16 v[166:167], v217 offset:33792
    s_add_u32 s92, s73, 57344
    s_add_u32 m0, s52, 49152
    s_nop 0
    buffer_load_dwordx4 v203, s[28:31], s92 offen lds
    s_waitcnt lgkmcnt(4)
    v_mfma_f32_32x32x16_bf16 v[128:143], v[172:175], v[28:31], v[128:143]
    ds_read_b64_tr_b16 v[168:169], v216 offset:40960
    ds_read_b64_tr_b16 v[170:171], v216 offset:41984
    s_waitcnt vmcnt(8) lgkmcnt(4)
    v_mfma_f32_32x32x16_bf16 v[112:127], v[160:163], v[32:35], v[112:127]
    ds_read_b64_tr_b16 v[172:173], v217 offset:40960
    ds_read_b64_tr_b16 v[174:175], v217 offset:41984
    s_add_u32 s93, s73, 172032
    s_add_u32 m0, s52, 57344
    s_nop 0
    buffer_load_dwordx4 v203, s[28:31], s93 offen lds
    s_waitcnt lgkmcnt(4)
    v_mfma_f32_32x32x16_bf16 v[128:143], v[164:167], v[32:35], v[128:143]
    v_add_u32 v216, 0x10000, v216
    ds_read_b64_tr_b16 v[160:161], v216 offset:0
    ds_read_b64_tr_b16 v[162:163], v216 offset:1024
    s_waitcnt vmcnt(8) lgkmcnt(4)
    v_mfma_f32_32x32x16_bf16 v[112:127], v[168:171], v[36:39], v[112:127]
    v_add_u32 v217, 0x10000, v217
    ds_read_b64_tr_b16 v[164:165], v217 offset:0
    ds_read_b64_tr_b16 v[166:167], v217 offset:1024
    s_add_u32 s92, s74, 57344
    s_add_u32 m0, s52, 131072
    s_nop 0
    buffer_load_dwordx4 v203, s[28:31], s92 offen lds
    s_waitcnt lgkmcnt(4)
    v_mfma_f32_32x32x16_bf16 v[128:143], v[172:175], v[36:39], v[128:143]
    ds_read_b64_tr_b16 v[168:169], v216 offset:8192
    ds_read_b64_tr_b16 v[170:171], v216 offset:9216
    s_waitcnt vmcnt(8) lgkmcnt(4)
    v_mfma_f32_32x32x16_bf16 v[112:127], v[160:163], v[40:43], v[112:127]
    ds_read_b64_tr_b16 v[172:173], v217 offset:8192
    ds_read_b64_tr_b16 v[174:175], v217 offset:9216
    s_add_u32 s93, s74, 172032
    s_add_u32 m0, s52, 139264
    s_nop 0
    buffer_load_dwordx4 v203, s[28:31], s93 offen lds
    s_waitcnt lgkmcnt(4)
    v_mfma_f32_32x32x16_bf16 v[128:143], v[164:167], v[40:43], v[128:143]
    s_barrier
    ds_read_b64_tr_b16 v[160:161], v216 offset:16384
    ds_read_b64_tr_b16 v[162:163], v216 offset:17408
    s_add_u32 s94, s85, 4096
    buffer_load_dwordx4 v[56:59], v204, s[40:43], s94 offen
    s_add_u32 s94, s85, 12288
    buffer_load_dwordx4 v[60:63], v204, s[40:43], s94 offen
    s_add_u32 s94, s86, 4096
    buffer_load_dwordx4 v[64:67], v204, s[40:43], s94 offen
    s_add_u32 s94, s86, 12288
    buffer_load_dwordx4 v[68:71], v204, s[40:43], s94 offen
    s_add_u32 s94, s87, 4096
    buffer_load_dwordx4 v[72:75], v204, s[40:43], s94 offen
    s_add_u32 s94, s87, 12288
    buffer_load_dwordx4 v[76:79], v204, s[40:43], s94 offen
    s_add_u32 s94, s88, 4096
    buffer_load_dwordx4 v[80:83], v204, s[40:43], s94 offen
    s_add_u32 s94, s88, 12288
    buffer_load_dwordx4 v[84:87], v204, s[40:43], s94 offen
    s_add_u32 s94, s89, 4096
    buffer_load_dwordx4 v[88:91], v204, s[40:43], s94 offen
    s_add_u32 s94, s89, 12288
    buffer_load_dwordx4 v[92:95], v204, s[40:43], s94 offen
    s_add_u32 s94, s90, 4096
    buffer_load_dwordx4 v[96:99], v204, s[40:43], s94 offen
    s_add_u32 s94, s90, 12288
    buffer_load_dwordx4 v[100:103], v204, s[40:43], s94 offen
    s_add_u32 s94, s91, 4096
    buffer_load_dwordx4 v[104:107], v204, s[40:43], s94 offen
    s_add_u32 s94, s91, 12288
    s_waitcnt vmcnt(20) lgkmcnt(4)
    v_mfma_f32_32x32x16_bf16 v[112:127], v[168:171], v[44:47], v[112:127]
    ds_read_b64_tr_b16 v[164:165], v217 offset:16384
    ds_read_b64_tr_b16 v[166:167], v217 offset:17408
    s_add_u32 s92, s75, 57344
    s_add_u32 m0, s52, 0
    s_nop 0
    buffer_load_dwordx4 v203, s[28:31], s92 offen lds
    buffer_load_dwordx4 v[108:111], v204, s[40:43], s94 offen
    s_waitcnt lgkmcnt(4)
    v_mfma_f32_32x32x16_bf16 v[128:143], v[172:175], v[44:47], v[128:143]
    ds_read_b64_tr_b16 v[168:169], v216 offset:24576
    ds_read_b64_tr_b16 v[170:171], v216 offset:25600
    s_waitcnt vmcnt(21) lgkmcnt(4)
    v_mfma_f32_32x32x16_bf16 v[112:127], v[160:163], v[48:51], v[112:127]
    ds_read_b64_tr_b16 v[172:173], v217 offset:24576
    ds_read_b64_tr_b16 v[174:175], v217 offset:25600
    s_add_u32 s93, s75, 172032
    s_add_u32 m0, s52, 8192
    s_nop 0
    buffer_load_dwordx4 v203, s[28:31], s93 offen lds
    s_waitcnt lgkmcnt(4)
    v_mfma_f32_32x32x16_bf16 v[128:143], v[164:167], v[48:51], v[128:143]
    ds_read_b64_tr_b16 v[160:161], v216 offset:32768
    ds_read_b64_tr_b16 v[162:163], v216 offset:33792
    s_waitcnt vmcnt(21) lgkmcnt(4)
    v_mfma_f32_32x32x16_bf16 v[112:127], v[168:171], v[52:55], v[112:127]
    ds_read_b64_tr_b16 v[164:165], v217 offset:32768
    ds_read_b64_tr_b16 v[166:167], v217 offset:33792
    s_add_u32 s92, s76, 57344
    s_add_u32 m0, s52, 16384
    s_nop 0
    buffer_load_dwordx4 v203, s[28:31], s92 offen lds
    s_waitcnt lgkmcnt(4)
    v_mfma_f32_32x32x16_bf16 v[128:143], v[172:175], v[52:55], v[128:143]
    ds_read_b64_tr_b16 v[168:169], v216 offset:40960
    ds_read_b64_tr_b16 v[170:171], v216 offset:41984
    s_waitcnt vmcnt(16) lgkmcnt(4)
    v_mfma_f32_32x32x16_bf16 v[112:127], v[160:163], v[56:59], v[112:127]
    ds_read_b64_tr_b16 v[172:173], v217 offset:40960
    ds_read_b64_tr_b16 v[174:175], v217 offset:41984
    s_add_u32 s93, s76, 172032
    s_add_u32 m0, s52, 24576
    s_nop 0
    buffer_load_dwordx4 v203, s[28:31], s93 offen lds
    s_waitcnt lgkmcnt(4)
    v_mfma_f32_32x32x16_bf16 v[128:143], v[164:167], v[56:59], v[128:143]
    s_barrier
    ds_read_b64_tr_b16 v[160:161], v216 offset:49152
    ds_read_b64_tr_b16 v[162:163], v216 offset:50176
    s_waitcnt vmcnt(16) lgkmcnt(4)
    v_mfma_f32_32x32x16_bf16 v[112:127], v[168:171], v[60:63], v[112:127]
    ds_read_b64_tr_b16 v[164:165], v217 offset:49152
    ds_read_b64_tr_b16 v[166:167], v217 offset:50176
    s_add_u32 s92, s77, 57344
    s_add_u32 m0, s52, 32768
    s_nop 0
    buffer_load_dwordx4 v203, s[28:31], s92 offen lds
    s_waitcnt lgkmcnt(4)
    v_mfma_f32_32x32x16_bf16 v[128:143], v[172:175], v[60:63], v[128:143]
    ds_read_b64_tr_b16 v[168:169], v216 offset:57344
    ds_read_b64_tr_b16 v[170:171], v216 offset:58368
    s_waitcnt vmcnt(16) lgkmcnt(4)
    v_mfma_f32_32x32x16_bf16 v[112:127], v[160:163], v[64:67], v[112:127]
    ds_read_b64_tr_b16 v[172:173], v217 offset:57344
    ds_read_b64_tr_b16 v[174:175], v217 offset:58368
    s_add_u32 s93, s77, 172032
    s_add_u32 m0, s52, 40960
    s_nop 0
    buffer_load_dwordx4 v203, s[28:31], s93 offen lds
    s_waitcnt lgkmcnt(4)
    v_mfma_f32_32x32x16_bf16 v[128:143], v[164:167], v[64:67], v[128:143]
    v_add_u32 v216, 0xffff0000, v216
    ds_read_b64_tr_b16 v[160:161], v216 offset:49152
    ds_read_b64_tr_b16 v[162:163], v216 offset:50176
    s_waitcnt vmcnt(16) lgkmcnt(4)
    v_mfma_f32_32x32x16_bf16 v[112:127], v[168:171], v[68:71], v[112:127]
    v_add_u32 v217, 0xffff0000, v217
    ds_read_b64_tr_b16 v[164:165], v217 offset:49152
    ds_read_b64_tr_b16 v[166:167], v217 offset:50176
    s_add_u32 s92, s58, 0
    s_add_u32 m0, s52, 65536
    s_nop 0
    buffer_load_dwordx4 v203, s[16:19], s92 offen lds
    s_waitcnt lgkmcnt(4)
    v_mfma_f32_32x32x16_bf16 v[128:143], v[172:175], v[68:71], v[128:143]
    ds_read_b64_tr_b16 v[168:169], v216 offset:57344
    ds_read_b64_tr_b16 v[170:171], v216 offset:58368
    s_waitcnt vmcnt(16) lgkmcnt(4)
    v_mfma_f32_32x32x16_bf16 v[112:127], v[160:163], v[72:75], v[112:127]
    ds_read_b64_tr_b16 v[172:173], v217 offset:57344
    ds_read_b64_tr_b16 v[174:175], v217 offset:58368
    s_add_u32 s93, s63, 0
    s_add_u32 m0, s52, 73728
    s_nop 0
    buffer_load_dwordx4 v203, s[16:19], s93 offen lds
    s_waitcnt lgkmcnt(4)
    v_mfma_f32_32x32x16_bf16 v[128:143], v[164:167], v[72:75], v[128:143]
    s_waitcnt vmcnt(6)
    s_barrier
    v_add_u32 v216, 0x20000, v216
    ds_read_b64_tr_b16 v[160:161], v216 offset:0
    ds_read_b64_tr_b16 v[162:163], v216 offset:1024
    s_waitcnt lgkmcnt(4)
    v_mfma_f32_32x32x16_bf16 v[112:127], v[168:171], v[76:79], v[112:127]
    v_add_u32 v217, 0x20000, v217
    ds_read_b64_tr_b16 v[164:165], v217 offset:0
    ds_read_b64_tr_b16 v[166:167], v217 offset:1024
    s_add_u32 s92, s58, 50176
    s_add_u32 m0, s52, 81920
    s_nop 0
    buffer_load_dwordx4 v203, s[16:19], s92 offen lds
    s_waitcnt lgkmcnt(4)
    v_mfma_f32_32x32x16_bf16 v[128:143], v[172:175], v[76:79], v[128:143]
    ds_read_b64_tr_b16 v[168:169], v216 offset:8192
    ds_read_b64_tr_b16 v[170:171], v216 offset:9216
    s_waitcnt lgkmcnt(4)
    v_mfma_f32_32x32x16_bf16 v[112:127], v[160:163], v[80:83], v[112:127]
    ds_read_b64_tr_b16 v[172:173], v217 offset:8192
    ds_read_b64_tr_b16 v[174:175], v217 offset:9216
    s_add_u32 s93, s63, 50176
    s_add_u32 m0, s52, 90112
    s_nop 0
    buffer_load_dwordx4 v203, s[16:19], s93 offen lds
    s_waitcnt lgkmcnt(4)
    v_mfma_f32_32x32x16_bf16 v[128:143], v[164:167], v[80:83], v[128:143]
    v_add_u32 v216, 0xfffe0000, v216
    ds_read_b64_tr_b16 v[160:161], v216 offset:0
    ds_read_b64_tr_b16 v[162:163], v216 offset:1024
    s_waitcnt lgkmcnt(4)
    v_mfma_f32_32x32x16_bf16 v[112:127], v[168:171], v[84:87], v[112:127]
    v_add_u32 v217, 0xfffe0000, v217
    ds_read_b64_tr_b16 v[164:165], v217 offset:0
    ds_read_b64_tr_b16 v[166:167], v217 offset:1024
    s_add_u32 s92, s58, 100352
    s_add_u32 m0, s52, 98304
    s_nop 0
    buffer_load_dwordx4 v203, s[16:19], s92 offen lds
    s_waitcnt lgkmcnt(4)
    v_mfma_f32_32x32x16_bf16 v[128:143], v[172:175], v[84:87], v[128:143]
    ds_read_b64_tr_b16 v[168:169], v216 offset:8192
    ds_read_b64_tr_b16 v[170:171], v216 offset:9216
    s_waitcnt lgkmcnt(4)
    v_mfma_f32_32x32x16_bf16 v[112:127], v[160:163], v[88:91], v[112:127]
    ds_read_b64_tr_b16 v[172:173], v217 offset:8192
    ds_read_b64_tr_b16 v[174:175], v217 offset:9216
    s_add_u32 s93, s63, 100352
    s_add_u32 m0, s52, 106496
    s_nop 0
    buffer_load_dwordx4 v203, s[16:19], s93 offen lds
    s_waitcnt lgkmcnt(4)
    v_mfma_f32_32x32x16_bf16 v[128:143], v[164:167], v[88:91], v[128:143]
    s_waitcnt vmcnt(6)
    s_barrier
    ds_read_b64_tr_b16 v[160:161], v216 offset:16384
    ds_read_b64_tr_b16 v[162:163], v216 offset:17408
    s_add_u32 s94, s57, 0
    buffer_load_dwordx4 v[0:3], v204, s[40:43], s94 offen
    s_add_u32 s94, s57, 1024
    buffer_load_dwordx4 v[4:7], v204, s[40:43], s94 offen
    s_add_u32 s94, s57, 4096
    buffer_load_dwordx4 v[8:11], v204, s[40:43], s94 offen
    s_add_u32 s94, s57, 5120
    buffer_load_dwordx4 v[12:15], v204, s[40:43], s94 offen
    s_add_u32 s94, s57, 8192
    buffer_load_dwordx4 v[16:19], v204, s[40:43], s94 offen
    s_add_u32 s94, s57, 9216
    buffer_load_dwordx4 v[20:23], v204, s[40:43], s94 offen
    s_waitcnt lgkmcnt(4)
    v_mfma_f32_32x32x16_bf16 v[112:127], v[168:171], v[92:95], v[112:127]
    ds_read_b64_tr_b16 v[164:165], v217 offset:16384
    ds_read_b64_tr_b16 v[166:167], v217 offset:17408
    s_waitcnt lgkmcnt(4)
    v_mfma_f32_32x32x16_bf16 v[128:143], v[172:175], v[92:95], v[128:143]
    ds_read_b64_tr_b16 v[168:169], v216 offset:24576
    ds_read_b64_tr_b16 v[170:171], v216 offset:25600
    s_add_u32 s92, s58, 150528
    s_add_u32 m0, s52, 114688
    s_nop 0
    buffer_load_dwordx4 v203, s[16:19], s92 offen lds
    s_waitcnt lgkmcnt(4)
    v_mfma_f32_32x32x16_bf16 v[112:127], v[160:163], v[96:99], v[112:127]
    ds_read_b64_tr_b16 v[172:173], v217 offset:24576
    ds_read_b64_tr_b16 v[174:175], v217 offset:25600
    s_waitcnt lgkmcnt(4)
    v_mfma_f32_32x32x16_bf16 v[128:143], v[164:167], v[96:99], v[128:143]
    ds_read_b64_tr_b16 v[160:161], v216 offset:32768
    ds_read_b64_tr_b16 v[162:163], v216 offset:33792
    s_waitcnt lgkmcnt(4)
    v_mfma_f32_32x32x16_bf16 v[112:127], v[168:171], v[100:103], v[112:127]
    ds_read_b64_tr_b16 v[164:165], v217 offset:32768
    ds_read_b64_tr_b16 v[166:167], v217 offset:33792
    s_waitcnt lgkmcnt(4)
    v_mfma_f32_32x32x16_bf16 v[128:143], v[172:175], v[100:103], v[128:143]
    ds_read_b64_tr_b16 v[168:169], v216 offset:40960
    ds_read_b64_tr_b16 v[170:171], v216 offset:41984
    s_add_u32 s93, s63, 150528
    s_add_u32 m0, s52, 122880
    s_nop 0
    buffer_load_dwordx4 v203, s[16:19], s93 offen lds
    s_waitcnt lgkmcnt(4)
    v_mfma_f32_32x32x16_bf16 v[112:127], v[160:163], v[104:107], v[112:127]
    ds_read_b64_tr_b16 v[172:173], v217 offset:40960
    ds_read_b64_tr_b16 v[174:175], v217 offset:41984
    s_waitcnt lgkmcnt(4)
    v_mfma_f32_32x32x16_bf16 v[128:143], v[164:167], v[104:107], v[128:143]
    s_waitcnt vmcnt(10)
    s_barrier
    v_add_u32 v216, 0x10000, v216
    ds_read_b64_tr_b16 v[160:161], v216 offset:0
    ds_read_b64_tr_b16 v[162:163], v216 offset:1024
    s_waitcnt lgkmcnt(4)
    v_mfma_f32_32x32x16_bf16 v[112:127], v[168:171], v[108:111], v[112:127]
    v_add_u32 v217, 0x10000, v217
    ds_read_b64_tr_b16 v[164:165], v217 offset:0
    ds_read_b64_tr_b16 v[166:167], v217 offset:1024
    s_waitcnt lgkmcnt(4)
    v_mfma_f32_32x32x16_bf16 v[128:143], v[172:175], v[108:111], v[128:143]
    ds_read_b64_tr_b16 v[168:169], v216 offset:8192
    ds_read_b64_tr_b16 v[170:171], v216 offset:9216
    s_waitcnt vmcnt(7) lgkmcnt(4)
    v_mfma_f32_32x32x16_bf16 v[112:127], v[160:163], v[0:3], v[112:127]
    ds_read_b64_tr_b16 v[172:173], v217 offset:8192
    ds_read_b64_tr_b16 v[174:175], v217 offset:9216
    s_waitcnt lgkmcnt(4)
    v_mfma_f32_32x32x16_bf16 v[128:143], v[164:167], v[0:3], v[128:143]
    ds_read_b64_tr_b16 v[160:161], v216 offset:16384
    ds_read_b64_tr_b16 v[162:163], v216 offset:17408
    s_waitcnt vmcnt(6) lgkmcnt(4)
    v_mfma_f32_32x32x16_bf16 v[112:127], v[168:171], v[4:7], v[112:127]
    ds_read_b64_tr_b16 v[164:165], v217 offset:16384
    ds_read_b64_tr_b16 v[166:167], v217 offset:17408
    s_waitcnt lgkmcnt(4)
    v_mfma_f32_32x32x16_bf16 v[128:143], v[172:175], v[4:7], v[128:143]
    ds_read_b64_tr_b16 v[168:169], v216 offset:24576
    ds_read_b64_tr_b16 v[170:171], v216 offset:25600
    s_waitcnt vmcnt(5) lgkmcnt(4)
    v_mfma_f32_32x32x16_bf16 v[112:127], v[160:163], v[8:11], v[112:127]
    ds_read_b64_tr_b16 v[172:173], v217 offset:24576
    ds_read_b64_tr_b16 v[174:175], v217 offset:25600
    s_waitcnt lgkmcnt(4)
    v_mfma_f32_32x32x16_bf16 v[128:143], v[164:167], v[8:11], v[128:143]
    s_waitcnt vmcnt(0)
    s_barrier
    ds_read_b64_tr_b16 v[160:161], v216 offset:32768
    ds_read_b64_tr_b16 v[162:163], v216 offset:33792
    s_add_u32 s94, s57, 12288
    buffer_load_dwordx4 v[24:27], v204, s[40:43], s94 offen
    s_add_u32 s94, s57, 13312
    buffer_load_dwordx4 v[28:31], v204, s[40:43], s94 offen
    s_waitcnt lgkmcnt(4)
    v_mfma_f32_32x32x16_bf16 v[112:127], v[168:171], v[12:15], v[112:127]
    ds_read_b64_tr_b16 v[164:165], v217 offset:32768
    ds_read_b64_tr_b16 v[166:167], v217 offset:33792
    s_waitcnt lgkmcnt(4)
    v_mfma_f32_32x32x16_bf16 v[128:143], v[172:175], v[12:15], v[128:143]
    ds_read_b64_tr_b16 v[168:169], v216 offset:40960
    ds_read_b64_tr_b16 v[170:171], v216 offset:41984
    s_waitcnt lgkmcnt(4)
    v_mfma_f32_32x32x16_bf16 v[112:127], v[160:163], v[16:19], v[112:127]
    ds_read_b64_tr_b16 v[172:173], v217 offset:40960
    ds_read_b64_tr_b16 v[174:175], v217 offset:41984
    s_waitcnt lgkmcnt(4)
    v_mfma_f32_32x32x16_bf16 v[128:143], v[164:167], v[16:19], v[128:143]
    ds_read_b64_tr_b16 v[160:161], v216 offset:49152
    ds_read_b64_tr_b16 v[162:163], v216 offset:50176
    s_waitcnt lgkmcnt(4)
    v_mfma_f32_32x32x16_bf16 v[112:127], v[168:171], v[20:23], v[112:127]
    ds_read_b64_tr_b16 v[164:165], v217 offset:49152
    ds_read_b64_tr_b16 v[166:167], v217 offset:50176
    s_waitcnt lgkmcnt(4)
    v_mfma_f32_32x32x16_bf16 v[128:143], v[172:175], v[20:23], v[128:143]
    ds_read_b64_tr_b16 v[168:169], v216 offset:57344
    ds_read_b64_tr_b16 v[170:171], v216 offset:58368
    s_waitcnt vmcnt(1) lgkmcnt(4)
    v_mfma_f32_32x32x16_bf16 v[112:127], v[160:163], v[24:27], v[112:127]
    ds_read_b64_tr_b16 v[172:173], v217 offset:57344
    ds_read_b64_tr_b16 v[174:175], v217 offset:58368
    s_waitcnt lgkmcnt(4)
    v_mfma_f32_32x32x16_bf16 v[128:143], v[164:167], v[24:27], v[128:143]
    s_waitcnt vmcnt(0) lgkmcnt(2)
    v_mfma_f32_32x32x16_bf16 v[112:127], v[168:171], v[28:31], v[112:127]
    s_waitcnt lgkmcnt(0)
    v_mfma_f32_32x32x16_bf16 v[128:143], v[172:175], v[28:31], v[128:143]
    v_bfe_u32 v228, v204, 4, 3
    v_lshrrev_b32 v229, 9, v204
    v_xor_b32 v228, v228, v229
    v_lshlrev_b32 v228, 4, v228
    v_and_b32 v229, 0x1f0, v204
    v_lshl_add_u32 v228, v229, 4, v228
    s_lshl_b32 s94, s45, 2
    s_lshr_b32 s94, 0x1083, s94
    s_and_b32 s94, s94, 15
    s_lshl_b32 s94, s94, 14
    s_add_u32 s94, s94, 8192
    v_add_u32 v228, s94, v228
    v_xor_b32 v230, 32, v228
    v_xor_b32 v231, 64, v228
    v_xor_b32 v232, 96, v228
    v_and_b32 v233, 7, v220
    v_lshlrev_b32 v233, 4, v233
    v_lshlrev_b32 v229, 1, v221
    v_xor_b32 v233, v233, v229
    v_lshl_add_u32 v233, v220, 8, v233
    v_xor_b32 v234, 16, v233
    ds_write_b128 v228, v[112:115] offset:0
    ds_write_b128 v230, v[116:119] offset:0
    ds_write_b128 v231, v[120:123] offset:0
    ds_write_b128 v232, v[124:127] offset:0
    ds_write_b128 v228, v[128:131] offset:128
    ds_write_b128 v230, v[132:135] offset:128
    ds_write_b128 v231, v[136:139] offset:128
    ds_write_b128 v232, v[140:143] offset:128
    s_waitcnt lgkmcnt(0)
    s_barrier
    ds_read_b128 v[0:3], v233 offset:49152
    ds_read_b128 v[4:7], v234 offset:49152
    v_add_u32 v233, 0x20000, v233
    ds_read_b128 v[8:11], v233 offset:0
    v_add_u32 v234, 0x20000, v234
    ds_read_b128 v[12:15], v234 offset:0
    v_add_u32 v233, 0xfffe0000, v233
    ds_read_b128 v[16:19], v233 offset:0
    v_add_u32 v234, 0xfffe0000, v234
    ds_read_b128 v[20:23], v234 offset:0
    ds_read_b128 v[24:27], v233 offset:16384
    ds_read_b128 v[28:31], v234 offset:16384
    v_lshlrev_b32 v32, 16, v224
    v_and_b32 v33, 0xffff0000, v224
    v_lshlrev_b32 v34, 16, v225
    v_and_b32 v35, 0xffff0000, v225
    v_lshlrev_b32 v36, 16, v226
    v_and_b32 v37, 0xffff0000, v226
    v_lshlrev_b32 v38, 16, v227
    v_and_b32 v39, 0xffff0000, v227
    s_waitcnt lgkmcnt(7)
    v_add_f32 v32, v32, v0
    v_add_f32 v33, v33, v1
    v_add_f32 v34, v34, v2
    v_add_f32 v35, v35, v3
    s_waitcnt lgkmcnt(6)
    v_add_f32 v36, v36, v4
    v_add_f32 v37, v37, v5
    v_add_f32 v38, v38, v6
    v_add_f32 v39, v39, v7
    s_waitcnt lgkmcnt(5)
    v_add_f32 v32, v32, v8
    v_add_f32 v33, v33, v9
    v_add_f32 v34, v34, v10
    v_add_f32 v35, v35, v11
    s_waitcnt lgkmcnt(4)
    v_add_f32 v36, v36, v12
    v_add_f32 v37, v37, v13
    v_add_f32 v38, v38, v14
    v_add_f32 v39, v39, v15
    s_waitcnt lgkmcnt(3)
    v_add_f32 v32, v32, v16
    v_add_f32 v33, v33, v17
    v_add_f32 v34, v34, v18
    v_add_f32 v35, v35, v19
    s_waitcnt lgkmcnt(2)
    v_add_f32 v36, v36, v20
    v_add_f32 v37, v37, v21
    v_add_f32 v38, v38, v22
    v_add_f32 v39, v39, v23
    s_waitcnt lgkmcnt(1)
    v_add_f32 v32, v32, v24
    v_add_f32 v33, v33, v25
    v_add_f32 v34, v34, v26
    v_add_f32 v35, v35, v27
    s_waitcnt lgkmcnt(0)
    v_add_f32 v36, v36, v28
    v_add_f32 v37, v37, v29
    v_add_f32 v38, v38, v30
    v_add_f32 v39, v39, v31
    v_cvt_pk_bf16_f32 v40, v32, v33
    v_cvt_pk_bf16_f32 v41, v34, v35
    v_cvt_pk_bf16_f32 v42, v36, v37
    v_cvt_pk_bf16_f32 v43, v38, v39
    buffer_store_dwordx4 v[40:43], v222, s[32:35], s96 offen
    s_endpgm
.LQ:
    s_nop 4
    s_cmp_eq_u32 s46, 1
    s_cbranch_scc1 .LQ1
    s_lshl_b32 s51, s48, 3
    s_add_u32 s51, s51, s44
    s_mul_i32 s96, s51, 1568
    s_add_u32 m0, s53, 147456
    s_nop 0
    buffer_load_dwordx4 v204, s[12:15], s96 offen lds
    buffer_load_dwordx4 v204, s[12:15], s96 offen offset:1024 lds
    v_bfe_u32 v115, v204, 4, 5
    v_subrev_u32 v116, 2, v115
    v_cmp_gt_u32 vcc, 26, v115
    s_nop 1
    v_cndmask_b32 v116, v116, v115, vcc
    v_lshlrev_b32 v116, 1, v116
    v_lshrrev_b32 v113, 9, v204
    v_mul_u32_u24 v113, 224, v113
    v_add_u32 v113, v113, v116
    v_add_u32 v113, s53, v113
    v_add_u32 v113, 0x24000, v113
    s_mul_i32 s97, s48, 448
    v_and_b32 v224, 3, v255
    v_lshlrev_b32 v224, 4, v224
    v_min_u32 v224, 40, v224
    v_lshrrev_b32 v225, 2, v255
    v_xor_b32 v225, v225, v222
    v_mad_u32_u24 v224, v225, 56, v224
    v_mul_u32_u24 v200, 2688, v223
    v_add3_u32 v200, v200, v224, s97
    v_mov_b32 v226, 0
    v_mov_b32 v227, 0
    v_mov_b32 v228, 0
    v_mov_b32 v229, 0
    s_lshl_b32 s96, s47, 1
    s_add_u32 s96, s96, s48
    s_mul_i32 s97, s96, 4992
    s_add_u32 s97, s97, 0xa00000
    v_lshlrev_b32 v224, 4, v0
    v_mov_b32 v225, 0x40000000
    v_cmp_gt_u32 vcc, 312, v0
    s_nop 1
    v_cndmask_b32 v224, v225, v224, vcc
    buffer_store_dwordx4 v[226:229], v224, s[40:43], s97 offen sc1
    s_lshl_b32 s96, s96, 2
    v_mov_b32 v235, s96
    v_cmp_eq_u32 vcc, 0, v0
    s_nop 1
    v_cndmask_b32 v235, v225, v235, vcc
    v_bfe_u32 v230, v253, 4, 1
    v_lshrrev_b32 v231, 5, v253
    v_bfe_u32 v232, v253, 2, 2
    v_and_b32 v233, 3, v253
    s_add_u32 s92, s45, 0
    s_and_b32 s92, s92, 3
    s_add_u32 s93, s45, 1
    s_and_b32 s93, s93, 3
    s_add_u32 s94, s45, 2
    s_and_b32 s94, s94, 3
    s_add_u32 s95, s45, 3
    s_and_b32 s95, s95, 3
    v_bfe_u32 v224, v253, 1, 3
    v_xor_b32 v224, v224, v231
    v_lshlrev_b32 v224, 4, v224
    v_and_b32 v225, 31, v253
    v_lshl_add_u32 v234, v225, 7, v224
    s_lshl_b32 s96, s45, 12
    v_add_u32 v234, s96, v234
    v_lshlrev_b32 v206, 4, v225
    v_add_u32 v206, 0x25000, v206
    v_lshl_add_u32 v207, v231, 3, v206
    v_lshl_add_u32 v206, s45, 2, v206
    v_mov_b32 v224, 0x40000000
    v_cmp_eq_u32 vcc, 0, v253
    s_nop 1
    v_cndmask_b32 v205, v224, 0, vcc
    s_lshl_b32 s96, s92, 5
    v_xor_b32 v222, s96, v234
    s_lshl_b32 s96, s93, 5
    v_xor_b32 v223, s96, v234
    s_lshl_b32 s96, s94, 5
    v_xor_b32 v224, s96, v234
    s_lshl_b32 s96, s95, 5
    v_xor_b32 v225, s96, v234
    v_and_b32 v226, 7, v253
    v_lshlrev_b32 v227, 2, v230
    v_cmp_eq_u32 vcc, v226, v227
    v_mov_b32 v234, 0x3f803f80
    s_nop 0
    v_cndmask_b32 v176, 0, v234, vcc
    v_cndmask_b32 v177, 0, v234, vcc
    v_cndmask_b32 v178, 0, v234, vcc
    v_cndmask_b32 v179, 0, v234, vcc
    v_lshl_add_u32 v226, v231, 3, v232
    v_lshlrev_b32 v226, 7, v226
    v_lshl_add_u32 v226, v233, 3, v226
    v_lshrrev_b32 v227, 1, v232
    v_lshlrev_b32 v228, 1, v227
    v_xor_b32 v228, v228, v230
    v_xor_b32 v229, 0, v228
    v_lshl_add_u32 v229, v229, 5, v226
    s_lshl_b32 s92, s92, 11
    v_add_u32 v196, s92, v229
    s_lshl_b32 s93, s93, 11
    v_add_u32 v197, s93, v229
    s_lshl_b32 s94, s94, 11
    v_add_u32 v198, s94, v229
    s_lshl_b32 s95, s95, 11
    v_add_u32 v199, s95, v229
    s_lshl_b32 s96, s48, 4
    s_add_u32 s54, s54, s96
    s_add_u32 s54, s54, 112
    s_lshl_b32 s54, s54, 10
    s_lshr_b32 s55, s55, 1
    s_lshl_b32 s96, s48, 5
    s_add_u32 s55, s55, s96
    s_add_u32 s55, s55, 0xa24000
    s_add_u32 m0, s53, 49152
    s_nop 0
    buffer_load_dwordx4 v220, s[4:7], s66 offen lds
    s_add_u32 m0, s53, 50176
    s_nop 0
    buffer_load_dwordx4 v221, s[4:7], s66 offen lds
    s_add_u32 m0, s53, 65536
    s_nop 0
    buffer_load_dwordx4 v220, s[4:7], s67 offen lds
    s_add_u32 m0, s53, 66560
    s_nop 0
    buffer_load_dwordx4 v221, s[4:7], s67 offen lds
    s_add_u32 m0, s52, 81920
    s_nop 0
    buffer_load_dwordx4 v202, s[8:11], s80 offen lds
    s_add_u32 m0, s52, 90112
    s_nop 0
    buffer_load_dwordx4 v202, s[8:11], s81 offen lds
    s_waitcnt vmcnt(9)
    s_barrier
    ds_read_b128 v[0:3], v222 offset:0
    ds_read_b64_tr_b16 v[160:161], v196 offset:32768
    ds_read_b64_tr_b16 v[162:163], v196 offset:33280
    ds_read_b128 v[4:7], v223 offset:0
    ds_read_b64_tr_b16 v[164:165], v197 offset:32768
    ds_read_b64_tr_b16 v[166:167], v197 offset:33280
    ds_read_b128 v[8:11], v224 offset:0
    ds_read_b64_tr_b16 v[168:169], v198 offset:32768
    ds_read_b64_tr_b16 v[170:171], v198 offset:33280
    s_waitcnt lgkmcnt(6)
    v_mfma_f32_32x32x16_bf16 v[144:159], v[160:163], v[0:3], 0
    v_mfma_f32_16x16x32_bf16 v[180:183], v[176:179], v[160:163], 0
    ds_read_b128 v[12:15], v225 offset:0
    ds_read_b64_tr_b16 v[172:173], v199 offset:32768
    ds_read_b64_tr_b16 v[174:175], v199 offset:33280
    s_add_u32 m0, s53, 98304
    s_nop 0
    buffer_load_dwordx4 v220, s[4:7], s68 offen lds
    s_add_u32 m0, s53, 99328
    s_nop 0
    buffer_load_dwordx4 v221, s[4:7], s68 offen lds
    s_waitcnt vmcnt(8)
    s_waitcnt lgkmcnt(6)
    v_mfma_f32_32x32x16_bf16 v[144:159], v[164:167], v[4:7], v[144:159]
    ds_read_b128 v[16:19], v222 offset:16384
    ds_read_b64_tr_b16 v[160:161], v196 offset:40960
    ds_read_b64_tr_b16 v[162:163], v196 offset:41472
    s_add_u32 m0, s53, 114688
    s_nop 0
    buffer_load_dwordx4 v220, s[4:7], s69 offen lds
    s_waitcnt lgkmcnt(6)
    v_mfma_f32_32x32x16_bf16 v[144:159], v[168:171], v[8:11], v[144:159]
    ds_read_b128 v[20:23], v223 offset:16384
    ds_read_b64_tr_b16 v[164:165], v197 offset:40960
    ds_read_b64_tr_b16 v[166:167], v197 offset:41472
    s_waitcnt lgkmcnt(6)
    v_mfma_f32_32x32x16_bf16 v[144:159], v[172:175], v[12:15], v[144:159]
    ds_read_b128 v[24:27], v224 offset:16384
    ds_read_b64_tr_b16 v[168:169], v198 offset:40960
    ds_read_b64_tr_b16 v[170:171], v198 offset:41472
    s_add_u32 m0, s53, 115712
    s_nop 0
    buffer_load_dwordx4 v221, s[4:7], s69 offen lds
    s_waitcnt lgkmcnt(6)
    v_mfma_f32_32x32x16_bf16 v[144:159], v[160:163], v[16:19], v[144:159]
    v_mfma_f32_16x16x32_bf16 v[180:183], v[176:179], v[160:163], v[180:183]
    ds_read_b128 v[28:31], v225 offset:16384
    ds_read_b64_tr_b16 v[172:173], v199 offset:40960
    ds_read_b64_tr_b16 v[174:175], v199 offset:41472
    s_add_u32 m0, s52, 131072
    s_nop 0
    buffer_load_dwordx4 v202, s[8:11], s82 offen lds
    s_waitcnt lgkmcnt(6)
    v_mfma_f32_32x32x16_bf16 v[144:159], v[164:167], v[20:23], v[144:159]
    s_waitcnt vmcnt(5) lgkmcnt(0)
    s_barrier
    ds_read_b128 v[32:35], v222 offset:49152
    v_add_u32 v196, 0x10000, v196
    ds_read_b64_tr_b16 v[160:161], v196 offset:16384
    ds_read_b64_tr_b16 v[162:163], v196 offset:16896
    s_add_u32 m0, s52, 139264
    s_nop 0
    buffer_load_dwordx4 v202, s[8:11], s83 offen lds
    v_mov_b32 v255, 1
    buffer_store_dword v255, v235, s[36:39], 0 offen offset:128 sc1
    v_mov_b32 v226, 0
    v_mov_b32 v227, 0
    v_mov_b32 v228, 0
    v_mov_b32 v229, 0
    v_dot2c_f32_bf16 v226, v0, v234
    v_dot2c_f32_bf16 v228, v0, v0
    v_dot2c_f32_bf16 v227, v1, v234
    v_dot2c_f32_bf16 v229, v1, v1
    v_mfma_f32_32x32x16_bf16 v[144:159], v[168:171], v[24:27], v[144:159]
    ds_read_b128 v[36:39], v223 offset:49152
    v_add_u32 v197, 0x10000, v197
    ds_read_b64_tr_b16 v[164:165], v197 offset:16384
    ds_read_b64_tr_b16 v[166:167], v197 offset:16896
    s_add_u32 m0, s53, 0
    s_nop 0
    buffer_load_dwordx4 v220, s[4:7], s70 offen lds
    v_dot2c_f32_bf16 v226, v2, v234
    v_dot2c_f32_bf16 v228, v2, v2
    v_dot2c_f32_bf16 v227, v3, v234
    v_dot2c_f32_bf16 v229, v3, v3
    v_dot2c_f32_bf16 v226, v4, v234
    v_dot2c_f32_bf16 v228, v4, v4
    v_dot2c_f32_bf16 v227, v5, v234
    v_dot2c_f32_bf16 v229, v5, v5
    v_dot2c_f32_bf16 v226, v6, v234
    v_dot2c_f32_bf16 v228, v6, v6
    v_mfma_f32_32x32x16_bf16 v[144:159], v[172:175], v[28:31], v[144:159]
    ds_read_b128 v[40:43], v224 offset:49152
    v_add_u32 v198, 0x10000, v198
    ds_read_b64_tr_b16 v[168:169], v198 offset:16384
    ds_read_b64_tr_b16 v[170:171], v198 offset:16896
    s_add_u32 m0, s53, 1024
    s_nop 0
    buffer_load_dwordx4 v221, s[4:7], s70 offen lds
    v_dot2c_f32_bf16 v227, v7, v234
    v_dot2c_f32_bf16 v229, v7, v7
    v_dot2c_f32_bf16 v226, v16, v234
    v_dot2c_f32_bf16 v228, v16, v16
    v_dot2c_f32_bf16 v227, v17, v234
    v_dot2c_f32_bf16 v229, v17, v17
    v_dot2c_f32_bf16 v226, v18, v234
    v_dot2c_f32_bf16 v228, v18, v18
    v_dot2c_f32_bf16 v227, v19, v234
    v_dot2c_f32_bf16 v229, v19, v19
    s_waitcnt lgkmcnt(6)
    v_mfma_f32_32x32x16_bf16 v[144:159], v[160:163], v[32:35], v[144:159]
    v_mfma_f32_16x16x32_bf16 v[180:183], v[176:179], v[160:163], v[180:183]
    ds_read_b128 v[44:47], v225 offset:49152
    v_add_u32 v199, 0x10000, v199
    ds_read_b64_tr_b16 v[172:173], v199 offset:16384
    ds_read_b64_tr_b16 v[174:175], v199 offset:16896
    v_dot2c_f32_bf16 v226, v20, v234
    v_dot2c_f32_bf16 v228, v20, v20
    v_dot2c_f32_bf16 v227, v21, v234
    v_dot2c_f32_bf16 v229, v21, v21
    v_dot2c_f32_bf16 v226, v22, v234
    v_dot2c_f32_bf16 v228, v22, v22
    v_dot2c_f32_bf16 v227, v23, v234
    v_dot2c_f32_bf16 v229, v23, v23
    v_dot2c_f32_bf16 v226, v32, v234
    v_dot2c_f32_bf16 v228, v32, v32
    s_waitcnt lgkmcnt(6)
    v_mfma_f32_32x32x16_bf16 v[144:159], v[164:167], v[36:39], v[144:159]
    v_add_u32 v222, 0x10000, v222
    ds_read_b128 v[48:51], v222 offset:0
    ds_read_b64_tr_b16 v[160:161], v196 offset:24576
    ds_read_b64_tr_b16 v[162:163], v196 offset:25088
    s_add_u32 m0, s52, 16384
    s_nop 0
    buffer_load_dwordx4 v202, s[8:11], s84 offen lds
    v_dot2c_f32_bf16 v227, v33, v234
    v_dot2c_f32_bf16 v229, v33, v33
    v_dot2c_f32_bf16 v226, v34, v234
    v_dot2c_f32_bf16 v228, v34, v34
    v_dot2c_f32_bf16 v227, v35, v234
    v_dot2c_f32_bf16 v229, v35, v35
    v_dot2c_f32_bf16 v226, v36, v234
    v_dot2c_f32_bf16 v228, v36, v36
    v_dot2c_f32_bf16 v227, v37, v234
    v_dot2c_f32_bf16 v229, v37, v37
    s_waitcnt lgkmcnt(6)
    v_mfma_f32_32x32x16_bf16 v[144:159], v[168:171], v[40:43], v[144:159]
    v_add_u32 v223, 0x10000, v223
    ds_read_b128 v[52:55], v223 offset:0
    ds_read_b64_tr_b16 v[164:165], v197 offset:24576
    ds_read_b64_tr_b16 v[166:167], v197 offset:25088
    s_add_u32 m0, s52, 32768
    s_nop 0
    buffer_load_dwordx4 v200, s[8:11], s78 offen lds
    v_dot2c_f32_bf16 v226, v38, v234
    v_dot2c_f32_bf16 v228, v38, v38
    v_dot2c_f32_bf16 v227, v39, v234
    v_dot2c_f32_bf16 v229, v39, v39
    ds_read_u16 v236, v113 offset:0
    ds_read_u16 v244, v113 offset:56
    ds_read_u16 v237, v113 offset:112
    ds_read_u16 v245, v113 offset:168
    ds_read_u16 v238, v113 offset:448
    ds_read_u16 v246, v113 offset:504
    s_waitcnt lgkmcnt(12)
    v_mfma_f32_32x32x16_bf16 v[144:159], v[172:175], v[44:47], v[144:159]
    v_add_u32 v224, 0x10000, v224
    ds_read_b128 v[56:59], v224 offset:0
    ds_read_b64_tr_b16 v[168:169], v198 offset:24576
    ds_read_b64_tr_b16 v[170:171], v198 offset:25088
    s_add_u32 m0, s52, 40960
    s_nop 0
    buffer_load_dwordx4 v200, s[8:11], s79 offen lds
    ds_read_u16 v239, v113 offset:560
    ds_read_u16 v247, v113 offset:616
    ds_read_u16 v240, v113 offset:896
    ds_read_u16 v248, v113 offset:952
    ds_read_u16 v241, v113 offset:1008
    ds_read_u16 v249, v113 offset:1064
    ds_read_u16 v242, v113 offset:1120
    ds_read_u16 v250, v113 offset:1176
    ds_read_u16 v243, v113 offset:1232
    ds_read_u16 v251, v113 offset:1288
    s_waitcnt lgkmcnt(15)
    v_mfma_f32_32x32x16_bf16 v[144:159], v[160:163], v[48:51], v[144:159]
    v_mfma_f32_16x16x32_bf16 v[180:183], v[176:179], v[160:163], v[180:183]
    v_add_u32 v225, 0x10000, v225
    ds_read_b128 v[60:63], v225 offset:0
    ds_read_b64_tr_b16 v[172:173], v199 offset:24576
    ds_read_b64_tr_b16 v[174:175], v199 offset:25088
    v_mfma_f32_32x32x16_bf16 v[144:159], v[164:167], v[52:55], v[144:159]
    s_waitcnt vmcnt(6) lgkmcnt(0)
    s_barrier
    ds_read_b128 v[64:67], v222 offset:32768
    v_add_u32 v196, 0x10000, v196
    ds_read_b64_tr_b16 v[160:161], v196 offset:0
    ds_read_b64_tr_b16 v[162:163], v196 offset:512
    s_add_u32 m0, s52, 49152
    s_nop 0
    buffer_load_dwordx4 v200, s[8:11], s80 offen lds
    v_lshl_or_b32 v236, v244, 16, v236
    v_lshl_or_b32 v237, v245, 16, v237
    v_lshl_or_b32 v238, v246, 16, v238
    v_lshl_or_b32 v239, v247, 16, v239
    v_lshl_or_b32 v240, v248, 16, v240
    v_lshl_or_b32 v241, v249, 16, v241
    v_lshl_or_b32 v242, v250, 16, v242
    v_lshl_or_b32 v243, v251, 16, v243
    s_mov_b32 s94, 0xcc000000
    s_mov_b32 s95, 0xcc000000
    v_cndmask_b32 v236, v236, 0, s[94:95]
    v_cndmask_b32 v237, v237, 0, s[94:95]
    v_cndmask_b32 v238, v238, 0, s[94:95]
    v_cndmask_b32 v239, v239, 0, s[94:95]
    v_cndmask_b32 v240, v240, 0, s[94:95]
    v_cndmask_b32 v241, v241, 0, s[94:95]
    s_mov_b32 s94, -1
    v_cndmask_b32 v242, v242, 0, s[94:95]
    v_cndmask_b32 v243, v243, 0, s[94:95]
    v_mfma_f32_32x32x16_bf16 v[144:159], v[168:171], v[56:59], v[144:159]
    ds_read_b128 v[68:71], v223 offset:32768
    v_add_u32 v197, 0x10000, v197
    ds_read_b64_tr_b16 v[164:165], v197 offset:0
    ds_read_b64_tr_b16 v[166:167], v197 offset:512
    s_add_u32 m0, s52, 57344
    s_nop 0
    buffer_load_dwordx4 v200, s[8:11], s81 offen lds
    v_dot2c_f32_bf16 v226, v48, v234
    v_dot2c_f32_bf16 v228, v48, v48
    v_dot2c_f32_bf16 v227, v49, v234
    v_dot2c_f32_bf16 v229, v49, v49
    v_dot2c_f32_bf16 v226, v50, v234
    v_dot2c_f32_bf16 v228, v50, v50
    v_dot2c_f32_bf16 v227, v51, v234
    v_dot2c_f32_bf16 v229, v51, v51
    v_dot2c_f32_bf16 v226, v52, v234
    v_dot2c_f32_bf16 v228, v52, v52
    v_mfma_f32_32x32x16_bf16 v[144:159], v[172:175], v[60:63], v[144:159]
    ds_read_b128 v[72:75], v224 offset:32768
    v_add_u32 v198, 0x10000, v198
    ds_read_b64_tr_b16 v[168:169], v198 offset:0
    ds_read_b64_tr_b16 v[170:171], v198 offset:512
    v_dot2c_f32_bf16 v227, v53, v234
    v_dot2c_f32_bf16 v229, v53, v53
    v_dot2c_f32_bf16 v226, v54, v234
    v_dot2c_f32_bf16 v228, v54, v54
    v_dot2c_f32_bf16 v227, v55, v234
    v_dot2c_f32_bf16 v229, v55, v55
    s_waitcnt lgkmcnt(6)
    v_mfma_f32_32x32x16_bf16 v[144:159], v[160:163], v[64:67], v[144:159]
    v_mfma_f32_16x16x32_bf16 v[180:183], v[176:179], v[160:163], v[180:183]
    ds_read_b128 v[76:79], v225 offset:32768
    v_add_u32 v199, 0x10000, v199
    ds_read_b64_tr_b16 v[172:173], v199 offset:0
    ds_read_b64_tr_b16 v[174:175], v199 offset:512
    s_add_u32 m0, s52, 65536
    s_nop 0
    buffer_load_dwordx4 v200, s[8:11], s82 offen lds
    v_dot2c_f32_bf16 v226, v64, v234
    v_dot2c_f32_bf16 v228, v64, v64
    v_dot2c_f32_bf16 v227, v65, v234
    v_dot2c_f32_bf16 v229, v65, v65
    v_dot2c_f32_bf16 v226, v66, v234
    v_dot2c_f32_bf16 v228, v66, v66
    v_dot2c_f32_bf16 v227, v67, v234
    v_dot2c_f32_bf16 v229, v67, v67
    s_waitcnt lgkmcnt(6)
    v_mfma_f32_32x32x16_bf16 v[144:159], v[164:167], v[68:71], v[144:159]
    ds_read_b128 v[80:83], v222 offset:49152
    ds_read_b64_tr_b16 v[160:161], v196 offset:8192
    ds_read_b64_tr_b16 v[162:163], v196 offset:8704
    s_add_u32 m0, s52, 73728
    s_nop 0
    buffer_load_dwordx4 v200, s[8:11], s83 offen lds
    v_dot2c_f32_bf16 v226, v68, v234
    v_dot2c_f32_bf16 v228, v68, v68
    v_dot2c_f32_bf16 v227, v69, v234
    v_dot2c_f32_bf16 v229, v69, v69
    v_dot2c_f32_bf16 v226, v70, v234
    v_dot2c_f32_bf16 v228, v70, v70
    v_dot2c_f32_bf16 v227, v71, v234
    v_dot2c_f32_bf16 v229, v71, v71
    s_waitcnt lgkmcnt(6)
    v_mfma_f32_32x32x16_bf16 v[144:159], v[168:171], v[72:75], v[144:159]
    ds_read_b128 v[84:87], v223 offset:49152
    ds_read_b64_tr_b16 v[164:165], v197 offset:8192
    ds_read_b64_tr_b16 v[166:167], v197 offset:8704
    s_waitcnt lgkmcnt(6)
    v_mfma_f32_32x32x16_bf16 v[144:159], v[172:175], v[76:79], v[144:159]
    ds_read_b128 v[88:91], v224 offset:49152
    ds_read_b64_tr_b16 v[168:169], v198 offset:8192
    ds_read_b64_tr_b16 v[170:171], v198 offset:8704
    s_add_u32 m0, s52, 24576
    s_nop 0
    buffer_load_dwordx4 v200, s[8:11], s84 offen lds
    s_waitcnt lgkmcnt(6)
    v_mfma_f32_32x32x16_bf16 v[144:159], v[160:163], v[80:83], v[144:159]
    v_mfma_f32_16x16x32_bf16 v[180:183], v[176:179], v[160:163], v[180:183]
    ds_read_b128 v[92:95], v225 offset:49152
    ds_read_b64_tr_b16 v[172:173], v199 offset:8192
    ds_read_b64_tr_b16 v[174:175], v199 offset:8704
    v_dot2c_f32_bf16 v226, v80, v234
    v_dot2c_f32_bf16 v228, v80, v80
    v_dot2c_f32_bf16 v227, v81, v234
    v_dot2c_f32_bf16 v229, v81, v81
    v_dot2c_f32_bf16 v226, v82, v234
    v_dot2c_f32_bf16 v228, v82, v82
    v_dot2c_f32_bf16 v227, v83, v234
    v_dot2c_f32_bf16 v229, v83, v83
    s_waitcnt lgkmcnt(6)
    v_mfma_f32_32x32x16_bf16 v[144:159], v[164:167], v[84:87], v[144:159]
    s_waitcnt vmcnt(7)
    s_barrier
    v_add_u32 v222, 0xffff0000, v222
    ds_read_b128 v[96:99], v222 offset:0
    v_add_u32 v196, 0xfffe0000, v196
    ds_read_b64_tr_b16 v[160:161], v196 offset:16384
    ds_read_b64_tr_b16 v[162:163], v196 offset:16896
    v_dot2c_f32_bf16 v226, v84, v234
    v_dot2c_f32_bf16 v228, v84, v84
    v_dot2c_f32_bf16 v227, v85, v234
    v_dot2c_f32_bf16 v229, v85, v85
    v_dot2c_f32_bf16 v226, v86, v234
    v_dot2c_f32_bf16 v228, v86, v86
    v_dot2c_f32_bf16 v227, v87, v234
    v_dot2c_f32_bf16 v229, v87, v87
    v_add_u32 v201, s53, v204
    v_add_u32 v201, 0x14000, v201
    s_waitcnt lgkmcnt(6)
    v_mfma_f32_32x32x16_bf16 v[144:159], v[168:171], v[88:91], v[144:159]
    v_add_u32 v223, 0xffff0000, v223
    ds_read_b128 v[100:103], v223 offset:0
    v_add_u32 v197, 0xfffe0000, v197
    ds_read_b64_tr_b16 v[164:165], v197 offset:16384
    ds_read_b64_tr_b16 v[166:167], v197 offset:16896
    ds_write_b128 v201, v[236:239]
    ds_write_b128 v201, v[240:243] offset:1024
    v_add_u32 v201, 0x14000, v204
    s_waitcnt lgkmcnt(8)
    v_mfma_f32_32x32x16_bf16 v[144:159], v[172:175], v[92:95], v[144:159]
    v_add_u32 v224, 0xffff0000, v224
    ds_read_b128 v[104:107], v224 offset:0
    v_add_u32 v198, 0xfffe0000, v198
    ds_read_b64_tr_b16 v[168:169], v198 offset:16384
    ds_read_b64_tr_b16 v[170:171], v198 offset:16896
    s_waitcnt lgkmcnt(8)
    v_mfma_f32_32x32x16_bf16 v[144:159], v[160:163], v[96:99], v[144:159]
    v_mfma_f32_16x16x32_bf16 v[180:183], v[176:179], v[160:163], v[180:183]
    v_add_u32 v225, 0xffff0000, v225
    ds_read_b128 v[108:111], v225 offset:0
    v_add_u32 v199, 0xfffe0000, v199
    ds_read_b64_tr_b16 v[172:173], v199 offset:16384
    ds_read_b64_tr_b16 v[174:175], v199 offset:16896
    s_waitcnt lgkmcnt(8)
    v_mfma_f32_32x32x16_bf16 v[144:159], v[164:167], v[100:103], v[144:159]
    s_waitcnt lgkmcnt(3)
    v_mfma_f32_32x32x16_bf16 v[144:159], v[168:171], v[104:107], v[144:159]
    ds_write_b32 v206, v180 offset:0
    v_dot2c_f32_bf16 v226, v96, v234
    v_dot2c_f32_bf16 v228, v96, v96
    v_dot2c_f32_bf16 v227, v97, v234
    v_dot2c_f32_bf16 v229, v97, v97
    v_dot2c_f32_bf16 v226, v98, v234
    v_dot2c_f32_bf16 v228, v98, v98
    v_dot2c_f32_bf16 v227, v99, v234
    v_dot2c_f32_bf16 v229, v99, v99
    v_dot2c_f32_bf16 v226, v100, v234
    s_waitcnt lgkmcnt(1)
    v_mfma_f32_32x32x16_bf16 v[144:159], v[172:175], v[108:111], v[144:159]
    v_dot2c_f32_bf16 v228, v100, v100
    v_dot2c_f32_bf16 v227, v101, v234
    v_dot2c_f32_bf16 v229, v101, v101
    v_dot2c_f32_bf16 v226, v102, v234
    v_dot2c_f32_bf16 v228, v102, v102
    v_dot2c_f32_bf16 v227, v103, v234
    v_dot2c_f32_bf16 v229, v103, v103
    s_nop 1
    v_add_f32 v226, v226, v227
    v_add_f32 v227, v228, v229
    v_and_b32 v230, 0x1f0, v204
    v_lshlrev_b32 v230, 1, v230
    s_lshl_b32 s94, s45, 10
    s_add_u32 s94, s94, 147456
    v_add_u32 v230, s94, v230
    v_lshrrev_b32 v231, 9, v204
    v_lshl_add_u32 v231, v231, 3, v230
    ds_write_b64 v231, v[226:227] offset:0
    s_waitcnt vmcnt(0) lgkmcnt(0)
    s_barrier
    ds_read_b128 v[220:223], v230
    ds_read_b128 v[224:227], v230 offset:16
    s_waitcnt lgkmcnt(1)
    v_add_f32 v220, v220, v222
    v_add_f32 v221, v221, v223
    s_waitcnt lgkmcnt(0)
    v_add_f32 v224, v224, v226
    v_add_f32 v225, v225, v227
    v_add_f32 v220, v220, v224
    v_add_f32 v221, v221, v225
    v_mul_f32 v208, 0xbb124925, v220
    v_mul_f32 v221, 0x3b124925, v221
    v_fma_f32 v221, -v208, v208, v221
    v_max_f32 v221, 0, v221
    v_add_f32 v221, 0x3727c5ac, v221
    v_rsq_f32 v209, v221
    v_rcp_f32 v210, v221
    s_nop 0
    v_mul_f32 v211, 0x3fb8aa3b, v209
    s_setprio 3
    s_and_b32 s94, s50, 7
    s_lshl_b32 s94, s94, 11
    v_add_u32 v252, s94, v201
    ds_read_b128 v[236:239], v252
    ds_read_b128 v[240:243], v252 offset:1024
    v_bfe_u32 v254, v204, 2, 7
    s_cmp_eq_u32 s44, 0
    s_cselect_b32 s94, 0, 0x40000000
    v_or_b32 v254, s94, v254
    buffer_load_dword v255, v254, s[36:39], 0 offen offset:128 sc1
    ds_read_b64 v[228:229], v207 offset:0
    s_waitcnt lgkmcnt(0)
    v_add_f32 v228, v228, v229
    v_add_u32 v200, 112, v200
    s_add_u32 m0, s52, 98304
    s_nop 0
    buffer_load_dwordx4 v200, s[8:11], s78 offen lds
    v_mfma_f32_32x32x2_f32 v[144:159], v228, v208, v[144:159]
    s_nop 15
    s_nop 3
    v_cvt_pk_bf16_f32 v144, v144, v145
    v_cvt_pk_bf16_f32 v145, v146, v147
    v_cvt_pk_bf16_f32 v146, v148, v149
    v_cvt_pk_bf16_f32 v147, v150, v151
    v_cvt_pk_bf16_f32 v148, v152, v153
    v_cvt_pk_bf16_f32 v149, v154, v155
    v_cvt_pk_bf16_f32 v150, v156, v157
    s_add_u32 m0, s52, 106496
    s_nop 0
    buffer_load_dwordx4 v200, s[8:11], s79 offen lds
    v_cvt_pk_bf16_f32 v151, v158, v159
    v_mfma_f32_32x32x16_bf16 v[220:235], v[236:239], v[144:147], 0
    s_nop 0
    v_mfma_f32_32x32x16_bf16 v[220:235], v[240:243], v[148:151], v[220:235]
    s_setprio 0
    s_nop 10
    v_max3_f32 v244, v220, v221, v222
    v_min3_f32 v245, v220, v221, v222
    v_max3_f32 v244, v244, v223, v224
    v_min3_f32 v245, v245, v223, v224
    s_add_u32 m0, s52, 114688
    s_nop 0
    buffer_load_dwordx4 v200, s[8:11], s80 offen lds
    v_max3_f32 v244, v244, v225, v226
    v_min3_f32 v245, v245, v225, v226
    v_max3_f32 v244, v244, v227, v228
    v_min3_f32 v245, v245, v227, v228
    v_max3_f32 v244, v244, v229, v230
    v_min3_f32 v245, v245, v229, v230
    v_max3_f32 v244, v244, v231, v232
    v_min3_f32 v245, v245, v231, v232
    v_max_f32 v244, v244, v233
    v_min_f32 v245, v245, v233
    s_add_u32 m0, s52, 122880
    s_nop 0
    buffer_load_dwordx4 v200, s[8:11], s81 offen lds
    v_mul_f32 v245, -1.0, v245
    s_nop 1
    v_permlane32_swap_b32 v244, v245
    v_max_f32 v244, v244, v245
    v_mov_b32 v245, v244
    s_nop 1
    v_permlane32_swap_b32 v244, v245
    v_mul_f32 v244, v244, v211
    v_mul_f32 v245, v245, v211
    v_fma_f32 v144, -v220, v211, -v245
    v_fma_f32 v145, -v221, v211, -v245
    v_fma_f32 v220, v220, v211, -v244
    v_fma_f32 v221, v221, v211, -v244
    v_fma_f32 v146, -v222, v211, -v245
    v_fma_f32 v147, -v223, v211, -v245
    v_fma_f32 v222, v222, v211, -v244
    v_fma_f32 v223, v223, v211, -v244
    v_fma_f32 v148, -v224, v211, -v245
    v_fma_f32 v149, -v225, v211, -v245
    v_fma_f32 v224, v224, v211, -v244
    v_fma_f32 v225, v225, v211, -v244
    v_fma_f32 v150, -v226, v211, -v245
    v_fma_f32 v151, -v227, v211, -v245
    v_fma_f32 v226, v226, v211, -v244
    v_fma_f32 v227, v227, v211, -v244
    v_fma_f32 v152, -v228, v211, -v245
    v_fma_f32 v153, -v229, v211, -v245
    v_fma_f32 v228, v228, v211, -v244
    v_fma_f32 v229, v229, v211, -v244
    v_fma_f32 v154, -v230, v211, -v245
    v_fma_f32 v155, -v231, v211, -v245
    v_fma_f32 v230, v230, v211, -v244
    v_fma_f32 v231, v231, v211, -v244
    v_fma_f32 v156, -v232, v211, -v245
    v_fma_f32 v157, -v233, v211, -v245
    v_fma_f32 v232, v232, v211, -v244
    v_fma_f32 v233, v233, v211, -v244
    v_exp_f32 v144, v144
    v_exp_f32 v220, v220
    v_exp_f32 v145, v145
    v_exp_f32 v221, v221
    v_exp_f32 v146, v146
    v_exp_f32 v222, v222
    v_exp_f32 v147, v147
    v_exp_f32 v223, v223
    v_exp_f32 v148, v148
    v_exp_f32 v224, v224
    v_exp_f32 v149, v149
    v_exp_f32 v225, v225
    v_exp_f32 v150, v150
    v_exp_f32 v226, v226
    v_exp_f32 v151, v151
    v_exp_f32 v227, v227
    v_exp_f32 v152, v152
    v_exp_f32 v228, v228
    v_exp_f32 v153, v153
    v_exp_f32 v229, v229
    v_exp_f32 v154, v154
    v_exp_f32 v230, v230
    v_exp_f32 v155, v155
    v_exp_f32 v231, v231
    v_exp_f32 v156, v156
    v_exp_f32 v232, v232
    v_exp_f32 v157, v157
    v_exp_f32 v233, v233
    v_add_f32 v246, v220, v222
    v_add_f32 v247, v221, v223
    v_add_f32 v248, v144, v146
    v_add_f32 v249, v145, v147
    v_add_f32 v246, v246, v224
    v_add_f32 v247, v247, v225
    v_add_f32 v248, v248, v148
    v_add_f32 v249, v249, v149
    v_add_f32 v246, v246, v226
    v_add_f32 v247, v247, v227
    v_add_f32 v248, v248, v150
    v_add_f32 v249, v249, v151
    v_add_f32 v246, v246, v228
    v_add_f32 v247, v247, v229
    v_add_f32 v248, v248, v152
    v_add_f32 v249, v249, v153
    v_add_f32 v246, v246, v230
    v_add_f32 v247, v247, v231
    v_add_f32 v248, v248, v154
    v_add_f32 v249, v249, v155
    v_add_f32 v246, v246, v232
    v_add_f32 v247, v247, v233
    v_add_f32 v248, v248, v156
    v_add_f32 v249, v249, v157
    v_add_f32 v247, v246, v247
    v_add_f32 v248, v248, v249
    s_nop 1
    v_permlane32_swap_b32 v247, v248
    v_add_f32 v247, v247, v248
    v_rcp_f32 v247, v247
    s_nop 0
    v_mov_b32 v248, v247
    s_nop 1
    v_permlane32_swap_b32 v247, v248
    v_mul_f32 v220, v220, v247
    v_mul_f32 v221, v221, v247
    v_mul_f32 v144, v144, v248
    v_mul_f32 v145, v145, v248
    v_mul_f32 v222, v222, v247
    v_mul_f32 v223, v223, v247
    v_mul_f32 v146, v146, v248
    v_mul_f32 v147, v147, v248
    v_mul_f32 v224, v224, v247
    v_mul_f32 v225, v225, v247
    v_mul_f32 v148, v148, v248
    v_mul_f32 v149, v149, v248
    v_mul_f32 v226, v226, v247
    v_mul_f32 v227, v227, v247
    v_mul_f32 v150, v150, v248
    v_mul_f32 v151, v151, v248
    v_mul_f32 v228, v228, v247
    v_mul_f32 v229, v229, v247
    v_mul_f32 v152, v152, v248
    v_mul_f32 v153, v153, v248
    v_mul_f32 v230, v230, v247
    v_mul_f32 v231, v231, v247
    v_mul_f32 v154, v154, v248
    v_mul_f32 v155, v155, v248
    v_mul_f32 v232, v232, v247
    v_mul_f32 v233, v233, v247
    v_mul_f32 v156, v156, v248
    v_mul_f32 v157, v157, v248
    v_cvt_pk_bf16_f32 v220, v220, v221
    v_cvt_pk_bf16_f32 v144, v144, v145
    v_cvt_pk_bf16_f32 v221, v222, v223
    v_cvt_pk_bf16_f32 v145, v146, v147
    v_cvt_pk_bf16_f32 v222, v224, v225
    v_cvt_pk_bf16_f32 v146, v148, v149
    v_cvt_pk_bf16_f32 v223, v226, v227
    v_cvt_pk_bf16_f32 v147, v150, v151
    v_cvt_pk_bf16_f32 v224, v228, v229
    v_cvt_pk_bf16_f32 v148, v152, v153
    v_cvt_pk_bf16_f32 v225, v230, v231
    v_cvt_pk_bf16_f32 v149, v154, v155
    v_cvt_pk_bf16_f32 v226, v232, v233
    v_cvt_pk_bf16_f32 v150, v156, v157
    v_mov_b32 v227, 0
    v_mov_b32 v151, 0
    v_bfe_u32 v252, v204, 4, 3
    v_bfe_u32 v253, v204, 7, 1
    v_lshlrev_b32 v253, 2, v253
    v_xor_b32 v252, v252, v253
    v_lshrrev_b32 v253, 9, v204
    v_xor_b32 v252, v252, v253
    v_lshlrev_b32 v252, 4, v252
    v_and_b32 v253, 0x1f0, v204
    v_lshl_add_u32 v252, v253, 3, v252
    s_lshl_b32 s94, s45, 12
    s_add_u32 s94, s94, 0
    v_add_u32 v252, s94, v252
    ds_write_b128 v252, v[220:223]
    v_xor_b32 v253, 32, v252
    ds_write_b128 v253, v[224:227]
    v_xor_b32 v253, 64, v252
    ds_write_b128 v253, v[144:147]
    v_xor_b32 v253, 96, v252
    ds_write_b128 v253, v[148:151]
    s_setprio 2
    s_waitcnt vmcnt(4)
    s_cmp_lg_u32 s44, 0
    s_cbranch_scc1 .ok11
    v_cmp_ne_u32 vcc, 0, v255
    s_and_b32 s99, vcc_lo, vcc_hi
    s_and_b32 s99, s99, -1
    s_cmp_eq_u32 s99, -1
    s_cbranch_scc1 .ok11
    s_mov_b32 s98, 20000
.sp12:
    buffer_load_dword v255, v254, s[36:39], 0 offen offset:128 sc1
    s_waitcnt vmcnt(0)
    v_cmp_ne_u32 vcc, 0, v255
    s_and_b32 s99, vcc_lo, vcc_hi
    s_and_b32 s99, s99, -1
    s_cmp_eq_u32 s99, -1
    s_cbranch_scc1 .ok11
    s_sub_u32 s98, s98, 1
    s_cmp_lg_u32 s98, 0
    s_cbranch_scc1 .sp12
.ok11:
    s_nop 1
    ds_read_b64_tr_b16 v[160:161], v196 offset:32768
    ds_read_b64_tr_b16 v[162:163], v196 offset:33280
    ds_read_b64_tr_b16 v[164:165], v197 offset:32768
    ds_read_b64_tr_b16 v[166:167], v197 offset:33280
    ds_read_b64_tr_b16 v[168:169], v198 offset:32768
    ds_read_b64_tr_b16 v[170:171], v198 offset:33280
    ds_read_b64_tr_b16 v[172:173], v199 offset:32768
    ds_read_b64_tr_b16 v[174:175], v199 offset:33280
    ds_read_b64_tr_b16 v[128:129], v196 offset:40960
    ds_read_b64_tr_b16 v[130:131], v196 offset:41472
    ds_read_b64_tr_b16 v[132:133], v197 offset:40960
    ds_read_b64_tr_b16 v[134:135], v197 offset:41472
    ds_read_b64_tr_b16 v[136:137], v198 offset:40960
    ds_read_b64_tr_b16 v[138:139], v198 offset:41472
    s_waitcnt lgkmcnt(14)
    s_barrier
    s_waitcnt lgkmcnt(12)
    v_mfma_f32_32x32x16_bf16 v[112:127], v[160:163], v[0:3], 0
    v_mfma_f32_16x16x32_bf16 v[180:183], v[176:179], v[160:163], 0
    ds_read_b64_tr_b16 v[140:141], v199 offset:40960
    ds_read_b64_tr_b16 v[142:143], v199 offset:41472
    s_add_u32 m0, s52, 131072
    s_nop 0
    buffer_load_dwordx4 v200, s[8:11], s82 offen lds
    v_lshrrev_b32 v248, 8, v204
    v_bfe_u32 v249, v204, 6, 2
    v_bfe_u32 v250, v204, 4, 2
    s_waitcnt lgkmcnt(12)
    v_mfma_f32_32x32x16_bf16 v[112:127], v[164:167], v[4:7], v[112:127]
    ds_read_b64_tr_b16 v[160:161], v196 offset:49152
    ds_read_b64_tr_b16 v[162:163], v196 offset:49664
    s_add_u32 m0, s52, 139264
    s_nop 0
    buffer_load_dwordx4 v200, s[8:11], s83 offen lds
    v_and_b32 v245, 1, v248
    v_lshlrev_b32 v245, 2, v245
    v_xor_b32 v244, v249, v245
    s_waitcnt lgkmcnt(12)
    v_mfma_f32_32x32x16_bf16 v[112:127], v[168:171], v[8:11], v[112:127]
    ds_read_b64_tr_b16 v[164:165], v197 offset:49152
    ds_read_b64_tr_b16 v[166:167], v197 offset:49664
    v_lshrrev_b32 v246, 1, v250
    v_lshl_add_u32 v246, s45, 1, v246
    v_xor_b32 v244, v244, v246
    s_waitcnt lgkmcnt(12)
    v_mfma_f32_32x32x16_bf16 v[112:127], v[172:175], v[12:15], v[112:127]
    ds_read_b64_tr_b16 v[168:169], v198 offset:49152
    ds_read_b64_tr_b16 v[170:171], v198 offset:49664
    v_lshlrev_b32 v244, 4, v244
    v_and_b32 v246, 1, v250
    v_lshl_add_u32 v244, v246, 3, v244
    s_waitcnt lgkmcnt(12)
    v_mfma_f32_32x32x16_bf16 v[112:127], v[128:131], v[16:19], v[112:127]
    v_mfma_f32_16x16x32_bf16 v[180:183], v[176:179], v[128:131], v[180:183]
    ds_read_b64_tr_b16 v[172:173], v199 offset:49152
    ds_read_b64_tr_b16 v[174:175], v199 offset:49664
    s_add_u32 m0, s52, 16384
    s_nop 0
    buffer_load_dwordx4 v200, s[8:11], s84 offen lds
    v_lshl_add_u32 v248, v248, 3, v249
    v_lshl_add_u32 v244, v248, 7, v244
    v_add_u32 v244, 0x0, v244
    s_waitcnt lgkmcnt(12)
    v_mfma_f32_32x32x16_bf16 v[112:127], v[132:135], v[20:23], v[112:127]
    ds_read_b64_tr_b16 v[128:129], v196 offset:57344
    ds_read_b64_tr_b16 v[130:131], v196 offset:57856
    v_or_b32 v246, 0, v250
    v_xor_b32 v246, v246, v245
    v_lshlrev_b32 v246, 3, v246
    s_waitcnt lgkmcnt(12)
    v_mfma_f32_32x32x16_bf16 v[112:127], v[136:139], v[24:27], v[112:127]
    ds_read_b64_tr_b16 v[132:133], v197 offset:57344
    ds_read_b64_tr_b16 v[134:135], v197 offset:57856
    v_lshl_add_u32 v246, v248, 6, v246
    v_add_u32 v246, 0x26000, v246
    v_xor_b32 v245, 64, v244
    s_waitcnt lgkmcnt(12)
    v_mfma_f32_32x32x16_bf16 v[112:127], v[140:143], v[28:31], v[112:127]
    ds_read_b64_tr_b16 v[136:137], v198 offset:57344
    ds_read_b64_tr_b16 v[138:139], v198 offset:57856
    v_xor_b32 v247, 8, v246
    ds_read_b64_tr_b16 v[220:221], v244 offset:0
    ds_read_b64_tr_b16 v[222:223], v245 offset:512
    s_waitcnt lgkmcnt(14)
    v_mfma_f32_32x32x16_bf16 v[112:127], v[160:163], v[32:35], v[112:127]
    v_mfma_f32_16x16x32_bf16 v[180:183], v[176:179], v[160:163], v[180:183]
    ds_read_b64_tr_b16 v[140:141], v199 offset:57344
    ds_read_b64_tr_b16 v[142:143], v199 offset:57856
    ds_read_b64_tr_b16 v[224:225], v246 offset:0
    ds_read_b64_tr_b16 v[226:227], v247 offset:256
    ds_read_b64_tr_b16 v[228:229], v244 offset:4096
    s_waitcnt lgkmcnt(15)
    v_mfma_f32_32x32x16_bf16 v[112:127], v[164:167], v[36:39], v[112:127]
    v_add_u32 v196, 0x10000, v196
    ds_read_b64_tr_b16 v[160:161], v196 offset:0
    ds_read_b64_tr_b16 v[162:163], v196 offset:512
    ds_read_b64_tr_b16 v[230:231], v245 offset:4608
    ds_read_b64_tr_b16 v[232:233], v246 offset:2048
    ds_read_b64_tr_b16 v[234:235], v247 offset:2304
    v_mfma_f32_32x32x16_bf16 v[112:127], v[168:171], v[40:43], v[112:127]
    v_add_u32 v197, 0x10000, v197
    ds_read_b64_tr_b16 v[164:165], v197 offset:0
    ds_read_b64_tr_b16 v[166:167], v197 offset:512
    s_waitcnt lgkmcnt(15)
    v_mfma_f32_32x32x16_bf16 v[112:127], v[172:175], v[44:47], v[112:127]
    v_add_u32 v198, 0x10000, v198
    ds_read_b64_tr_b16 v[168:169], v198 offset:0
    ds_read_b64_tr_b16 v[170:171], v198 offset:512
    s_waitcnt lgkmcnt(10)
    v_mfma_f32_16x16x32_bf16 v[236:239], v[220:223], v[224:227], 0
    s_waitcnt lgkmcnt(4)
    v_mfma_f32_16x16x32_bf16 v[236:239], v[228:231], v[232:235], v[236:239]
    ds_read_b64_tr_b16 v[220:221], v244 offset:8192
    v_mfma_f32_32x32x16_bf16 v[112:127], v[128:131], v[48:51], v[112:127]
    v_mfma_f32_16x16x32_bf16 v[180:183], v[176:179], v[128:131], v[180:183]
    v_add_u32 v199, 0x10000, v199
    ds_read_b64_tr_b16 v[172:173], v199 offset:0
    ds_read_b64_tr_b16 v[174:175], v199 offset:512
    ds_read_b64_tr_b16 v[222:223], v245 offset:8704
    ds_read_b64_tr_b16 v[224:225], v246 offset:4096
    ds_read_b64_tr_b16 v[226:227], v247 offset:4352
    v_mfma_f32_32x32x16_bf16 v[112:127], v[132:135], v[52:55], v[112:127]
    ds_read_b64_tr_b16 v[128:129], v196 offset:8192
    ds_read_b64_tr_b16 v[130:131], v196 offset:8704
    ds_read_b64_tr_b16 v[228:229], v244 offset:12288
    ds_read_b64_tr_b16 v[230:231], v245 offset:12800
    ds_read_b64_tr_b16 v[232:233], v246 offset:6144
    v_mfma_f32_32x32x16_bf16 v[112:127], v[136:139], v[56:59], v[112:127]
    ds_read_b64_tr_b16 v[132:133], v197 offset:8192
    ds_read_b64_tr_b16 v[134:135], v197 offset:8704
    ds_read_b64_tr_b16 v[234:235], v247 offset:6400
    v_mfma_f32_32x32x16_bf16 v[112:127], v[140:143], v[60:63], v[112:127]
    ds_read_b64_tr_b16 v[136:137], v198 offset:8192
    ds_read_b64_tr_b16 v[138:139], v198 offset:8704
    v_mfma_f32_32x32x16_bf16 v[112:127], v[160:163], v[64:67], v[112:127]
    v_mfma_f32_16x16x32_bf16 v[180:183], v[176:179], v[160:163], v[180:183]
    ds_read_b64_tr_b16 v[140:141], v199 offset:8192
    ds_read_b64_tr_b16 v[142:143], v199 offset:8704
    s_waitcnt lgkmcnt(12)
    v_mfma_f32_16x16x32_bf16 v[236:239], v[220:223], v[224:227], v[236:239]
    s_waitcnt lgkmcnt(4)
    v_mfma_f32_16x16x32_bf16 v[236:239], v[228:231], v[232:235], v[236:239]
    v_lshrrev_b32 v248, 8, v204
    v_mfma_f32_32x32x16_bf16 v[112:127], v[164:167], v[68:71], v[112:127]
    v_add_u32 v196, 0xffff0000, v196
    ds_read_b64_tr_b16 v[160:161], v196 offset:24576
    ds_read_b64_tr_b16 v[162:163], v196 offset:25088
    v_bfe_u32 v250, v204, 4, 4
    v_lshlrev_b32 v250, 2, v250
    v_lshl_add_u32 v248, v248, 9, v250
    v_mfma_f32_32x32x16_bf16 v[112:127], v[168:171], v[72:75], v[112:127]
    v_add_u32 v197, 0xffff0000, v197
    ds_read_b64_tr_b16 v[164:165], v197 offset:24576
    ds_read_b64_tr_b16 v[166:167], v197 offset:25088
    s_lshl_b32 s94, s50, 13
    s_lshl_b32 s95, s45, 11
    s_add_u32 s94, s94, s95
    s_add_u32 s94, s94, 10485760
    v_mfma_f32_32x32x16_bf16 v[112:127], v[172:175], v[76:79], v[112:127]
    v_add_u32 v198, 0xffff0000, v198
    ds_read_b64_tr_b16 v[168:169], v198 offset:24576
    ds_read_b64_tr_b16 v[170:171], v198 offset:25088
    v_mfma_f32_32x32x16_bf16 v[112:127], v[128:131], v[80:83], v[112:127]
    v_mfma_f32_16x16x32_bf16 v[180:183], v[176:179], v[128:131], v[180:183]
    v_add_u32 v199, 0xffff0000, v199
    ds_read_b64_tr_b16 v[172:173], v199 offset:24576
    ds_read_b64_tr_b16 v[174:175], v199 offset:25088
    buffer_atomic_add_f32 v236, v248, s[40:43], s94 offen offset:0
    buffer_atomic_add_f32 v237, v248, s[40:43], s94 offen offset:128
    buffer_atomic_add_f32 v238, v248, s[40:43], s94 offen offset:256
    v_mfma_f32_32x32x16_bf16 v[112:127], v[132:135], v[84:87], v[112:127]
    buffer_atomic_add_f32 v239, v248, s[40:43], s94 offen offset:384
    s_waitcnt lgkmcnt(10)
    v_mfma_f32_32x32x16_bf16 v[112:127], v[136:139], v[88:91], v[112:127]
    s_waitcnt lgkmcnt(8)
    v_mfma_f32_32x32x16_bf16 v[112:127], v[140:143], v[92:95], v[112:127]
    s_waitcnt lgkmcnt(6)
    v_mfma_f32_32x32x16_bf16 v[112:127], v[160:163], v[96:99], v[112:127]
    v_mfma_f32_16x16x32_bf16 v[180:183], v[176:179], v[160:163], v[180:183]
    s_waitcnt lgkmcnt(4)
    v_mfma_f32_32x32x16_bf16 v[112:127], v[164:167], v[100:103], v[112:127]
    s_waitcnt lgkmcnt(2)
    v_mfma_f32_32x32x16_bf16 v[112:127], v[168:171], v[104:107], v[112:127]
    s_nop 3
    ds_write_b32 v206, v180 offset:2048
    s_waitcnt lgkmcnt(1)
    v_mfma_f32_32x32x16_bf16 v[112:127], v[172:175], v[108:111], v[112:127]
    s_waitcnt vmcnt(4) lgkmcnt(0)
    s_barrier
    s_setprio 3
    ds_read_b128 v[236:239], v201 offset:0
    ds_read_b128 v[240:243], v201 offset:1024
    ds_read_b64 v[228:229], v207 offset:2048
    s_waitcnt lgkmcnt(0)
    v_add_f32 v228, v228, v229
    s_nop 1
    v_mfma_f32_32x32x2_f32 v[112:127], v228, v208, v[112:127]
    s_nop 15
    s_nop 3
    v_cvt_pk_bf16_f32 v112, v112, v113
    v_cvt_pk_bf16_f32 v113, v114, v115
    v_cvt_pk_bf16_f32 v114, v116, v117
    v_cvt_pk_bf16_f32 v115, v118, v119
    v_add_u32 v200, 112, v200
    s_add_u32 m0, s52, 32768
    s_nop 0
    buffer_load_dwordx4 v200, s[8:11], s78 offen lds
    v_cvt_pk_bf16_f32 v116, v120, v121
    v_cvt_pk_bf16_f32 v117, v122, v123
    v_cvt_pk_bf16_f32 v118, v124, v125
    v_cvt_pk_bf16_f32 v119, v126, v127
    v_mfma_f32_32x32x16_bf16 v[220:235], v[236:239], v[112:115], 0
    s_nop 0
    v_mfma_f32_32x32x16_bf16 v[220:235], v[240:243], v[116:119], v[220:235]
    s_setprio 0
    s_nop 10
    v_max3_f32 v244, v220, v221, v222
    s_add_u32 m0, s52, 40960
    s_nop 0
    buffer_load_dwordx4 v200, s[8:11], s79 offen lds
    v_min3_f32 v245, v220, v221, v222
    v_max3_f32 v244, v244, v223, v224
    v_min3_f32 v245, v245, v223, v224
    v_max3_f32 v244, v244, v225, v226
    v_min3_f32 v245, v245, v225, v226
    v_max3_f32 v244, v244, v227, v228
    v_min3_f32 v245, v245, v227, v228
    v_max3_f32 v244, v244, v229, v230
    v_min3_f32 v245, v245, v229, v230
    v_max3_f32 v244, v244, v231, v232
    s_add_u32 m0, s52, 49152
    s_nop 0
    buffer_load_dwordx4 v200, s[8:11], s80 offen lds
    v_min3_f32 v245, v245, v231, v232
    v_max_f32 v244, v244, v233
    v_min_f32 v245, v245, v233
    v_mul_f32 v245, -1.0, v245
    s_nop 1
    v_permlane32_swap_b32 v244, v245
    v_max_f32 v244, v244, v245
    v_mov_b32 v245, v244
    s_nop 1
    v_permlane32_swap_b32 v244, v245
    s_add_u32 m0, s52, 57344
    s_nop 0
    buffer_load_dwordx4 v200, s[8:11], s81 offen lds
    v_mul_f32 v244, v244, v211
    v_mul_f32 v245, v245, v211
    v_fma_f32 v112, -v220, v211, -v245
    v_fma_f32 v113, -v221, v211, -v245
    v_fma_f32 v220, v220, v211, -v244
    v_fma_f32 v221, v221, v211, -v244
    v_fma_f32 v114, -v222, v211, -v245
    v_fma_f32 v115, -v223, v211, -v245
    v_fma_f32 v222, v222, v211, -v244
    v_fma_f32 v223, v223, v211, -v244
    v_fma_f32 v116, -v224, v211, -v245
    v_fma_f32 v117, -v225, v211, -v245
    v_fma_f32 v224, v224, v211, -v244
    v_fma_f32 v225, v225, v211, -v244
    v_fma_f32 v118, -v226, v211, -v245
    v_fma_f32 v119, -v227, v211, -v245
    v_fma_f32 v226, v226, v211, -v244
    v_fma_f32 v227, v227, v211, -v244
    v_fma_f32 v120, -v228, v211, -v245
    v_fma_f32 v121, -v229, v211, -v245
    v_fma_f32 v228, v228, v211, -v244
    v_fma_f32 v229, v229, v211, -v244
    v_fma_f32 v122, -v230, v211, -v245
    v_fma_f32 v123, -v231, v211, -v245
    v_fma_f32 v230, v230, v211, -v244
    v_fma_f32 v231, v231, v211, -v244
    v_fma_f32 v124, -v232, v211, -v245
    v_fma_f32 v125, -v233, v211, -v245
    v_fma_f32 v232, v232, v211, -v244
    v_fma_f32 v233, v233, v211, -v244
    v_exp_f32 v112, v112
    v_exp_f32 v220, v220
    v_exp_f32 v113, v113
    v_exp_f32 v221, v221
    v_exp_f32 v114, v114
    v_exp_f32 v222, v222
    v_exp_f32 v115, v115
    s_lshl_b32 s95, s50, 9
    s_lshl_b32 s94, s47, 5
    s_add_u32 s95, s95, s94
    s_lshl_b32 s94, s44, 2
    s_add_u32 s95, s95, s94
    s_add_u32 s95, s95, 10637312
    v_mov_b32 v255, 1
    s_waitcnt vmcnt(4)
    buffer_store_dword v255, v205, s[40:43], s95 offen sc1
    v_exp_f32 v223, v223
    v_exp_f32 v116, v116
    v_exp_f32 v224, v224
    v_exp_f32 v117, v117
    v_exp_f32 v225, v225
    v_exp_f32 v118, v118
    v_exp_f32 v226, v226
    v_exp_f32 v119, v119
    v_exp_f32 v227, v227
    v_exp_f32 v120, v120
    v_exp_f32 v228, v228
    v_exp_f32 v121, v121
    v_exp_f32 v229, v229
    v_exp_f32 v122, v122
    v_exp_f32 v230, v230
    v_exp_f32 v123, v123
    v_exp_f32 v231, v231
    v_exp_f32 v124, v124
    v_exp_f32 v232, v232
    v_exp_f32 v125, v125
    v_exp_f32 v233, v233
    v_cvt_pk_bf16_f32 v144, v220, v221
    v_cvt_pk_bf16_f32 v152, v112, v113
    v_cvt_pk_bf16_f32 v145, v222, v223
    v_cvt_pk_bf16_f32 v153, v114, v115
    v_cvt_pk_bf16_f32 v146, v224, v225
    v_cvt_pk_bf16_f32 v154, v116, v117
    v_cvt_pk_bf16_f32 v147, v226, v227
    v_cvt_pk_bf16_f32 v155, v118, v119
    v_cvt_pk_bf16_f32 v148, v228, v229
    v_cvt_pk_bf16_f32 v156, v120, v121
    v_cvt_pk_bf16_f32 v149, v230, v231
    v_cvt_pk_bf16_f32 v157, v122, v123
    v_cvt_pk_bf16_f32 v150, v232, v233
    v_cvt_pk_bf16_f32 v158, v124, v125
    v_mov_b32 v151, 0
    v_mov_b32 v159, 0
    s_setprio 2
    v_add_u32 v196, 0x10000, v196
    ds_read_b64_tr_b16 v[160:161], v196 offset:32768
    ds_read_b64_tr_b16 v[162:163], v196 offset:33280
    v_add_u32 v197, 0x10000, v197
    ds_read_b64_tr_b16 v[164:165], v197 offset:32768
    ds_read_b64_tr_b16 v[166:167], v197 offset:33280
    v_add_u32 v198, 0x10000, v198
    ds_read_b64_tr_b16 v[168:169], v198 offset:32768
    ds_read_b64_tr_b16 v[170:171], v198 offset:33280
    v_add_u32 v199, 0x10000, v199
    ds_read_b64_tr_b16 v[172:173], v199 offset:32768
    ds_read_b64_tr_b16 v[174:175], v199 offset:33280
    ds_read_b64_tr_b16 v[128:129], v196 offset:40960
    ds_read_b64_tr_b16 v[130:131], v196 offset:41472
    ds_read_b64_tr_b16 v[132:133], v197 offset:40960
    ds_read_b64_tr_b16 v[134:135], v197 offset:41472
    ds_read_b64_tr_b16 v[136:137], v198 offset:40960
    ds_read_b64_tr_b16 v[138:139], v198 offset:41472
    s_barrier
    s_waitcnt lgkmcnt(12)
    v_mfma_f32_32x32x16_bf16 v[112:127], v[160:163], v[0:3], 0
    v_mfma_f32_16x16x32_bf16 v[180:183], v[176:179], v[160:163], 0
    ds_read_b64_tr_b16 v[140:141], v199 offset:40960
    ds_read_b64_tr_b16 v[142:143], v199 offset:41472
    s_add_u32 m0, s52, 65536
    s_nop 0
    buffer_load_dwordx4 v200, s[8:11], s82 offen lds
    s_waitcnt lgkmcnt(12)
    v_mfma_f32_32x32x16_bf16 v[112:127], v[164:167], v[4:7], v[112:127]
    ds_read_b64_tr_b16 v[160:161], v196 offset:49152
    ds_read_b64_tr_b16 v[162:163], v196 offset:49664
    s_add_u32 m0, s52, 73728
    s_nop 0
    buffer_load_dwordx4 v200, s[8:11], s83 offen lds
    s_waitcnt lgkmcnt(12)
    v_mfma_f32_32x32x16_bf16 v[112:127], v[168:171], v[8:11], v[112:127]
    ds_read_b64_tr_b16 v[164:165], v197 offset:49152
    ds_read_b64_tr_b16 v[166:167], v197 offset:49664
    s_waitcnt lgkmcnt(12)
    v_mfma_f32_32x32x16_bf16 v[112:127], v[172:175], v[12:15], v[112:127]
    ds_read_b64_tr_b16 v[168:169], v198 offset:49152
    ds_read_b64_tr_b16 v[170:171], v198 offset:49664
    s_waitcnt lgkmcnt(12)
    v_mfma_f32_32x32x16_bf16 v[112:127], v[128:131], v[16:19], v[112:127]
    v_mfma_f32_16x16x32_bf16 v[180:183], v[176:179], v[128:131], v[180:183]
    ds_read_b64_tr_b16 v[172:173], v199 offset:49152
    ds_read_b64_tr_b16 v[174:175], v199 offset:49664
    s_add_u32 m0, s52, 24576
    s_nop 0
    buffer_load_dwordx4 v200, s[8:11], s84 offen lds
    s_waitcnt lgkmcnt(12)
    v_mfma_f32_32x32x16_bf16 v[112:127], v[132:135], v[20:23], v[112:127]
    ds_read_b64_tr_b16 v[128:129], v196 offset:57344
    ds_read_b64_tr_b16 v[130:131], v196 offset:57856
    s_waitcnt lgkmcnt(12)
    v_mfma_f32_32x32x16_bf16 v[112:127], v[136:139], v[24:27], v[112:127]
    ds_read_b64_tr_b16 v[132:133], v197 offset:57344
    ds_read_b64_tr_b16 v[134:135], v197 offset:57856
    s_waitcnt lgkmcnt(12)
    v_mfma_f32_32x32x16_bf16 v[112:127], v[140:143], v[28:31], v[112:127]
    ds_read_b64_tr_b16 v[136:137], v198 offset:57344
    ds_read_b64_tr_b16 v[138:139], v198 offset:57856
    s_waitcnt lgkmcnt(12)
    v_mfma_f32_32x32x16_bf16 v[112:127], v[160:163], v[32:35], v[112:127]
    v_mfma_f32_16x16x32_bf16 v[180:183], v[176:179], v[160:163], v[180:183]
    ds_read_b64_tr_b16 v[140:141], v199 offset:57344
    ds_read_b64_tr_b16 v[142:143], v199 offset:57856
    s_waitcnt lgkmcnt(12)
    v_mfma_f32_32x32x16_bf16 v[112:127], v[164:167], v[36:39], v[112:127]
    v_add_u32 v196, 0x10000, v196
    ds_read_b64_tr_b16 v[160:161], v196 offset:0
    ds_read_b64_tr_b16 v[162:163], v196 offset:512
    s_waitcnt lgkmcnt(12)
    v_mfma_f32_32x32x16_bf16 v[112:127], v[168:171], v[40:43], v[112:127]
    v_add_u32 v197, 0x10000, v197
    ds_read_b64_tr_b16 v[164:165], v197 offset:0
    ds_read_b64_tr_b16 v[166:167], v197 offset:512
    s_waitcnt lgkmcnt(12)
    v_mfma_f32_32x32x16_bf16 v[112:127], v[172:175], v[44:47], v[112:127]
    v_add_u32 v198, 0x10000, v198
    ds_read_b64_tr_b16 v[168:169], v198 offset:0
    ds_read_b64_tr_b16 v[170:171], v198 offset:512
    s_waitcnt lgkmcnt(12)
    v_mfma_f32_32x32x16_bf16 v[112:127], v[128:131], v[48:51], v[112:127]
    v_mfma_f32_16x16x32_bf16 v[180:183], v[176:179], v[128:131], v[180:183]
    v_add_u32 v199, 0x10000, v199
    ds_read_b64_tr_b16 v[172:173], v199 offset:0
    ds_read_b64_tr_b16 v[174:175], v199 offset:512
    s_waitcnt lgkmcnt(12)
    v_mfma_f32_32x32x16_bf16 v[112:127], v[132:135], v[52:55], v[112:127]
    ds_read_b64_tr_b16 v[128:129], v196 offset:8192
    ds_read_b64_tr_b16 v[130:131], v196 offset:8704
    s_waitcnt lgkmcnt(12)
    v_mfma_f32_32x32x16_bf16 v[112:127], v[136:139], v[56:59], v[112:127]
    ds_read_b64_tr_b16 v[132:133], v197 offset:8192
    ds_read_b64_tr_b16 v[134:135], v197 offset:8704
    s_waitcnt lgkmcnt(12)
    v_mfma_f32_32x32x16_bf16 v[112:127], v[140:143], v[60:63], v[112:127]
    ds_read_b64_tr_b16 v[136:137], v198 offset:8192
    ds_read_b64_tr_b16 v[138:139], v198 offset:8704
    s_waitcnt lgkmcnt(12)
    v_mfma_f32_32x32x16_bf16 v[112:127], v[160:163], v[64:67], v[112:127]
    v_mfma_f32_16x16x32_bf16 v[180:183], v[176:179], v[160:163], v[180:183]
    ds_read_b64_tr_b16 v[140:141], v199 offset:8192
    ds_read_b64_tr_b16 v[142:143], v199 offset:8704
    s_waitcnt lgkmcnt(12)
    v_mfma_f32_32x32x16_bf16 v[112:127], v[164:167], v[68:71], v[112:127]
    v_add_u32 v196, 0xfffe0000, v196
    ds_read_b64_tr_b16 v[160:161], v196 offset:16384
    ds_read_b64_tr_b16 v[162:163], v196 offset:16896
    s_waitcnt lgkmcnt(12)
    v_mfma_f32_32x32x16_bf16 v[112:127], v[168:171], v[72:75], v[112:127]
    v_add_u32 v197, 0xfffe0000, v197
    ds_read_b64_tr_b16 v[164:165], v197 offset:16384
    ds_read_b64_tr_b16 v[166:167], v197 offset:16896
    s_waitcnt lgkmcnt(12)
    v_mfma_f32_32x32x16_bf16 v[112:127], v[172:175], v[76:79], v[112:127]
    v_add_u32 v198, 0xfffe0000, v198
    ds_read_b64_tr_b16 v[168:169], v198 offset:16384
    ds_read_b64_tr_b16 v[170:171], v198 offset:16896
    s_waitcnt lgkmcnt(12)
    v_mfma_f32_32x32x16_bf16 v[112:127], v[128:131], v[80:83], v[112:127]
    v_mfma_f32_16x16x32_bf16 v[180:183], v[176:179], v[128:131], v[180:183]
    v_add_u32 v199, 0xfffe0000, v199
    ds_read_b64_tr_b16 v[172:173], v199 offset:16384
    ds_read_b64_tr_b16 v[174:175], v199 offset:16896
    s_waitcnt lgkmcnt(12)
    v_mfma_f32_32x32x16_bf16 v[112:127], v[132:135], v[84:87], v[112:127]
    s_waitcnt lgkmcnt(10)
    v_mfma_f32_32x32x16_bf16 v[112:127], v[136:139], v[88:91], v[112:127]
    s_waitcnt lgkmcnt(8)
    v_mfma_f32_32x32x16_bf16 v[112:127], v[140:143], v[92:95], v[112:127]
    s_waitcnt lgkmcnt(6)
    v_mfma_f32_32x32x16_bf16 v[112:127], v[160:163], v[96:99], v[112:127]
    v_mfma_f32_16x16x32_bf16 v[180:183], v[176:179], v[160:163], v[180:183]
    s_waitcnt lgkmcnt(4)
    v_mfma_f32_32x32x16_bf16 v[112:127], v[164:167], v[100:103], v[112:127]
    s_waitcnt lgkmcnt(2)
    v_mfma_f32_32x32x16_bf16 v[112:127], v[168:171], v[104:107], v[112:127]
    s_nop 3
    ds_write_b32 v206, v180 offset:0
    s_waitcnt lgkmcnt(1)
    v_mfma_f32_32x32x16_bf16 v[112:127], v[172:175], v[108:111], v[112:127]
    s_waitcnt vmcnt(0) lgkmcnt(0)
    s_barrier
    s_setprio 3
    ds_read_b128 v[236:239], v201 offset:4096
    ds_read_b128 v[240:243], v201 offset:5120
    ds_read_b64 v[228:229], v207 offset:0
    s_waitcnt lgkmcnt(0)
    v_add_f32 v228, v228, v229
    s_nop 1
    v_mfma_f32_32x32x2_f32 v[112:127], v228, v208, v[112:127]
    s_nop 15
    s_nop 3
    v_cvt_pk_bf16_f32 v112, v112, v113
    v_cvt_pk_bf16_f32 v113, v114, v115
    v_cvt_pk_bf16_f32 v114, v116, v117
    v_cvt_pk_bf16_f32 v115, v118, v119
    v_add_u32 v200, 112, v200
    s_add_u32 m0, s52, 98304
    s_nop 0
    buffer_load_dwordx4 v200, s[8:11], s78 offen lds
    v_cvt_pk_bf16_f32 v116, v120, v121
    v_cvt_pk_bf16_f32 v117, v122, v123
    v_cvt_pk_bf16_f32 v118, v124, v125
    v_cvt_pk_bf16_f32 v119, v126, v127
    v_mfma_f32_32x32x16_bf16 v[220:235], v[236:239], v[112:115], 0
    s_nop 0
    v_mfma_f32_32x32x16_bf16 v[220:235], v[240:243], v[116:119], v[220:235]
    s_setprio 0
    s_nop 10
    v_max3_f32 v244, v220, v221, v222
    s_add_u32 m0, s52, 106496
    s_nop 0
    buffer_load_dwordx4 v200, s[8:11], s79 offen lds
    v_min3_f32 v245, v220, v221, v222
    v_max3_f32 v244, v244, v223, v224
    v_min3_f32 v245, v245, v223, v224
    v_max3_f32 v244, v244, v225, v226
    v_min3_f32 v245, v245, v225, v226
    v_max3_f32 v244, v244, v227, v228
    v_min3_f32 v245, v245, v227, v228
    v_max3_f32 v244, v244, v229, v230
    v_min3_f32 v245, v245, v229, v230
    v_max3_f32 v244, v244, v231, v232
    s_add_u32 m0, s52, 114688
    s_nop 0
    buffer_load_dwordx4 v200, s[8:11], s80 offen lds
    v_min3_f32 v245, v245, v231, v232
    v_max_f32 v244, v244, v233
    v_min_f32 v245, v245, v233
    v_mul_f32 v245, -1.0, v245
    s_nop 1
    v_permlane32_swap_b32 v244, v245
    v_max_f32 v244, v244, v245
    v_mov_b32 v245, v244
    s_nop 1
    v_permlane32_swap_b32 v244, v245
    s_add_u32 m0, s52, 122880
    s_nop 0
    buffer_load_dwordx4 v200, s[8:11], s81 offen lds
    v_mul_f32 v244, v244, v211
    v_mul_f32 v245, v245, v211
    v_fma_f32 v112, -v220, v211, -v245
    v_fma_f32 v113, -v221, v211, -v245
    v_fma_f32 v220, v220, v211, -v244
    v_fma_f32 v221, v221, v211, -v244
    v_fma_f32 v114, -v222, v211, -v245
    v_fma_f32 v115, -v223, v211, -v245
    v_fma_f32 v222, v222, v211, -v244
    v_fma_f32 v223, v223, v211, -v244
    v_fma_f32 v116, -v224, v211, -v245
    v_fma_f32 v117, -v225, v211, -v245
    v_fma_f32 v224, v224, v211, -v244
    v_fma_f32 v225, v225, v211, -v244
    v_fma_f32 v118, -v226, v211, -v245
    v_fma_f32 v119, -v227, v211, -v245
    v_fma_f32 v226, v226, v211, -v244
    v_fma_f32 v227, v227, v211, -v244
    v_fma_f32 v120, -v228, v211, -v245
    v_fma_f32 v121, -v229, v211, -v245
    v_fma_f32 v228, v228, v211, -v244
    v_fma_f32 v229, v229, v211, -v244
    v_fma_f32 v122, -v230, v211, -v245
    v_fma_f32 v123, -v231, v211, -v245
    v_fma_f32 v230, v230, v211, -v244
    v_fma_f32 v231, v231, v211, -v244
    v_fma_f32 v124, -v232, v211, -v245
    v_fma_f32 v125, -v233, v211, -v245
    v_fma_f32 v232, v232, v211, -v244
    v_fma_f32 v233, v233, v211, -v244
    v_exp_f32 v112, v112
    v_exp_f32 v220, v220
    v_exp_f32 v113, v113
    v_exp_f32 v221, v221
    v_exp_f32 v114, v114
    v_exp_f32 v222, v222
    v_exp_f32 v115, v115
    v_exp_f32 v223, v223
    v_exp_f32 v116, v116
    v_exp_f32 v224, v224
    v_exp_f32 v117, v117
    v_exp_f32 v225, v225
    v_exp_f32 v118, v118
    v_exp_f32 v226, v226
    v_exp_f32 v119, v119
    v_exp_f32 v227, v227
    v_exp_f32 v120, v120
    v_exp_f32 v228, v228
    v_exp_f32 v121, v121
    v_exp_f32 v229, v229
    v_exp_f32 v122, v122
    v_exp_f32 v230, v230
    v_exp_f32 v123, v123
    v_exp_f32 v231, v231
    v_exp_f32 v124, v124
    v_exp_f32 v232, v232
    v_exp_f32 v125, v125
    v_exp_f32 v233, v233
    v_cvt_pk_bf16_f32 v188, v220, v221
    v_cvt_pk_bf16_f32 v212, v112, v113
    v_cvt_pk_bf16_f32 v189, v222, v223
    v_cvt_pk_bf16_f32 v213, v114, v115
    v_cvt_pk_bf16_f32 v190, v224, v225
    v_cvt_pk_bf16_f32 v214, v116, v117
    v_cvt_pk_bf16_f32 v191, v226, v227
    v_cvt_pk_bf16_f32 v215, v118, v119
    v_cvt_pk_bf16_f32 v192, v228, v229
    v_cvt_pk_bf16_f32 v216, v120, v121
    v_cvt_pk_bf16_f32 v193, v230, v231
    v_cvt_pk_bf16_f32 v217, v122, v123
    v_cvt_pk_bf16_f32 v194, v232, v233
    v_cvt_pk_bf16_f32 v218, v124, v125
    v_mov_b32 v195, 0
    v_mov_b32 v219, 0
    s_setprio 2
    ds_read_b64_tr_b16 v[160:161], v196 offset:32768
    ds_read_b64_tr_b16 v[162:163], v196 offset:33280
    ds_read_b64_tr_b16 v[164:165], v197 offset:32768
    ds_read_b64_tr_b16 v[166:167], v197 offset:33280
    ds_read_b64_tr_b16 v[168:169], v198 offset:32768
    ds_read_b64_tr_b16 v[170:171], v198 offset:33280
    ds_read_b64_tr_b16 v[172:173], v199 offset:32768
    ds_read_b64_tr_b16 v[174:175], v199 offset:33280
    ds_read_b64_tr_b16 v[128:129], v196 offset:40960
    ds_read_b64_tr_b16 v[130:131], v196 offset:41472
    ds_read_b64_tr_b16 v[132:133], v197 offset:40960
    ds_read_b64_tr_b16 v[134:135], v197 offset:41472
    ds_read_b64_tr_b16 v[136:137], v198 offset:40960
    ds_read_b64_tr_b16 v[138:139], v198 offset:41472
    s_barrier
    s_waitcnt lgkmcnt(12)
    v_mfma_f32_32x32x16_bf16 v[112:127], v[160:163], v[0:3], 0
    v_mfma_f32_16x16x32_bf16 v[180:183], v[176:179], v[160:163], 0
    ds_read_b64_tr_b16 v[140:141], v199 offset:40960
    ds_read_b64_tr_b16 v[142:143], v199 offset:41472
    s_add_u32 m0, s52, 131072
    s_nop 0
    buffer_load_dwordx4 v200, s[8:11], s82 offen lds
    s_waitcnt lgkmcnt(12)
    v_mfma_f32_32x32x16_bf16 v[112:127], v[164:167], v[4:7], v[112:127]
    ds_read_b64_tr_b16 v[160:161], v196 offset:49152
    ds_read_b64_tr_b16 v[162:163], v196 offset:49664
    s_add_u32 m0, s52, 139264
    s_nop 0
    buffer_load_dwordx4 v200, s[8:11], s83 offen lds
    s_waitcnt lgkmcnt(12)
    v_mfma_f32_32x32x16_bf16 v[112:127], v[168:171], v[8:11], v[112:127]
    ds_read_b64_tr_b16 v[164:165], v197 offset:49152
    ds_read_b64_tr_b16 v[166:167], v197 offset:49664
    s_waitcnt lgkmcnt(12)
    v_mfma_f32_32x32x16_bf16 v[112:127], v[172:175], v[12:15], v[112:127]
    ds_read_b64_tr_b16 v[168:169], v198 offset:49152
    ds_read_b64_tr_b16 v[170:171], v198 offset:49664
    s_waitcnt lgkmcnt(12)
    v_mfma_f32_32x32x16_bf16 v[112:127], v[128:131], v[16:19], v[112:127]
    v_mfma_f32_16x16x32_bf16 v[180:183], v[176:179], v[128:131], v[180:183]
    ds_read_b64_tr_b16 v[172:173], v199 offset:49152
    ds_read_b64_tr_b16 v[174:175], v199 offset:49664
    s_add_u32 m0, s52, 16384
    s_nop 0
    buffer_load_dwordx4 v200, s[8:11], s84 offen lds
    s_waitcnt lgkmcnt(12)
    v_mfma_f32_32x32x16_bf16 v[112:127], v[132:135], v[20:23], v[112:127]
    ds_read_b64_tr_b16 v[128:129], v196 offset:57344
    ds_read_b64_tr_b16 v[130:131], v196 offset:57856
    s_waitcnt lgkmcnt(12)
    v_mfma_f32_32x32x16_bf16 v[112:127], v[136:139], v[24:27], v[112:127]
    ds_read_b64_tr_b16 v[132:133], v197 offset:57344
    ds_read_b64_tr_b16 v[134:135], v197 offset:57856
    s_waitcnt lgkmcnt(12)
    v_mfma_f32_32x32x16_bf16 v[112:127], v[140:143], v[28:31], v[112:127]
    ds_read_b64_tr_b16 v[136:137], v198 offset:57344
    ds_read_b64_tr_b16 v[138:139], v198 offset:57856
    s_waitcnt lgkmcnt(12)
    v_mfma_f32_32x32x16_bf16 v[112:127], v[160:163], v[32:35], v[112:127]
    v_mfma_f32_16x16x32_bf16 v[180:183], v[176:179], v[160:163], v[180:183]
    ds_read_b64_tr_b16 v[140:141], v199 offset:57344
    ds_read_b64_tr_b16 v[142:143], v199 offset:57856
    s_waitcnt lgkmcnt(12)
    v_mfma_f32_32x32x16_bf16 v[112:127], v[164:167], v[36:39], v[112:127]
    v_add_u32 v196, 0x10000, v196
    ds_read_b64_tr_b16 v[160:161], v196 offset:0
    ds_read_b64_tr_b16 v[162:163], v196 offset:512
    s_waitcnt lgkmcnt(12)
    v_mfma_f32_32x32x16_bf16 v[112:127], v[168:171], v[40:43], v[112:127]
    v_add_u32 v197, 0x10000, v197
    ds_read_b64_tr_b16 v[164:165], v197 offset:0
    ds_read_b64_tr_b16 v[166:167], v197 offset:512
    s_waitcnt lgkmcnt(12)
    v_mfma_f32_32x32x16_bf16 v[112:127], v[172:175], v[44:47], v[112:127]
    v_add_u32 v198, 0x10000, v198
    ds_read_b64_tr_b16 v[168:169], v198 offset:0
    ds_read_b64_tr_b16 v[170:171], v198 offset:512
    s_waitcnt lgkmcnt(12)
    v_mfma_f32_32x32x16_bf16 v[112:127], v[128:131], v[48:51], v[112:127]
    v_mfma_f32_16x16x32_bf16 v[180:183], v[176:179], v[128:131], v[180:183]
    v_add_u32 v199, 0x10000, v199
    ds_read_b64_tr_b16 v[172:173], v199 offset:0
    ds_read_b64_tr_b16 v[174:175], v199 offset:512
    s_waitcnt lgkmcnt(12)
    v_mfma_f32_32x32x16_bf16 v[112:127], v[132:135], v[52:55], v[112:127]
    ds_read_b64_tr_b16 v[128:129], v196 offset:8192
    ds_read_b64_tr_b16 v[130:131], v196 offset:8704
    s_waitcnt lgkmcnt(12)
    v_mfma_f32_32x32x16_bf16 v[112:127], v[136:139], v[56:59], v[112:127]
    ds_read_b64_tr_b16 v[132:133], v197 offset:8192
    ds_read_b64_tr_b16 v[134:135], v197 offset:8704
    s_waitcnt lgkmcnt(12)
    v_mfma_f32_32x32x16_bf16 v[112:127], v[140:143], v[60:63], v[112:127]
    ds_read_b64_tr_b16 v[136:137], v198 offset:8192
    ds_read_b64_tr_b16 v[138:139], v198 offset:8704
    s_waitcnt lgkmcnt(12)
    v_mfma_f32_32x32x16_bf16 v[112:127], v[160:163], v[64:67], v[112:127]
    v_mfma_f32_16x16x32_bf16 v[180:183], v[176:179], v[160:163], v[180:183]
    ds_read_b64_tr_b16 v[140:141], v199 offset:8192
    ds_read_b64_tr_b16 v[142:143], v199 offset:8704
    s_waitcnt lgkmcnt(12)
    v_mfma_f32_32x32x16_bf16 v[112:127], v[164:167], v[68:71], v[112:127]
    v_add_u32 v196, 0xffff0000, v196
    ds_read_b64_tr_b16 v[160:161], v196 offset:24576
    ds_read_b64_tr_b16 v[162:163], v196 offset:25088
    s_waitcnt lgkmcnt(12)
    v_mfma_f32_32x32x16_bf16 v[112:127], v[168:171], v[72:75], v[112:127]
    v_add_u32 v197, 0xffff0000, v197
    ds_read_b64_tr_b16 v[164:165], v197 offset:24576
    ds_read_b64_tr_b16 v[166:167], v197 offset:25088
    s_waitcnt lgkmcnt(12)
    v_mfma_f32_32x32x16_bf16 v[112:127], v[172:175], v[76:79], v[112:127]
    v_add_u32 v198, 0xffff0000, v198
    ds_read_b64_tr_b16 v[168:169], v198 offset:24576
    ds_read_b64_tr_b16 v[170:171], v198 offset:25088
    s_waitcnt lgkmcnt(12)
    v_mfma_f32_32x32x16_bf16 v[112:127], v[128:131], v[80:83], v[112:127]
    v_mfma_f32_16x16x32_bf16 v[180:183], v[176:179], v[128:131], v[180:183]
    v_add_u32 v199, 0xffff0000, v199
    ds_read_b64_tr_b16 v[172:173], v199 offset:24576
    ds_read_b64_tr_b16 v[174:175], v199 offset:25088
    s_waitcnt lgkmcnt(12)
    v_mfma_f32_32x32x16_bf16 v[112:127], v[132:135], v[84:87], v[112:127]
    s_waitcnt lgkmcnt(10)
    v_mfma_f32_32x32x16_bf16 v[112:127], v[136:139], v[88:91], v[112:127]
    s_waitcnt lgkmcnt(8)
    v_mfma_f32_32x32x16_bf16 v[112:127], v[140:143], v[92:95], v[112:127]
    s_waitcnt lgkmcnt(6)
    v_mfma_f32_32x32x16_bf16 v[112:127], v[160:163], v[96:99], v[112:127]
    v_mfma_f32_16x16x32_bf16 v[180:183], v[176:179], v[160:163], v[180:183]
    s_waitcnt lgkmcnt(4)
    v_mfma_f32_32x32x16_bf16 v[112:127], v[164:167], v[100:103], v[112:127]
    s_waitcnt lgkmcnt(2)
    v_mfma_f32_32x32x16_bf16 v[112:127], v[168:171], v[104:107], v[112:127]
    s_nop 3
    ds_write_b32 v206, v180 offset:2048
    s_waitcnt lgkmcnt(1)
    v_mfma_f32_32x32x16_bf16 v[112:127], v[172:175], v[108:111], v[112:127]
    s_waitcnt vmcnt(0) lgkmcnt(0)
    s_barrier
    s_setprio 3
    ds_read_b128 v[236:239], v201 offset:8192
    ds_read_b128 v[240:243], v201 offset:9216
    ds_read_b64 v[228:229], v207 offset:2048
    s_waitcnt lgkmcnt(0)
    v_add_f32 v228, v228, v229
    s_nop 1
    v_mfma_f32_32x32x2_f32 v[112:127], v228, v208, v[112:127]
    s_nop 15
    s_nop 3
    v_cvt_pk_bf16_f32 v112, v112, v113
    v_cvt_pk_bf16_f32 v113, v114, v115
    v_cvt_pk_bf16_f32 v114, v116, v117
    v_cvt_pk_bf16_f32 v115, v118, v119
    v_cvt_pk_bf16_f32 v116, v120, v121
    v_cvt_pk_bf16_f32 v117, v122, v123
    v_cvt_pk_bf16_f32 v118, v124, v125
    v_cvt_pk_bf16_f32 v119, v126, v127
    v_mfma_f32_32x32x16_bf16 v[220:235], v[236:239], v[112:115], 0
    s_nop 0
    v_mfma_f32_32x32x16_bf16 v[220:235], v[240:243], v[116:119], v[220:235]
    s_setprio 0
    s_nop 10
    v_max3_f32 v244, v220, v221, v222
    v_min3_f32 v245, v220, v221, v222
    v_max3_f32 v244, v244, v223, v224
    v_min3_f32 v245, v245, v223, v224
    v_max3_f32 v244, v244, v225, v226
    v_min3_f32 v245, v245, v225, v226
    v_max3_f32 v244, v244, v227, v228
    v_min3_f32 v245, v245, v227, v228
    v_max3_f32 v244, v244, v229, v230
    v_min3_f32 v245, v245, v229, v230
    v_max3_f32 v244, v244, v231, v232
    v_min3_f32 v245, v245, v231, v232
    v_max_f32 v244, v244, v233
    v_min_f32 v245, v245, v233
    v_mul_f32 v245, -1.0, v245
    s_nop 1
    v_permlane32_swap_b32 v244, v245
    v_max_f32 v244, v244, v245
    v_mov_b32 v245, v244
    s_nop 1
    v_permlane32_swap_b32 v244, v245
    v_mul_f32 v244, v244, v211
    v_mul_f32 v245, v245, v211
    v_fma_f32 v112, -v220, v211, -v245
    v_fma_f32 v113, -v221, v211, -v245
    v_fma_f32 v220, v220, v211, -v244
    v_fma_f32 v221, v221, v211, -v244
    v_fma_f32 v114, -v222, v211, -v245
    v_fma_f32 v115, -v223, v211, -v245
    v_fma_f32 v222, v222, v211, -v244
    v_fma_f32 v223, v223, v211, -v244
    v_fma_f32 v116, -v224, v211, -v245
    v_fma_f32 v117, -v225, v211, -v245
    v_fma_f32 v224, v224, v211, -v244
    v_fma_f32 v225, v225, v211, -v244
    v_fma_f32 v118, -v226, v211, -v245
    v_fma_f32 v119, -v227, v211, -v245
    v_fma_f32 v226, v226, v211, -v244
    v_fma_f32 v227, v227, v211, -v244
    v_fma_f32 v120, -v228, v211, -v245
    v_fma_f32 v121, -v229, v211, -v245
    v_fma_f32 v228, v228, v211, -v244
    v_fma_f32 v229, v229, v211, -v244
    v_fma_f32 v122, -v230, v211, -v245
    v_fma_f32 v123, -v231, v211, -v245
    v_fma_f32 v230, v230, v211, -v244
    v_fma_f32 v231, v231, v211, -v244
    v_fma_f32 v124, -v232, v211, -v245
    v_fma_f32 v125, -v233, v211, -v245
    v_fma_f32 v232, v232, v211, -v244
    v_fma_f32 v233, v233, v211, -v244
    v_exp_f32 v112, v112
    v_exp_f32 v220, v220
    v_exp_f32 v113, v113
    v_exp_f32 v221, v221
    v_exp_f32 v114, v114
    v_exp_f32 v222, v222
    v_exp_f32 v115, v115
    v_exp_f32 v223, v223
    v_exp_f32 v116, v116
    v_exp_f32 v224, v224
    v_exp_f32 v117, v117
    v_exp_f32 v225, v225
    v_exp_f32 v118, v118
    v_exp_f32 v226, v226
    v_exp_f32 v119, v119
    v_exp_f32 v227, v227
    v_exp_f32 v120, v120
    v_exp_f32 v228, v228
    v_exp_f32 v121, v121
    v_exp_f32 v229, v229
    v_exp_f32 v122, v122
    v_exp_f32 v230, v230
    v_exp_f32 v123, v123
    v_exp_f32 v231, v231
    v_exp_f32 v124, v124
    v_exp_f32 v232, v232
    v_exp_f32 v125, v125
    v_exp_f32 v233, v233
    v_cvt_pk_bf16_f32 v128, v220, v221
    v_cvt_pk_bf16_f32 v136, v112, v113
    v_cvt_pk_bf16_f32 v129, v222, v223
    v_cvt_pk_bf16_f32 v137, v114, v115
    v_cvt_pk_bf16_f32 v130, v224, v225
    v_cvt_pk_bf16_f32 v138, v116, v117
    v_cvt_pk_bf16_f32 v131, v226, v227
    v_cvt_pk_bf16_f32 v139, v118, v119
    v_cvt_pk_bf16_f32 v132, v228, v229
    v_cvt_pk_bf16_f32 v140, v120, v121
    v_cvt_pk_bf16_f32 v133, v230, v231
    v_cvt_pk_bf16_f32 v141, v122, v123
    v_cvt_pk_bf16_f32 v134, v232, v233
    v_cvt_pk_bf16_f32 v142, v124, v125
    v_mov_b32 v135, 0
    v_mov_b32 v143, 0
    s_setprio 2
    v_add_u32 v196, 0x10000, v196
    ds_read_b64_tr_b16 v[160:161], v196 offset:32768
    ds_read_b64_tr_b16 v[162:163], v196 offset:33280
    v_add_u32 v197, 0x10000, v197
    ds_read_b64_tr_b16 v[164:165], v197 offset:32768
    ds_read_b64_tr_b16 v[166:167], v197 offset:33280
    v_add_u32 v198, 0x10000, v198
    ds_read_b64_tr_b16 v[168:169], v198 offset:32768
    ds_read_b64_tr_b16 v[170:171], v198 offset:33280
    v_add_u32 v199, 0x10000, v199
    ds_read_b64_tr_b16 v[172:173], v199 offset:32768
    ds_read_b64_tr_b16 v[174:175], v199 offset:33280
    ds_read_b64_tr_b16 v[220:221], v196 offset:40960
    ds_read_b64_tr_b16 v[222:223], v196 offset:41472
    ds_read_b64_tr_b16 v[224:225], v197 offset:40960
    ds_read_b64_tr_b16 v[226:227], v197 offset:41472
    ds_read_b64_tr_b16 v[228:229], v198 offset:40960
    ds_read_b64_tr_b16 v[230:231], v198 offset:41472
    s_barrier
    s_waitcnt lgkmcnt(12)
    v_mfma_f32_32x32x16_bf16 v[112:127], v[160:163], v[0:3], 0
    v_mfma_f32_16x16x32_bf16 v[180:183], v[176:179], v[160:163], 0
    ds_read_b64_tr_b16 v[232:233], v199 offset:40960
    ds_read_b64_tr_b16 v[234:235], v199 offset:41472
    s_waitcnt lgkmcnt(12)
    v_mfma_f32_32x32x16_bf16 v[112:127], v[164:167], v[4:7], v[112:127]
    ds_read_b64_tr_b16 v[160:161], v196 offset:49152
    ds_read_b64_tr_b16 v[162:163], v196 offset:49664
    s_waitcnt lgkmcnt(12)
    v_mfma_f32_32x32x16_bf16 v[112:127], v[168:171], v[8:11], v[112:127]
    ds_read_b64_tr_b16 v[164:165], v197 offset:49152
    ds_read_b64_tr_b16 v[166:167], v197 offset:49664
    s_waitcnt lgkmcnt(12)
    v_mfma_f32_32x32x16_bf16 v[112:127], v[172:175], v[12:15], v[112:127]
    ds_read_b64_tr_b16 v[168:169], v198 offset:49152
    ds_read_b64_tr_b16 v[170:171], v198 offset:49664
    s_waitcnt lgkmcnt(12)
    v_mfma_f32_32x32x16_bf16 v[112:127], v[220:223], v[16:19], v[112:127]
    v_mfma_f32_16x16x32_bf16 v[180:183], v[176:179], v[220:223], v[180:183]
    ds_read_b64_tr_b16 v[172:173], v199 offset:49152
    ds_read_b64_tr_b16 v[174:175], v199 offset:49664
    s_waitcnt lgkmcnt(12)
    v_mfma_f32_32x32x16_bf16 v[112:127], v[224:227], v[20:23], v[112:127]
    ds_read_b64_tr_b16 v[220:221], v196 offset:57344
    ds_read_b64_tr_b16 v[222:223], v196 offset:57856
    s_waitcnt lgkmcnt(12)
    v_mfma_f32_32x32x16_bf16 v[112:127], v[228:231], v[24:27], v[112:127]
    ds_read_b64_tr_b16 v[224:225], v197 offset:57344
    ds_read_b64_tr_b16 v[226:227], v197 offset:57856
    s_waitcnt lgkmcnt(12)
    v_mfma_f32_32x32x16_bf16 v[112:127], v[232:235], v[28:31], v[112:127]
    ds_read_b64_tr_b16 v[228:229], v198 offset:57344
    ds_read_b64_tr_b16 v[230:231], v198 offset:57856
    s_waitcnt lgkmcnt(12)
    v_mfma_f32_32x32x16_bf16 v[112:127], v[160:163], v[32:35], v[112:127]
    v_mfma_f32_16x16x32_bf16 v[180:183], v[176:179], v[160:163], v[180:183]
    ds_read_b64_tr_b16 v[232:233], v199 offset:57344
    ds_read_b64_tr_b16 v[234:235], v199 offset:57856
    s_waitcnt lgkmcnt(12)
    v_mfma_f32_32x32x16_bf16 v[112:127], v[164:167], v[36:39], v[112:127]
    v_add_u32 v196, 0x10000, v196
    ds_read_b64_tr_b16 v[160:161], v196 offset:0
    ds_read_b64_tr_b16 v[162:163], v196 offset:512
    s_waitcnt lgkmcnt(12)
    v_mfma_f32_32x32x16_bf16 v[112:127], v[168:171], v[40:43], v[112:127]
    v_add_u32 v197, 0x10000, v197
    ds_read_b64_tr_b16 v[164:165], v197 offset:0
    ds_read_b64_tr_b16 v[166:167], v197 offset:512
    s_waitcnt lgkmcnt(12)
    v_mfma_f32_32x32x16_bf16 v[112:127], v[172:175], v[44:47], v[112:127]
    v_add_u32 v198, 0x10000, v198
    ds_read_b64_tr_b16 v[168:169], v198 offset:0
    ds_read_b64_tr_b16 v[170:171], v198 offset:512
    s_waitcnt lgkmcnt(12)
    v_mfma_f32_32x32x16_bf16 v[112:127], v[220:223], v[48:51], v[112:127]
    v_mfma_f32_16x16x32_bf16 v[180:183], v[176:179], v[220:223], v[180:183]
    v_add_u32 v199, 0x10000, v199
    ds_read_b64_tr_b16 v[172:173], v199 offset:0
    ds_read_b64_tr_b16 v[174:175], v199 offset:512
    s_waitcnt lgkmcnt(12)
    v_mfma_f32_32x32x16_bf16 v[112:127], v[224:227], v[52:55], v[112:127]
    ds_read_b64_tr_b16 v[220:221], v196 offset:8192
    ds_read_b64_tr_b16 v[222:223], v196 offset:8704
    s_waitcnt lgkmcnt(12)
    v_mfma_f32_32x32x16_bf16 v[112:127], v[228:231], v[56:59], v[112:127]
    ds_read_b64_tr_b16 v[224:225], v197 offset:8192
    ds_read_b64_tr_b16 v[226:227], v197 offset:8704
    s_waitcnt lgkmcnt(12)
    v_mfma_f32_32x32x16_bf16 v[112:127], v[232:235], v[60:63], v[112:127]
    ds_read_b64_tr_b16 v[228:229], v198 offset:8192
    ds_read_b64_tr_b16 v[230:231], v198 offset:8704
    s_waitcnt lgkmcnt(12)
    v_mfma_f32_32x32x16_bf16 v[112:127], v[160:163], v[64:67], v[112:127]
    v_mfma_f32_16x16x32_bf16 v[180:183], v[176:179], v[160:163], v[180:183]
    ds_read_b64_tr_b16 v[232:233], v199 offset:8192
    ds_read_b64_tr_b16 v[234:235], v199 offset:8704
    s_waitcnt lgkmcnt(12)
    v_mfma_f32_32x32x16_bf16 v[112:127], v[164:167], v[68:71], v[112:127]
    v_add_u32 v196, 0xfffe0000, v196
    ds_read_b64_tr_b16 v[160:161], v196 offset:16384
    ds_read_b64_tr_b16 v[162:163], v196 offset:16896
    s_waitcnt lgkmcnt(12)
    v_mfma_f32_32x32x16_bf16 v[112:127], v[168:171], v[72:75], v[112:127]
    v_add_u32 v197, 0xfffe0000, v197
    ds_read_b64_tr_b16 v[164:165], v197 offset:16384
    ds_read_b64_tr_b16 v[166:167], v197 offset:16896
    s_waitcnt lgkmcnt(12)
    v_mfma_f32_32x32x16_bf16 v[112:127], v[172:175], v[76:79], v[112:127]
    v_add_u32 v198, 0xfffe0000, v198
    ds_read_b64_tr_b16 v[168:169], v198 offset:16384
    ds_read_b64_tr_b16 v[170:171], v198 offset:16896
    s_waitcnt lgkmcnt(12)
    v_mfma_f32_32x32x16_bf16 v[112:127], v[220:223], v[80:83], v[112:127]
    v_mfma_f32_16x16x32_bf16 v[180:183], v[176:179], v[220:223], v[180:183]
    v_add_u32 v199, 0xfffe0000, v199
    ds_read_b64_tr_b16 v[172:173], v199 offset:16384
    ds_read_b64_tr_b16 v[174:175], v199 offset:16896
    s_waitcnt lgkmcnt(12)
    v_mfma_f32_32x32x16_bf16 v[112:127], v[224:227], v[84:87], v[112:127]
    s_waitcnt lgkmcnt(10)
    v_mfma_f32_32x32x16_bf16 v[112:127], v[228:231], v[88:91], v[112:127]
    s_waitcnt lgkmcnt(8)
    v_mfma_f32_32x32x16_bf16 v[112:127], v[232:235], v[92:95], v[112:127]
    s_waitcnt lgkmcnt(6)
    v_mfma_f32_32x32x16_bf16 v[112:127], v[160:163], v[96:99], v[112:127]
    v_mfma_f32_16x16x32_bf16 v[180:183], v[176:179], v[160:163], v[180:183]
    s_waitcnt lgkmcnt(4)
    v_mfma_f32_32x32x16_bf16 v[112:127], v[164:167], v[100:103], v[112:127]
    s_waitcnt lgkmcnt(2)
    v_mfma_f32_32x32x16_bf16 v[112:127], v[168:171], v[104:107], v[112:127]
    s_nop 3
    ds_write_b32 v206, v180 offset:0
    s_waitcnt lgkmcnt(1)
    v_mfma_f32_32x32x16_bf16 v[112:127], v[172:175], v[108:111], v[112:127]
    v_lshrrev_b32 v184, 9, v204
    v_bfe_u32 v185, v204, 6, 2
    v_lshl_add_u32 v184, v184, 3, v185
    v_lshlrev_b32 v184, 6, v184
    v_bfe_u32 v185, v204, 8, 1
    v_lshl_add_u32 v184, v185, 5, v184
    v_bfe_u32 v185, v204, 4, 2
    v_lshl_add_u32 v184, v185, 3, v184
    s_waitcnt lgkmcnt(0)
    s_barrier
    ds_read_b64_tr_b16 v[32:33], v184 offset:32768
    ds_read_b64_tr_b16 v[34:35], v184 offset:33024
    ds_read_b64_tr_b16 v[36:37], v184 offset:33792
    ds_read_b64_tr_b16 v[38:39], v184 offset:34048
    ds_read_b64_tr_b16 v[40:41], v184 offset:34816
    ds_read_b64_tr_b16 v[42:43], v184 offset:35072
    ds_read_b64_tr_b16 v[44:45], v184 offset:35840
    ds_read_b64_tr_b16 v[46:47], v184 offset:36096
    ds_read_b64_tr_b16 v[48:49], v184 offset:40960
    ds_read_b64_tr_b16 v[50:51], v184 offset:41216
    ds_read_b64_tr_b16 v[52:53], v184 offset:41984
    ds_read_b64_tr_b16 v[54:55], v184 offset:42240
    ds_read_b64_tr_b16 v[56:57], v184 offset:43008
    ds_read_b64_tr_b16 v[58:59], v184 offset:43264
    ds_read_b64_tr_b16 v[60:61], v184 offset:44032
    ds_read_b64_tr_b16 v[62:63], v184 offset:44288
    ds_read_b64_tr_b16 v[64:65], v184 offset:49152
    ds_read_b64_tr_b16 v[66:67], v184 offset:49408
    ds_read_b64_tr_b16 v[68:69], v184 offset:50176
    ds_read_b64_tr_b16 v[70:71], v184 offset:50432
    ds_read_b64_tr_b16 v[72:73], v184 offset:51200
    ds_read_b64_tr_b16 v[74:75], v184 offset:51456
    ds_read_b64_tr_b16 v[76:77], v184 offset:52224
    ds_read_b64_tr_b16 v[78:79], v184 offset:52480
    ds_read_b64_tr_b16 v[160:161], v184 offset:57344
    ds_read_b64_tr_b16 v[162:163], v184 offset:57600
    ds_read_b64_tr_b16 v[164:165], v184 offset:58368
    ds_read_b64_tr_b16 v[166:167], v184 offset:58624
    ds_read_b64_tr_b16 v[168:169], v184 offset:59392
    ds_read_b64_tr_b16 v[170:171], v184 offset:59648
    ds_read_b64_tr_b16 v[172:173], v184 offset:60416
    ds_read_b64_tr_b16 v[174:175], v184 offset:60672
    v_mov_b32 v255, 1
    s_waitcnt lgkmcnt(15)
    v_mfma_f32_32x32x16_bf16 v[16:31], v[32:35], v[144:147], 0
    v_mfma_f32_32x32x16_bf16 v[80:95], v[40:43], v[152:155], 0
    v_mfma_f32_32x32x16_bf16 v[16:31], v[36:39], v[148:151], v[16:31]
    v_mfma_f32_32x32x16_bf16 v[80:95], v[44:47], v[156:159], v[80:95]
    v_mfma_f32_32x32x16_bf16 v[96:111], v[48:51], v[188:191], 0
    v_mfma_f32_32x32x16_bf16 v[32:47], v[56:59], v[212:215], 0
    v_mfma_f32_32x32x16_bf16 v[96:111], v[52:55], v[192:195], v[96:111]
    v_mfma_f32_32x32x16_bf16 v[32:47], v[60:63], v[216:219], v[32:47]
    s_nop 7
    v_mul_f32 v252, v28, v93
    v_mul_f32 v253, v29, v93
    v_fmac_f32 v252, v92, v29
    v_fmac_f32 v252, 0x358637bd, v253
    v_rcp_f32 v252, v252
    s_nop 0
    v_mul_f32 v254, v93, v252
    v_mul_f32 v185, v93, v252
    v_mul_f32 v186, v29, v252
    v_mul_f32 v187, v29, v252
    v_permlane32_swap_b32 v254, v185
    s_nop 0
    v_permlane32_swap_b32 v186, v187
    v_cndmask_b32 v185, v254, 0, s[60:61]
    v_cndmask_b32 v187, v186, 0, s[60:61]
    v_mul_f32 v16, v16, v254
    v_mul_f32 v17, v17, v254
    v_mul_f32 v18, v18, v254
    v_mul_f32 v19, v19, v254
    v_mul_f32 v20, v20, v254
    v_mul_f32 v21, v21, v254
    v_mul_f32 v22, v22, v254
    v_mul_f32 v23, v23, v254
    v_mul_f32 v24, v24, v254
    v_mul_f32 v25, v25, v254
    v_mul_f32 v26, v26, v254
    v_mul_f32 v27, v27, v254
    v_mul_f32 v28, v28, v185
    v_mul_f32 v29, v29, v185
    v_mul_f32 v30, v30, v185
    v_mul_f32 v31, v31, v185
    v_fmac_f32 v16, v80, v186
    v_fmac_f32 v17, v81, v186
    v_fmac_f32 v18, v82, v186
    v_fmac_f32 v19, v83, v186
    v_fmac_f32 v20, v84, v186
    v_fmac_f32 v21, v85, v186
    v_fmac_f32 v22, v86, v186
    v_fmac_f32 v23, v87, v186
    v_fmac_f32 v24, v88, v186
    v_fmac_f32 v25, v89, v186
    v_fmac_f32 v26, v90, v186
    v_fmac_f32 v27, v91, v186
    v_fmac_f32 v28, v92, v187
    v_fmac_f32 v29, v93, v187
    v_fmac_f32 v30, v94, v187
    v_fmac_f32 v31, v95, v187
    v_cvt_pk_bf16_f32 v16, v16, v17
    v_cvt_pk_bf16_f32 v17, v18, v19
    v_cvt_pk_bf16_f32 v18, v20, v21
    v_cvt_pk_bf16_f32 v19, v22, v23
    v_cvt_pk_bf16_f32 v20, v24, v25
    v_cvt_pk_bf16_f32 v21, v26, v27
    v_cvt_pk_bf16_f32 v22, v28, v29
    v_cvt_pk_bf16_f32 v23, v30, v31
    s_add_u32 s94, s54, 0
    buffer_store_dwordx4 v[16:19], v204, s[40:43], s94 offen offset:0 sc1
    buffer_store_dwordx4 v[20:23], v204, s[40:43], s94 offen offset:1024 sc1
    s_waitcnt lgkmcnt(14)
    v_mfma_f32_32x32x16_bf16 v[48:63], v[64:67], v[128:131], 0
    s_waitcnt lgkmcnt(10)
    v_mfma_f32_32x32x16_bf16 v[80:95], v[72:75], v[136:139], 0
    v_mfma_f32_32x32x16_bf16 v[48:63], v[68:71], v[132:135], v[48:63]
    s_waitcnt lgkmcnt(8)
    v_mfma_f32_32x32x16_bf16 v[80:95], v[76:79], v[140:143], v[80:95]
    v_mul_f32 v252, v108, v45
    v_mul_f32 v253, v109, v45
    v_fmac_f32 v252, v44, v109
    v_fmac_f32 v252, 0x358637bd, v253
    v_rcp_f32 v252, v252
    s_nop 0
    v_mul_f32 v254, v45, v252
    v_mul_f32 v185, v45, v252
    v_mul_f32 v186, v109, v252
    v_mul_f32 v187, v109, v252
    v_permlane32_swap_b32 v254, v185
    s_nop 0
    v_permlane32_swap_b32 v186, v187
    v_cndmask_b32 v185, v254, 0, s[60:61]
    v_cndmask_b32 v187, v186, 0, s[60:61]
    v_mul_f32 v96, v96, v254
    v_mul_f32 v97, v97, v254
    v_mul_f32 v98, v98, v254
    v_mul_f32 v99, v99, v254
    v_mul_f32 v100, v100, v254
    v_mul_f32 v101, v101, v254
    v_mul_f32 v102, v102, v254
    v_mul_f32 v103, v103, v254
    v_mul_f32 v104, v104, v254
    v_mul_f32 v105, v105, v254
    v_mul_f32 v106, v106, v254
    v_mul_f32 v107, v107, v254
    v_mul_f32 v108, v108, v185
    v_mul_f32 v109, v109, v185
    v_mul_f32 v110, v110, v185
    v_mul_f32 v111, v111, v185
    v_fmac_f32 v96, v32, v186
    v_fmac_f32 v97, v33, v186
    v_fmac_f32 v98, v34, v186
    v_fmac_f32 v99, v35, v186
    v_fmac_f32 v100, v36, v186
    v_fmac_f32 v101, v37, v186
    v_fmac_f32 v102, v38, v186
    v_fmac_f32 v103, v39, v186
    v_fmac_f32 v104, v40, v186
    v_fmac_f32 v105, v41, v186
    v_fmac_f32 v106, v42, v186
    v_fmac_f32 v107, v43, v186
    v_fmac_f32 v108, v44, v187
    v_fmac_f32 v109, v45, v187
    v_fmac_f32 v110, v46, v187
    v_fmac_f32 v111, v47, v187
    v_cvt_pk_bf16_f32 v96, v96, v97
    v_cvt_pk_bf16_f32 v97, v98, v99
    v_cvt_pk_bf16_f32 v98, v100, v101
    v_cvt_pk_bf16_f32 v99, v102, v103
    v_cvt_pk_bf16_f32 v100, v104, v105
    v_cvt_pk_bf16_f32 v101, v106, v107
    v_cvt_pk_bf16_f32 v102, v108, v109
    v_cvt_pk_bf16_f32 v103, v110, v111
    s_add_u32 s94, s54, 4096
    buffer_store_dwordx4 v[96:99], v204, s[40:43], s94 offen offset:0 sc1
    buffer_store_dwordx4 v[100:103], v204, s[40:43], s94 offen offset:1024 sc1
    v_mul_f32 v252, v60, v93
    v_mul_f32 v253, v61, v93
    v_fmac_f32 v252, v92, v61
    v_fmac_f32 v252, 0x358637bd, v253
    v_rcp_f32 v252, v252
    s_nop 0
    v_mul_f32 v254, v93, v252
    v_mul_f32 v185, v93, v252
    v_mul_f32 v186, v61, v252
    v_mul_f32 v187, v61, v252
    v_permlane32_swap_b32 v254, v185
    s_nop 0
    v_permlane32_swap_b32 v186, v187
    v_cndmask_b32 v185, v254, 0, s[60:61]
    v_cndmask_b32 v187, v186, 0, s[60:61]
    v_mul_f32 v48, v48, v254
    v_mul_f32 v49, v49, v254
    v_mul_f32 v50, v50, v254
    v_mul_f32 v51, v51, v254
    v_mul_f32 v52, v52, v254
    v_mul_f32 v53, v53, v254
    v_mul_f32 v54, v54, v254
    v_mul_f32 v55, v55, v254
    v_mul_f32 v56, v56, v254
    v_mul_f32 v57, v57, v254
    v_mul_f32 v58, v58, v254
    v_mul_f32 v59, v59, v254
    v_mul_f32 v60, v60, v185
    v_mul_f32 v61, v61, v185
    v_mul_f32 v62, v62, v185
    v_mul_f32 v63, v63, v185
    v_fmac_f32 v48, v80, v186
    v_fmac_f32 v49, v81, v186
    v_fmac_f32 v50, v82, v186
    v_fmac_f32 v51, v83, v186
    v_fmac_f32 v52, v84, v186
    v_fmac_f32 v53, v85, v186
    v_fmac_f32 v54, v86, v186
    v_fmac_f32 v55, v87, v186
    v_fmac_f32 v56, v88, v186
    v_fmac_f32 v57, v89, v186
    v_fmac_f32 v58, v90, v186
    v_fmac_f32 v59, v91, v186
    v_fmac_f32 v60, v92, v187
    v_fmac_f32 v61, v93, v187
    v_fmac_f32 v62, v94, v187
    v_fmac_f32 v63, v95, v187
    v_cvt_pk_bf16_f32 v48, v48, v49
    v_cvt_pk_bf16_f32 v49, v50, v51
    v_cvt_pk_bf16_f32 v50, v52, v53
    v_cvt_pk_bf16_f32 v51, v54, v55
    v_cvt_pk_bf16_f32 v52, v56, v57
    v_cvt_pk_bf16_f32 v53, v58, v59
    v_cvt_pk_bf16_f32 v54, v60, v61
    v_cvt_pk_bf16_f32 v55, v62, v63
    s_add_u32 s94, s54, 8192
    buffer_store_dwordx4 v[48:51], v204, s[40:43], s94 offen offset:0 sc1
    buffer_store_dwordx4 v[52:55], v204, s[40:43], s94 offen offset:1024 sc1
    s_setprio 3
    ds_read_b128 v[236:239], v201 offset:12288
    ds_read_b128 v[240:243], v201 offset:13312
    ds_read_b64 v[228:229], v207 offset:0
    s_waitcnt lgkmcnt(0)
    v_add_f32 v228, v228, v229
    s_nop 1
    v_mfma_f32_32x32x2_f32 v[112:127], v228, v208, v[112:127]
    s_nop 15
    s_nop 3
    v_cvt_pk_bf16_f32 v112, v112, v113
    v_cvt_pk_bf16_f32 v113, v114, v115
    v_cvt_pk_bf16_f32 v114, v116, v117
    v_cvt_pk_bf16_f32 v115, v118, v119
    v_cvt_pk_bf16_f32 v116, v120, v121
    v_cvt_pk_bf16_f32 v117, v122, v123
    v_cvt_pk_bf16_f32 v118, v124, v125
    v_cvt_pk_bf16_f32 v119, v126, v127
    v_mfma_f32_32x32x16_bf16 v[220:235], v[236:239], v[112:115], 0
    s_nop 0
    v_mfma_f32_32x32x16_bf16 v[220:235], v[240:243], v[116:119], v[220:235]
    s_setprio 0
    s_nop 10
    v_max3_f32 v244, v220, v221, v222
    v_min3_f32 v245, v220, v221, v222
    v_max3_f32 v244, v244, v223, v224
    v_min3_f32 v245, v245, v223, v224
    v_max3_f32 v244, v244, v225, v226
    v_min3_f32 v245, v245, v225, v226
    v_max3_f32 v244, v244, v227, v228
    v_min3_f32 v245, v245, v227, v228
    v_max3_f32 v244, v244, v229, v230
    v_min3_f32 v245, v245, v229, v230
    v_max3_f32 v244, v244, v231, v232
    v_min3_f32 v245, v245, v231, v232
    v_max_f32 v244, v244, v233
    v_min_f32 v245, v245, v233
    v_mul_f32 v245, -1.0, v245
    s_nop 1
    v_permlane32_swap_b32 v244, v245
    v_max_f32 v244, v244, v245
    v_mov_b32 v245, v244
    s_nop 1
    v_permlane32_swap_b32 v244, v245
    v_mul_f32 v244, v244, v211
    v_mul_f32 v245, v245, v211
    v_fma_f32 v112, -v220, v211, -v245
    v_fma_f32 v113, -v221, v211, -v245
    v_fma_f32 v220, v220, v211, -v244
    v_fma_f32 v221, v221, v211, -v244
    v_fma_f32 v114, -v222, v211, -v245
    v_fma_f32 v115, -v223, v211, -v245
    v_fma_f32 v222, v222, v211, -v244
    v_fma_f32 v223, v223, v211, -v244
    v_fma_f32 v116, -v224, v211, -v245
    v_fma_f32 v117, -v225, v211, -v245
    v_fma_f32 v224, v224, v211, -v244
    v_fma_f32 v225, v225, v211, -v244
    v_fma_f32 v118, -v226, v211, -v245
    v_fma_f32 v119, -v227, v211, -v245
    v_fma_f32 v226, v226, v211, -v244
    v_fma_f32 v227, v227, v211, -v244
    v_fma_f32 v120, -v228, v211, -v245
    v_fma_f32 v121, -v229, v211, -v245
    v_fma_f32 v228, v228, v211, -v244
    v_fma_f32 v229, v229, v211, -v244
    v_fma_f32 v122, -v230, v211, -v245
    v_fma_f32 v123, -v231, v211, -v245
    v_fma_f32 v230, v230, v211, -v244
    v_fma_f32 v231, v231, v211, -v244
    v_fma_f32 v124, -v232, v211, -v245
    v_fma_f32 v125, -v233, v211, -v245
    v_fma_f32 v232, v232, v211, -v244
    v_fma_f32 v233, v233, v211, -v244
    v_exp_f32 v112, v112
    v_exp_f32 v220, v220
    v_exp_f32 v113, v113
    v_exp_f32 v221, v221
    v_exp_f32 v114, v114
    v_exp_f32 v222, v222
    v_exp_f32 v115, v115
    v_exp_f32 v223, v223
    v_exp_f32 v116, v116
    v_exp_f32 v224, v224
    v_exp_f32 v117, v117
    v_exp_f32 v225, v225
    v_exp_f32 v118, v118
    v_exp_f32 v226, v226
    v_exp_f32 v119, v119
    v_exp_f32 v227, v227
    v_exp_f32 v120, v120
    v_exp_f32 v228, v228
    v_exp_f32 v121, v121
    v_exp_f32 v229, v229
    v_exp_f32 v122, v122
    v_exp_f32 v230, v230
    s_waitcnt vmcnt(4)
    buffer_store_dword v255, v205, s[40:43], s55 offen offset:0 sc1
    s_waitcnt vmcnt(3)
    buffer_store_dword v255, v205, s[40:43], s55 offen offset:8 sc1
    s_waitcnt vmcnt(2)
    buffer_store_dword v255, v205, s[40:43], s55 offen offset:16 sc1
    v_exp_f32 v123, v123
    v_exp_f32 v231, v231
    v_exp_f32 v124, v124
    v_exp_f32 v232, v232
    v_exp_f32 v125, v125
    v_exp_f32 v233, v233
    v_cvt_pk_bf16_f32 v0, v220, v221
    v_cvt_pk_bf16_f32 v8, v112, v113
    v_cvt_pk_bf16_f32 v1, v222, v223
    v_cvt_pk_bf16_f32 v9, v114, v115
    v_cvt_pk_bf16_f32 v2, v224, v225
    v_cvt_pk_bf16_f32 v10, v116, v117
    v_cvt_pk_bf16_f32 v3, v226, v227
    v_cvt_pk_bf16_f32 v11, v118, v119
    v_cvt_pk_bf16_f32 v4, v228, v229
    v_cvt_pk_bf16_f32 v12, v120, v121
    v_cvt_pk_bf16_f32 v5, v230, v231
    v_cvt_pk_bf16_f32 v13, v122, v123
    v_cvt_pk_bf16_f32 v6, v232, v233
    v_cvt_pk_bf16_f32 v14, v124, v125
    v_mov_b32 v7, 0
    v_mov_b32 v15, 0
    s_setprio 2
    v_mfma_f32_32x32x16_bf16 v[64:79], v[160:163], v[0:3], 0
    v_mfma_f32_32x32x16_bf16 v[32:47], v[168:171], v[8:11], 0
    v_mfma_f32_32x32x16_bf16 v[64:79], v[164:167], v[4:7], v[64:79]
    v_mfma_f32_32x32x16_bf16 v[32:47], v[172:175], v[12:15], v[32:47]
    s_nop 11
    v_mul_f32 v252, v76, v45
    v_mul_f32 v253, v77, v45
    v_fmac_f32 v252, v44, v77
    v_fmac_f32 v252, 0x358637bd, v253
    v_rcp_f32 v252, v252
    s_nop 0
    v_mul_f32 v254, v45, v252
    v_mul_f32 v185, v45, v252
    v_mul_f32 v186, v77, v252
    v_mul_f32 v187, v77, v252
    v_permlane32_swap_b32 v254, v185
    s_nop 0
    v_permlane32_swap_b32 v186, v187
    v_cndmask_b32 v185, v254, 0, s[60:61]
    v_cndmask_b32 v187, v186, 0, s[60:61]
    v_mul_f32 v64, v64, v254
    v_mul_f32 v65, v65, v254
    v_mul_f32 v66, v66, v254
    v_mul_f32 v67, v67, v254
    v_mul_f32 v68, v68, v254
    v_mul_f32 v69, v69, v254
    v_mul_f32 v70, v70, v254
    v_mul_f32 v71, v71, v254
    v_mul_f32 v72, v72, v254
    v_mul_f32 v73, v73, v254
    v_mul_f32 v74, v74, v254
    v_mul_f32 v75, v75, v254
    v_mul_f32 v76, v76, v185
    v_mul_f32 v77, v77, v185
    v_mul_f32 v78, v78, v185
    v_mul_f32 v79, v79, v185
    v_fmac_f32 v64, v32, v186
    v_fmac_f32 v65, v33, v186
    v_fmac_f32 v66, v34, v186
    v_fmac_f32 v67, v35, v186
    v_fmac_f32 v68, v36, v186
    v_fmac_f32 v69, v37, v186
    v_fmac_f32 v70, v38, v186
    v_fmac_f32 v71, v39, v186
    v_fmac_f32 v72, v40, v186
    v_fmac_f32 v73, v41, v186
    v_fmac_f32 v74, v42, v186
    v_fmac_f32 v75, v43, v186
    v_fmac_f32 v76, v44, v187
    v_fmac_f32 v77, v45, v187
    v_fmac_f32 v78, v46, v187
    v_fmac_f32 v79, v47, v187
    v_cvt_pk_bf16_f32 v64, v64, v65
    v_cvt_pk_bf16_f32 v65, v66, v67
    v_cvt_pk_bf16_f32 v66, v68, v69
    v_cvt_pk_bf16_f32 v67, v70, v71
    v_cvt_pk_bf16_f32 v68, v72, v73
    v_cvt_pk_bf16_f32 v69, v74, v75
    v_cvt_pk_bf16_f32 v70, v76, v77
    v_cvt_pk_bf16_f32 v71, v78, v79
    s_add_u32 s94, s54, 12288
    buffer_store_dwordx4 v[64:67], v204, s[40:43], s94 offen offset:0 sc1
    buffer_store_dwordx4 v[68:71], v204, s[40:43], s94 offen offset:1024 sc1
    s_waitcnt vmcnt(0)
    buffer_store_dword v255, v205, s[40:43], s55 offen offset:24 sc1
    s_endpgm
.LQ1:
    s_nop 4
    s_lshl_b32 s51, s48, 3
    s_add_u32 s51, s51, s44
    s_mul_i32 s96, s51, 1568
    s_add_u32 m0, s53, 147456
    s_nop 0
    buffer_load_dwordx4 v204, s[12:15], s96 offen lds
    buffer_load_dwordx4 v204, s[12:15], s96 offen offset:1024 lds
    v_bfe_u32 v115, v204, 4, 5
    v_subrev_u32 v116, 2, v115
    v_cmp_gt_u32 vcc, 26, v115
    s_nop 1
    v_cndmask_b32 v116, v116, v115, vcc
    v_lshlrev_b32 v116, 1, v116
    v_lshrrev_b32 v113, 9, v204
    v_mul_u32_u24 v113, 224, v113
    v_add_u32 v113, v113, v116
    v_add_u32 v113, s53, v113
    v_add_u32 v113, 0x24000, v113
    s_mul_i32 s97, s48, 448
    v_and_b32 v224, 3, v255
    v_lshlrev_b32 v224, 4, v224
    v_min_u32 v224, 40, v224
    v_lshrrev_b32 v225, 2, v255
    v_xor_b32 v225, v225, v222
    v_mad_u32_u24 v224, v225, 56, v224
    v_mul_u32_u24 v200, 2688, v223
    v_add3_u32 v200, v200, v224, s97
    v_mov_b32 v226, 0
    v_mov_b32 v227, 0
    v_mov_b32 v228, 0
    v_mov_b32 v229, 0
    s_lshl_b32 s96, s47, 1
    s_add_u32 s96, s96, s48
    s_mul_i32 s97, s96, 4992
    s_add_u32 s97, s97, 0xa00000
    v_lshlrev_b32 v224, 4, v0
    v_mov_b32 v225, 0x40000000
    v_cmp_gt_u32 vcc, 312, v0
    s_nop 1
    v_cndmask_b32 v224, v225, v224, vcc
    buffer_store_dwordx4 v[226:229], v224, s[40:43], s97 offen sc1
    s_lshl_b32 s96, s96, 2
    v_mov_b32 v235, s96
    v_cmp_eq_u32 vcc, 0, v0
    s_nop 1
    v_cndmask_b32 v235, v225, v235, vcc
    v_bfe_u32 v230, v253, 4, 1
    v_lshrrev_b32 v231, 5, v253
    v_bfe_u32 v232, v253, 2, 2
    v_and_b32 v233, 3, v253
    s_add_u32 s92, s45, 0
    s_and_b32 s92, s92, 3
    s_add_u32 s93, s45, 1
    s_and_b32 s93, s93, 3
    s_add_u32 s94, s45, 2
    s_and_b32 s94, s94, 3
    s_add_u32 s95, s45, 3
    s_and_b32 s95, s95, 3
    v_bfe_u32 v224, v253, 1, 3
    v_xor_b32 v224, v224, v231
    v_lshlrev_b32 v224, 4, v224
    v_and_b32 v225, 31, v253
    v_lshl_add_u32 v234, v225, 7, v224
    s_lshl_b32 s96, s45, 12
    v_add_u32 v234, s96, v234
    v_lshlrev_b32 v206, 4, v225
    v_add_u32 v206, 0x25400, v206
    v_lshl_add_u32 v207, v231, 3, v206
    v_lshl_add_u32 v206, s45, 2, v206
    v_mov_b32 v224, 0x40000000
    v_cmp_eq_u32 vcc, 0, v253
    s_nop 1
    v_cndmask_b32 v205, v224, 0, vcc
    s_lshl_b32 s96, s92, 5
    v_xor_b32 v222, s96, v234
    s_lshl_b32 s96, s93, 5
    v_xor_b32 v223, s96, v234
    s_lshl_b32 s96, s94, 5
    v_xor_b32 v224, s96, v234
    s_lshl_b32 s96, s95, 5
    v_xor_b32 v225, s96, v234
    v_and_b32 v226, 7, v253
    v_lshlrev_b32 v227, 2, v230
    v_cmp_eq_u32 vcc, v226, v227
    v_mov_b32 v234, 0x3f803f80
    s_nop 0
    v_cndmask_b32 v176, 0, v234, vcc
    v_cndmask_b32 v177, 0, v234, vcc
    v_cndmask_b32 v178, 0, v234, vcc
    v_cndmask_b32 v179, 0, v234, vcc
    v_lshl_add_u32 v226, v231, 3, v232
    v_lshlrev_b32 v226, 7, v226
    v_lshl_add_u32 v226, v233, 3, v226
    v_lshrrev_b32 v227, 1, v232
    v_lshlrev_b32 v228, 1, v227
    v_xor_b32 v228, v228, v230
    v_xor_b32 v229, 2, v228
    v_lshl_add_u32 v229, v229, 5, v226
    s_lshl_b32 s92, s92, 11
    v_add_u32 v196, s92, v229
    s_lshl_b32 s93, s93, 11
    v_add_u32 v197, s93, v229
    s_lshl_b32 s94, s94, 11
    v_add_u32 v198, s94, v229
    s_lshl_b32 s95, s95, 11
    v_add_u32 v199, s95, v229
    s_lshl_b32 s96, s48, 4
    s_add_u32 s54, s54, s96
    s_add_u32 s54, s54, 114
    s_lshl_b32 s54, s54, 10
    s_lshr_b32 s55, s55, 1
    s_lshl_b32 s96, s48, 5
    s_add_u32 s55, s55, s96
    s_add_u32 s55, s55, 0xa24004
    s_add_u32 m0, s53, 49152
    s_nop 0
    buffer_load_dwordx4 v220, s[4:7], s66 offen lds
    s_add_u32 m0, s53, 50176
    s_nop 0
    buffer_load_dwordx4 v221, s[4:7], s66 offen lds
    s_add_u32 m0, s53, 65536
    s_nop 0
    buffer_load_dwordx4 v220, s[4:7], s67 offen lds
    s_add_u32 m0, s53, 66560
    s_nop 0
    buffer_load_dwordx4 v221, s[4:7], s67 offen lds
    s_add_u32 m0, s52, 81920
    s_nop 0
    buffer_load_dwordx4 v202, s[8:11], s80 offen lds
    s_add_u32 m0, s52, 90112
    s_nop 0
    buffer_load_dwordx4 v202, s[8:11], s81 offen lds
    s_waitcnt vmcnt(9)
    s_barrier
    ds_read_b128 v[0:3], v222 offset:0
    ds_read_b64_tr_b16 v[160:161], v196 offset:32768
    ds_read_b64_tr_b16 v[162:163], v196 offset:33280
    ds_read_b128 v[4:7], v223 offset:0
    ds_read_b64_tr_b16 v[164:165], v197 offset:32768
    ds_read_b64_tr_b16 v[166:167], v197 offset:33280
    ds_read_b128 v[8:11], v224 offset:0
    ds_read_b64_tr_b16 v[168:169], v198 offset:32768
    ds_read_b64_tr_b16 v[170:171], v198 offset:33280
    s_waitcnt lgkmcnt(6)
    v_mfma_f32_32x32x16_bf16 v[144:159], v[160:163], v[0:3], 0
    v_mfma_f32_16x16x32_bf16 v[180:183], v[176:179], v[160:163], 0
    ds_read_b128 v[12:15], v225 offset:0
    ds_read_b64_tr_b16 v[172:173], v199 offset:32768
    ds_read_b64_tr_b16 v[174:175], v199 offset:33280
    s_add_u32 m0, s53, 98304
    s_nop 0
    buffer_load_dwordx4 v220, s[4:7], s68 offen lds
    s_waitcnt vmcnt(7)
    s_waitcnt lgkmcnt(6)
    v_mfma_f32_32x32x16_bf16 v[144:159], v[164:167], v[4:7], v[144:159]
    ds_read_b128 v[16:19], v222 offset:16384
    ds_read_b64_tr_b16 v[160:161], v196 offset:40960
    ds_read_b64_tr_b16 v[162:163], v196 offset:41472
    s_add_u32 m0, s53, 99328
    s_nop 0
    buffer_load_dwordx4 v221, s[4:7], s68 offen lds
    s_waitcnt lgkmcnt(6)
    v_mfma_f32_32x32x16_bf16 v[144:159], v[168:171], v[8:11], v[144:159]
    ds_read_b128 v[20:23], v223 offset:16384
    ds_read_b64_tr_b16 v[164:165], v197 offset:40960
    ds_read_b64_tr_b16 v[166:167], v197 offset:41472
    s_add_u32 m0, s53, 114688
    s_nop 0
    buffer_load_dwordx4 v220, s[4:7], s69 offen lds
    s_waitcnt lgkmcnt(6)
    v_mfma_f32_32x32x16_bf16 v[144:159], v[172:175], v[12:15], v[144:159]
    ds_read_b128 v[24:27], v224 offset:16384
    ds_read_b64_tr_b16 v[168:169], v198 offset:40960
    ds_read_b64_tr_b16 v[170:171], v198 offset:41472
    s_add_u32 m0, s53, 115712
    s_nop 0
    buffer_load_dwordx4 v221, s[4:7], s69 offen lds
    s_waitcnt lgkmcnt(6)
    v_mfma_f32_32x32x16_bf16 v[144:159], v[160:163], v[16:19], v[144:159]
    v_mfma_f32_16x16x32_bf16 v[180:183], v[176:179], v[160:163], v[180:183]
    ds_read_b128 v[28:31], v225 offset:16384
    ds_read_b64_tr_b16 v[172:173], v199 offset:40960
    ds_read_b64_tr_b16 v[174:175], v199 offset:41472
    s_waitcnt lgkmcnt(6)
    v_mfma_f32_32x32x16_bf16 v[144:159], v[164:167], v[20:23], v[144:159]
    s_waitcnt vmcnt(4) lgkmcnt(0)
    s_barrier
    ds_read_b128 v[32:35], v222 offset:49152
    v_add_u32 v196, 0x10000, v196
    ds_read_b64_tr_b16 v[160:161], v196 offset:16384
    ds_read_b64_tr_b16 v[162:163], v196 offset:16896
    s_add_u32 m0, s52, 131072
    s_nop 0
    buffer_load_dwordx4 v202, s[8:11], s82 offen lds
    v_mov_b32 v226, 0
    v_mov_b32 v227, 0
    v_mov_b32 v228, 0
    v_mov_b32 v229, 0
    v_dot2c_f32_bf16 v226, v8, v234
    v_dot2c_f32_bf16 v228, v8, v8
    v_dot2c_f32_bf16 v227, v9, v234
    v_dot2c_f32_bf16 v229, v9, v9
    v_dot2c_f32_bf16 v226, v10, v234
    v_dot2c_f32_bf16 v228, v10, v10
    v_mfma_f32_32x32x16_bf16 v[144:159], v[168:171], v[24:27], v[144:159]
    ds_read_b128 v[36:39], v223 offset:49152
    v_add_u32 v197, 0x10000, v197
    ds_read_b64_tr_b16 v[164:165], v197 offset:16384
    ds_read_b64_tr_b16 v[166:167], v197 offset:16896
    s_add_u32 m0, s52, 139264
    s_nop 0
    buffer_load_dwordx4 v202, s[8:11], s83 offen lds
    v_dot2c_f32_bf16 v227, v11, v234
    v_dot2c_f32_bf16 v229, v11, v11
    v_dot2c_f32_bf16 v226, v12, v234
    v_dot2c_f32_bf16 v228, v12, v12
    v_dot2c_f32_bf16 v227, v13, v234
    v_dot2c_f32_bf16 v229, v13, v13
    v_dot2c_f32_bf16 v226, v14, v234
    v_dot2c_f32_bf16 v228, v14, v14
    v_dot2c_f32_bf16 v227, v15, v234
    v_dot2c_f32_bf16 v229, v15, v15
    v_mfma_f32_32x32x16_bf16 v[144:159], v[172:175], v[28:31], v[144:159]
    ds_read_b128 v[40:43], v224 offset:49152
    v_add_u32 v198, 0x10000, v198
    ds_read_b64_tr_b16 v[168:169], v198 offset:16384
    ds_read_b64_tr_b16 v[170:171], v198 offset:16896
    s_add_u32 m0, s53, 0
    s_nop 0
    buffer_load_dwordx4 v220, s[4:7], s70 offen lds
    v_dot2c_f32_bf16 v226, v24, v234
    v_dot2c_f32_bf16 v228, v24, v24
    v_dot2c_f32_bf16 v227, v25, v234
    v_dot2c_f32_bf16 v229, v25, v25
    v_dot2c_f32_bf16 v226, v26, v234
    v_dot2c_f32_bf16 v228, v26, v26
    v_dot2c_f32_bf16 v227, v27, v234
    v_dot2c_f32_bf16 v229, v27, v27
    v_dot2c_f32_bf16 v226, v28, v234
    v_dot2c_f32_bf16 v228, v28, v28
    s_waitcnt lgkmcnt(6)
    v_mfma_f32_32x32x16_bf16 v[144:159], v[160:163], v[32:35], v[144:159]
    v_mfma_f32_16x16x32_bf16 v[180:183], v[176:179], v[160:163], v[180:183]
    ds_read_b128 v[44:47], v225 offset:49152
    v_add_u32 v199, 0x10000, v199
    ds_read_b64_tr_b16 v[172:173], v199 offset:16384
    ds_read_b64_tr_b16 v[174:175], v199 offset:16896
    v_dot2c_f32_bf16 v227, v29, v234
    v_dot2c_f32_bf16 v229, v29, v29
    v_dot2c_f32_bf16 v226, v30, v234
    v_dot2c_f32_bf16 v228, v30, v30
    v_dot2c_f32_bf16 v227, v31, v234
    v_dot2c_f32_bf16 v229, v31, v31
    s_waitcnt lgkmcnt(6)
    v_mfma_f32_32x32x16_bf16 v[144:159], v[164:167], v[36:39], v[144:159]
    v_add_u32 v222, 0x10000, v222
    ds_read_b128 v[48:51], v222 offset:0
    ds_read_b64_tr_b16 v[160:161], v196 offset:24576
    ds_read_b64_tr_b16 v[162:163], v196 offset:25088
    s_add_u32 m0, s53, 1024
    s_nop 0
    buffer_load_dwordx4 v221, s[4:7], s70 offen lds
    s_waitcnt lgkmcnt(6)
    v_mfma_f32_32x32x16_bf16 v[144:159], v[168:171], v[40:43], v[144:159]
    v_add_u32 v223, 0x10000, v223
    ds_read_b128 v[52:55], v223 offset:0
    ds_read_b64_tr_b16 v[164:165], v197 offset:24576
    ds_read_b64_tr_b16 v[166:167], v197 offset:25088
    s_add_u32 m0, s52, 16384
    s_nop 0
    buffer_load_dwordx4 v202, s[8:11], s84 offen lds
    ds_read_u16 v236, v113 offset:0
    ds_read_u16 v244, v113 offset:56
    ds_read_u16 v237, v113 offset:112
    ds_read_u16 v245, v113 offset:168
    ds_read_u16 v238, v113 offset:448
    ds_read_u16 v246, v113 offset:504
    ds_read_u16 v239, v113 offset:560
    ds_read_u16 v247, v113 offset:616
    ds_read_u16 v240, v113 offset:896
    ds_read_u16 v248, v113 offset:952
    s_waitcnt lgkmcnt(15)
    v_mfma_f32_32x32x16_bf16 v[144:159], v[172:175], v[44:47], v[144:159]
    v_add_u32 v224, 0x10000, v224
    ds_read_b128 v[56:59], v224 offset:0
    ds_read_b64_tr_b16 v[168:169], v198 offset:24576
    ds_read_b64_tr_b16 v[170:171], v198 offset:25088
    s_add_u32 m0, s52, 32768
    s_nop 0
    buffer_load_dwordx4 v200, s[8:11], s78 offen lds
    ds_read_u16 v241, v113 offset:1008
    ds_read_u16 v249, v113 offset:1064
    ds_read_u16 v242, v113 offset:1120
    ds_read_u16 v250, v113 offset:1176
    ds_read_u16 v243, v113 offset:1232
    ds_read_u16 v251, v113 offset:1288
    s_waitcnt lgkmcnt(15)
    v_mfma_f32_32x32x16_bf16 v[144:159], v[160:163], v[48:51], v[144:159]
    v_mfma_f32_16x16x32_bf16 v[180:183], v[176:179], v[160:163], v[180:183]
    v_add_u32 v225, 0x10000, v225
    ds_read_b128 v[60:63], v225 offset:0
    ds_read_b64_tr_b16 v[172:173], v199 offset:24576
    ds_read_b64_tr_b16 v[174:175], v199 offset:25088
    s_add_u32 m0, s52, 40960
    s_nop 0
    buffer_load_dwordx4 v200, s[8:11], s79 offen lds
    v_mfma_f32_32x32x16_bf16 v[144:159], v[164:167], v[52:55], v[144:159]
    s_waitcnt vmcnt(5) lgkmcnt(0)
    s_barrier
    ds_read_b128 v[64:67], v222 offset:32768
    v_add_u32 v196, 0x10000, v196
    ds_read_b64_tr_b16 v[160:161], v196 offset:0
    ds_read_b64_tr_b16 v[162:163], v196 offset:512
    s_add_u32 m0, s52, 49152
    s_nop 0
    buffer_load_dwordx4 v200, s[8:11], s80 offen lds
    v_lshl_or_b32 v236, v244, 16, v236
    v_lshl_or_b32 v237, v245, 16, v237
    v_lshl_or_b32 v238, v246, 16, v238
    v_lshl_or_b32 v239, v247, 16, v239
    v_lshl_or_b32 v240, v248, 16, v240
    v_lshl_or_b32 v241, v249, 16, v241
    v_lshl_or_b32 v242, v250, 16, v242
    v_lshl_or_b32 v243, v251, 16, v243
    s_mov_b32 s94, 0xcc000000
    s_mov_b32 s95, 0xcc000000
    v_cndmask_b32 v236, v236, 0, s[94:95]
    v_cndmask_b32 v237, v237, 0, s[94:95]
    v_cndmask_b32 v238, v238, 0, s[94:95]
    v_cndmask_b32 v239, v239, 0, s[94:95]
    v_cndmask_b32 v240, v240, 0, s[94:95]
    v_cndmask_b32 v241, v241, 0, s[94:95]
    s_mov_b32 s94, -1
    v_cndmask_b32 v242, v242, 0, s[94:95]
    v_cndmask_b32 v243, v243, 0, s[94:95]
    v_mfma_f32_32x32x16_bf16 v[144:159], v[168:171], v[56:59], v[144:159]
    ds_read_b128 v[68:71], v223 offset:32768
    v_add_u32 v197, 0x10000, v197
    ds_read_b64_tr_b16 v[164:165], v197 offset:0
    ds_read_b64_tr_b16 v[166:167], v197 offset:512
    v_dot2c_f32_bf16 v226, v40, v234
    v_dot2c_f32_bf16 v228, v40, v40
    v_dot2c_f32_bf16 v227, v41, v234
    v_dot2c_f32_bf16 v229, v41, v41
    v_dot2c_f32_bf16 v226, v42, v234
    v_dot2c_f32_bf16 v228, v42, v42
    v_dot2c_f32_bf16 v227, v43, v234
    v_dot2c_f32_bf16 v229, v43, v43
    v_dot2c_f32_bf16 v226, v44, v234
    v_dot2c_f32_bf16 v228, v44, v44
    v_mfma_f32_32x32x16_bf16 v[144:159], v[172:175], v[60:63], v[144:159]
    ds_read_b128 v[72:75], v224 offset:32768
    v_add_u32 v198, 0x10000, v198
    ds_read_b64_tr_b16 v[168:169], v198 offset:0
    ds_read_b64_tr_b16 v[170:171], v198 offset:512
    s_add_u32 m0, s52, 57344
    s_nop 0
    buffer_load_dwordx4 v200, s[8:11], s81 offen lds
    v_dot2c_f32_bf16 v227, v45, v234
    v_dot2c_f32_bf16 v229, v45, v45
    v_dot2c_f32_bf16 v226, v46, v234
    v_dot2c_f32_bf16 v228, v46, v46
    v_dot2c_f32_bf16 v227, v47, v234
    v_dot2c_f32_bf16 v229, v47, v47
    v_dot2c_f32_bf16 v226, v56, v234
    v_dot2c_f32_bf16 v228, v56, v56
    v_dot2c_f32_bf16 v227, v57, v234
    v_dot2c_f32_bf16 v229, v57, v57
    s_waitcnt lgkmcnt(6)
    v_mfma_f32_32x32x16_bf16 v[144:159], v[160:163], v[64:67], v[144:159]
    v_mfma_f32_16x16x32_bf16 v[180:183], v[176:179], v[160:163], v[180:183]
    ds_read_b128 v[76:79], v225 offset:32768
    v_add_u32 v199, 0x10000, v199
    ds_read_b64_tr_b16 v[172:173], v199 offset:0
    ds_read_b64_tr_b16 v[174:175], v199 offset:512
    v_dot2c_f32_bf16 v226, v58, v234
    v_dot2c_f32_bf16 v228, v58, v58
    v_dot2c_f32_bf16 v227, v59, v234
    v_dot2c_f32_bf16 v229, v59, v59
    v_dot2c_f32_bf16 v226, v60, v234
    v_dot2c_f32_bf16 v228, v60, v60
    v_dot2c_f32_bf16 v227, v61, v234
    v_dot2c_f32_bf16 v229, v61, v61
    v_dot2c_f32_bf16 v226, v62, v234
    v_dot2c_f32_bf16 v228, v62, v62
    s_waitcnt lgkmcnt(6)
    v_mfma_f32_32x32x16_bf16 v[144:159], v[164:167], v[68:71], v[144:159]
    ds_read_b128 v[80:83], v222 offset:49152
    ds_read_b64_tr_b16 v[160:161], v196 offset:8192
    ds_read_b64_tr_b16 v[162:163], v196 offset:8704
    s_add_u32 m0, s52, 65536
    s_nop 0
    buffer_load_dwordx4 v200, s[8:11], s82 offen lds
    v_dot2c_f32_bf16 v227, v63, v234
    v_dot2c_f32_bf16 v229, v63, v63
    s_waitcnt lgkmcnt(6)
    v_mfma_f32_32x32x16_bf16 v[144:159], v[168:171], v[72:75], v[144:159]
    ds_read_b128 v[84:87], v223 offset:49152
    ds_read_b64_tr_b16 v[164:165], v197 offset:8192
    ds_read_b64_tr_b16 v[166:167], v197 offset:8704
    s_add_u32 m0, s52, 73728
    s_nop 0
    buffer_load_dwordx4 v200, s[8:11], s83 offen lds
    v_dot2c_f32_bf16 v226, v72, v234
    v_dot2c_f32_bf16 v228, v72, v72
    v_dot2c_f32_bf16 v227, v73, v234
    v_dot2c_f32_bf16 v229, v73, v73
    v_dot2c_f32_bf16 v226, v74, v234
    v_dot2c_f32_bf16 v228, v74, v74
    v_dot2c_f32_bf16 v227, v75, v234
    v_dot2c_f32_bf16 v229, v75, v75
    s_waitcnt lgkmcnt(6)
    v_mfma_f32_32x32x16_bf16 v[144:159], v[172:175], v[76:79], v[144:159]
    ds_read_b128 v[88:91], v224 offset:49152
    ds_read_b64_tr_b16 v[168:169], v198 offset:8192
    ds_read_b64_tr_b16 v[170:171], v198 offset:8704
    v_dot2c_f32_bf16 v226, v76, v234
    v_dot2c_f32_bf16 v228, v76, v76
    v_dot2c_f32_bf16 v227, v77, v234
    v_dot2c_f32_bf16 v229, v77, v77
    v_dot2c_f32_bf16 v226, v78, v234
    v_dot2c_f32_bf16 v228, v78, v78
    v_dot2c_f32_bf16 v227, v79, v234
    v_dot2c_f32_bf16 v229, v79, v79
    s_waitcnt lgkmcnt(6)
    v_mfma_f32_32x32x16_bf16 v[144:159], v[160:163], v[80:83], v[144:159]
    v_mfma_f32_16x16x32_bf16 v[180:183], v[176:179], v[160:163], v[180:183]
    ds_read_b128 v[92:95], v225 offset:49152
    ds_read_b64_tr_b16 v[172:173], v199 offset:8192
    ds_read_b64_tr_b16 v[174:175], v199 offset:8704
    s_add_u32 m0, s52, 24576
    s_nop 0
    buffer_load_dwordx4 v200, s[8:11], s84 offen lds
    s_waitcnt lgkmcnt(6)
    v_mfma_f32_32x32x16_bf16 v[144:159], v[164:167], v[84:87], v[144:159]
    s_waitcnt vmcnt(7)
    s_barrier
    v_add_u32 v222, 0xffff0000, v222
    ds_read_b128 v[96:99], v222 offset:0
    v_add_u32 v196, 0xfffe0000, v196
    ds_read_b64_tr_b16 v[160:161], v196 offset:16384
    ds_read_b64_tr_b16 v[162:163], v196 offset:16896
    s_waitcnt lgkmcnt(6)
    v_mfma_f32_32x32x16_bf16 v[144:159], v[168:171], v[88:91], v[144:159]
    v_add_u32 v223, 0xffff0000, v223
    ds_read_b128 v[100:103], v223 offset:0
    v_add_u32 v197, 0xfffe0000, v197
    ds_read_b64_tr_b16 v[164:165], v197 offset:16384
    ds_read_b64_tr_b16 v[166:167], v197 offset:16896
    v_dot2c_f32_bf16 v226, v88, v234
    v_dot2c_f32_bf16 v228, v88, v88
    v_dot2c_f32_bf16 v227, v89, v234
    v_dot2c_f32_bf16 v229, v89, v89
    v_dot2c_f32_bf16 v226, v90, v234
    v_dot2c_f32_bf16 v228, v90, v90
    v_dot2c_f32_bf16 v227, v91, v234
    v_dot2c_f32_bf16 v229, v91, v91
    s_waitcnt lgkmcnt(6)
    v_mfma_f32_32x32x16_bf16 v[144:159], v[172:175], v[92:95], v[144:159]
    v_add_u32 v224, 0xffff0000, v224
    ds_read_b128 v[104:107], v224 offset:0
    v_add_u32 v198, 0xfffe0000, v198
    ds_read_b64_tr_b16 v[168:169], v198 offset:16384
    ds_read_b64_tr_b16 v[170:171], v198 offset:16896
    v_dot2c_f32_bf16 v226, v92, v234
    v_dot2c_f32_bf16 v228, v92, v92
    v_dot2c_f32_bf16 v227, v93, v234
    v_dot2c_f32_bf16 v229, v93, v93
    v_dot2c_f32_bf16 v226, v94, v234
    v_dot2c_f32_bf16 v228, v94, v94
    v_dot2c_f32_bf16 v227, v95, v234
    v_dot2c_f32_bf16 v229, v95, v95
    v_add_u32 v201, s53, v204
    v_add_u32 v201, 0x14000, v201
    s_waitcnt lgkmcnt(6)
    v_mfma_f32_32x32x16_bf16 v[144:159], v[160:163], v[96:99], v[144:159]
    v_mfma_f32_16x16x32_bf16 v[180:183], v[176:179], v[160:163], v[180:183]
    v_add_u32 v225, 0xffff0000, v225
    ds_read_b128 v[108:111], v225 offset:0
    v_add_u32 v199, 0xfffe0000, v199
    ds_read_b64_tr_b16 v[172:173], v199 offset:16384
    ds_read_b64_tr_b16 v[174:175], v199 offset:16896
    ds_write_b128 v201, v[236:239]
    ds_write_b128 v201, v[240:243] offset:1024
    v_add_u32 v201, 0x14000, v204
    s_waitcnt lgkmcnt(8)
    v_mfma_f32_32x32x16_bf16 v[144:159], v[164:167], v[100:103], v[144:159]
    s_waitcnt lgkmcnt(5)
    v_mfma_f32_32x32x16_bf16 v[144:159], v[168:171], v[104:107], v[144:159]
    ds_write_b32 v206, v180 offset:0
    v_dot2c_f32_bf16 v226, v104, v234
    v_dot2c_f32_bf16 v228, v104, v104
    v_dot2c_f32_bf16 v227, v105, v234
    v_dot2c_f32_bf16 v229, v105, v105
    v_dot2c_f32_bf16 v226, v106, v234
    v_dot2c_f32_bf16 v228, v106, v106
    v_dot2c_f32_bf16 v227, v107, v234
    v_dot2c_f32_bf16 v229, v107, v107
    s_waitcnt lgkmcnt(3)
    v_mfma_f32_32x32x16_bf16 v[144:159], v[172:175], v[108:111], v[144:159]
    v_dot2c_f32_bf16 v226, v108, v234
    v_dot2c_f32_bf16 v228, v108, v108
    v_dot2c_f32_bf16 v227, v109, v234
    v_dot2c_f32_bf16 v229, v109, v109
    v_dot2c_f32_bf16 v226, v110, v234
    v_dot2c_f32_bf16 v228, v110, v110
    v_dot2c_f32_bf16 v227, v111, v234
    v_dot2c_f32_bf16 v229, v111, v111
    s_nop 1
    v_add_f32 v226, v226, v227
    v_add_f32 v227, v228, v229
    v_and_b32 v230, 0x1f0, v204
    v_lshlrev_b32 v230, 1, v230
    s_lshl_b32 s94, s45, 10
    s_add_u32 s94, s94, 147456
    v_add_u32 v230, s94, v230
    v_lshrrev_b32 v231, 9, v204
    v_lshl_add_u32 v231, v231, 3, v230
    ds_write_b64 v231, v[226:227] offset:16
    s_waitcnt vmcnt(0) lgkmcnt(0)
    s_barrier
    ds_read_b64_tr_b16 v[160:161], v196 offset:32768
    ds_read_b64_tr_b16 v[162:163], v196 offset:33280
    ds_read_b64_tr_b16 v[164:165], v197 offset:32768
    ds_read_b64_tr_b16 v[166:167], v197 offset:33280
    ds_read_b64_tr_b16 v[168:169], v198 offset:32768
    ds_read_b64_tr_b16 v[170:171], v198 offset:33280
    ds_read_b64_tr_b16 v[172:173], v199 offset:32768
    ds_read_b64_tr_b16 v[174:175], v199 offset:33280
    ds_read_b64_tr_b16 v[128:129], v196 offset:40960
    ds_read_b64_tr_b16 v[130:131], v196 offset:41472
    ds_read_b64_tr_b16 v[132:133], v197 offset:40960
    ds_read_b64_tr_b16 v[134:135], v197 offset:41472
    ds_read_b64_tr_b16 v[136:137], v198 offset:40960
    ds_read_b64_tr_b16 v[138:139], v198 offset:41472
    s_waitcnt lgkmcnt(12)
    v_mfma_f32_32x32x16_bf16 v[112:127], v[160:163], v[0:3], 0
    v_mfma_f32_16x16x32_bf16 v[180:183], v[176:179], v[160:163], 0
    ds_read_b64_tr_b16 v[140:141], v199 offset:40960
    ds_read_b64_tr_b16 v[142:143], v199 offset:41472
    v_add_u32 v200, 112, v200
    s_add_u32 m0, s52, 98304
    s_nop 0
    buffer_load_dwordx4 v200, s[8:11], s78 offen lds
    ds_read_b128 v[220:223], v230
    ds_read_b128 v[224:227], v230 offset:16
    s_waitcnt lgkmcnt(14)
    v_mfma_f32_32x32x16_bf16 v[112:127], v[164:167], v[4:7], v[112:127]
    ds_read_b64_tr_b16 v[160:161], v196 offset:49152
    ds_read_b64_tr_b16 v[162:163], v196 offset:49664
    s_waitcnt lgkmcnt(14)
    v_mfma_f32_32x32x16_bf16 v[112:127], v[168:171], v[8:11], v[112:127]
    ds_read_b64_tr_b16 v[164:165], v197 offset:49152
    ds_read_b64_tr_b16 v[166:167], v197 offset:49664
    s_waitcnt lgkmcnt(5)
    v_add_f32 v220, v220, v222
    v_add_f32 v221, v221, v223
    s_waitcnt lgkmcnt(4)
    v_add_f32 v224, v224, v226
    v_mfma_f32_32x32x16_bf16 v[112:127], v[172:175], v[12:15], v[112:127]
    ds_read_b64_tr_b16 v[168:169], v198 offset:49152
    ds_read_b64_tr_b16 v[170:171], v198 offset:49664
    v_add_f32 v225, v225, v227
    v_add_f32 v220, v220, v224
    v_add_f32 v221, v221, v225
    v_mfma_f32_32x32x16_bf16 v[112:127], v[128:131], v[16:19], v[112:127]
    v_mfma_f32_16x16x32_bf16 v[180:183], v[176:179], v[128:131], v[180:183]
    ds_read_b64_tr_b16 v[172:173], v199 offset:49152
    ds_read_b64_tr_b16 v[174:175], v199 offset:49664
    s_add_u32 m0, s52, 106496
    s_nop 0
    buffer_load_dwordx4 v200, s[8:11], s79 offen lds
    v_mul_f32 v208, 0xbb124925, v220
    v_mul_f32 v221, 0x3b124925, v221
    v_fma_f32 v221, -v208, v208, v221
    v_mfma_f32_32x32x16_bf16 v[112:127], v[132:135], v[20:23], v[112:127]
    ds_read_b64_tr_b16 v[128:129], v196 offset:57344
    ds_read_b64_tr_b16 v[130:131], v196 offset:57856
    v_max_f32 v221, 0, v221
    v_add_f32 v221, 0x3727c5ac, v221
    v_rsq_f32 v209, v221
    v_mfma_f32_32x32x16_bf16 v[112:127], v[136:139], v[24:27], v[112:127]
    ds_read_b64_tr_b16 v[132:133], v197 offset:57344
    ds_read_b64_tr_b16 v[134:135], v197 offset:57856
    v_rcp_f32 v210, v221
    s_nop 0
    v_mul_f32 v211, 0x3fb8aa3b, v209
    v_mfma_f32_32x32x16_bf16 v[112:127], v[140:143], v[28:31], v[112:127]
    ds_read_b64_tr_b16 v[136:137], v198 offset:57344
    ds_read_b64_tr_b16 v[138:139], v198 offset:57856
    s_add_u32 m0, s52, 114688
    s_nop 0
    buffer_load_dwordx4 v200, s[8:11], s80 offen lds
    s_setprio 2
    ds_read_b64 v[228:229], v207 offset:0
    s_waitcnt lgkmcnt(13)
    v_mfma_f32_32x32x16_bf16 v[112:127], v[160:163], v[32:35], v[112:127]
    v_mfma_f32_16x16x32_bf16 v[180:183], v[176:179], v[160:163], v[180:183]
    ds_read_b64_tr_b16 v[140:141], v199 offset:57344
    ds_read_b64_tr_b16 v[142:143], v199 offset:57856
    s_waitcnt lgkmcnt(13)
    v_mfma_f32_32x32x16_bf16 v[112:127], v[164:167], v[36:39], v[112:127]
    v_add_u32 v196, 0x10000, v196
    ds_read_b64_tr_b16 v[160:161], v196 offset:0
    ds_read_b64_tr_b16 v[162:163], v196 offset:512
    s_waitcnt lgkmcnt(4)
    v_add_f32 v228, v228, v229
    v_mfma_f32_32x32x16_bf16 v[112:127], v[168:171], v[40:43], v[112:127]
    v_add_u32 v197, 0x10000, v197
    ds_read_b64_tr_b16 v[164:165], v197 offset:0
    ds_read_b64_tr_b16 v[166:167], v197 offset:512
    v_mfma_f32_32x32x2_f32 v[144:159], v228, v208, v[144:159]
    v_mfma_f32_32x32x16_bf16 v[112:127], v[172:175], v[44:47], v[112:127]
    v_add_u32 v198, 0x10000, v198
    ds_read_b64_tr_b16 v[168:169], v198 offset:0
    ds_read_b64_tr_b16 v[170:171], v198 offset:512
    s_add_u32 m0, s52, 122880
    s_nop 0
    buffer_load_dwordx4 v200, s[8:11], s81 offen lds
    v_mfma_f32_32x32x16_bf16 v[112:127], v[128:131], v[48:51], v[112:127]
    v_mfma_f32_16x16x32_bf16 v[180:183], v[176:179], v[128:131], v[180:183]
    v_add_u32 v199, 0x10000, v199
    ds_read_b64_tr_b16 v[172:173], v199 offset:0
    ds_read_b64_tr_b16 v[174:175], v199 offset:512
    v_mfma_f32_32x32x16_bf16 v[112:127], v[132:135], v[52:55], v[112:127]
    ds_read_b64_tr_b16 v[128:129], v196 offset:8192
    ds_read_b64_tr_b16 v[130:131], v196 offset:8704
    v_mfma_f32_32x32x16_bf16 v[112:127], v[136:139], v[56:59], v[112:127]
    ds_read_b64_tr_b16 v[132:133], v197 offset:8192
    ds_read_b64_tr_b16 v[134:135], v197 offset:8704
    s_nop 1
    v_mul_f32 v144, v144, v209
    v_mul_f32 v145, v145, v209
    v_mul_f32 v146, v146, v209
    s_waitcnt lgkmcnt(12)
    v_mfma_f32_32x32x16_bf16 v[112:127], v[140:143], v[60:63], v[112:127]
    ds_read_b64_tr_b16 v[136:137], v198 offset:8192
    ds_read_b64_tr_b16 v[138:139], v198 offset:8704
    v_mul_f32 v147, v147, v209
    v_mul_f32 v148, v148, v209
    v_mul_f32 v149, v149, v209
    s_waitcnt lgkmcnt(12)
    v_mfma_f32_32x32x16_bf16 v[112:127], v[160:163], v[64:67], v[112:127]
    v_mfma_f32_16x16x32_bf16 v[180:183], v[176:179], v[160:163], v[180:183]
    ds_read_b64_tr_b16 v[140:141], v199 offset:8192
    ds_read_b64_tr_b16 v[142:143], v199 offset:8704
    v_mul_f32 v150, v150, v209
    v_mul_f32 v151, v151, v209
    v_mul_f32 v152, v152, v209
    s_waitcnt lgkmcnt(12)
    v_mfma_f32_32x32x16_bf16 v[112:127], v[164:167], v[68:71], v[112:127]
    v_add_u32 v196, 0xffff0000, v196
    ds_read_b64_tr_b16 v[160:161], v196 offset:24576
    ds_read_b64_tr_b16 v[162:163], v196 offset:25088
    v_mul_f32 v153, v153, v209
    v_mul_f32 v154, v154, v209
    v_mul_f32 v155, v155, v209
    s_waitcnt lgkmcnt(12)
    v_mfma_f32_32x32x16_bf16 v[112:127], v[168:171], v[72:75], v[112:127]
    v_add_u32 v197, 0xffff0000, v197
    ds_read_b64_tr_b16 v[164:165], v197 offset:24576
    ds_read_b64_tr_b16 v[166:167], v197 offset:25088
    v_mul_f32 v156, v156, v209
    v_mul_f32 v157, v157, v209
    v_mul_f32 v158, v158, v209
    s_waitcnt lgkmcnt(12)
    v_mfma_f32_32x32x16_bf16 v[112:127], v[172:175], v[76:79], v[112:127]
    v_add_u32 v198, 0xffff0000, v198
    ds_read_b64_tr_b16 v[168:169], v198 offset:24576
    ds_read_b64_tr_b16 v[170:171], v198 offset:25088
    v_mul_f32 v159, v159, v209
    v_cndmask_b32 v156, v156, 1.0, s[60:61]
    v_cvt_pk_bf16_f32 v144, v144, v145
    s_waitcnt lgkmcnt(12)
    v_mfma_f32_32x32x16_bf16 v[112:127], v[128:131], v[80:83], v[112:127]
    v_mfma_f32_16x16x32_bf16 v[180:183], v[176:179], v[128:131], v[180:183]
    v_add_u32 v199, 0xffff0000, v199
    ds_read_b64_tr_b16 v[172:173], v199 offset:24576
    ds_read_b64_tr_b16 v[174:175], v199 offset:25088
    v_cvt_pk_bf16_f32 v145, v146, v147
    v_cvt_pk_bf16_f32 v146, v148, v149
    v_cvt_pk_bf16_f32 v147, v150, v151
    s_waitcnt lgkmcnt(12)
    v_mfma_f32_32x32x16_bf16 v[112:127], v[132:135], v[84:87], v[112:127]
    v_cvt_pk_bf16_f32 v148, v152, v153
    v_cvt_pk_bf16_f32 v149, v154, v155
    v_cvt_pk_bf16_f32 v150, v156, v157
    s_waitcnt lgkmcnt(10)
    v_mfma_f32_32x32x16_bf16 v[112:127], v[136:139], v[88:91], v[112:127]
    v_cvt_pk_bf16_f32 v151, v158, v159
    v_bfe_u32 v252, v204, 6, 1
    v_bfe_u32 v253, v204, 7, 1
    s_waitcnt lgkmcnt(8)
    v_mfma_f32_32x32x16_bf16 v[112:127], v[140:143], v[92:95], v[112:127]
    v_lshl_or_b32 v252, v253, 2, v252
    v_lshrrev_b32 v253, 9, v204
    v_xor_b32 v252, v252, v253
    s_waitcnt lgkmcnt(6)
    v_mfma_f32_32x32x16_bf16 v[112:127], v[160:163], v[96:99], v[112:127]
    v_mfma_f32_16x16x32_bf16 v[180:183], v[176:179], v[160:163], v[180:183]
    v_lshlrev_b32 v252, 3, v252
    v_and_b32 v253, 0x1f0, v204
    v_lshl_add_u32 v252, v253, 2, v252
    s_waitcnt lgkmcnt(4)
    v_mfma_f32_32x32x16_bf16 v[112:127], v[164:167], v[100:103], v[112:127]
    s_lshl_b32 s94, s45, 11
    s_add_u32 s94, s94, 155648
    v_add_u32 v252, s94, v252
    ds_write_b64 v252, v[144:145]
    s_waitcnt lgkmcnt(3)
    v_mfma_f32_32x32x16_bf16 v[112:127], v[168:171], v[104:107], v[112:127]
    v_xor_b32 v253, 16, v252
    ds_write_b64 v253, v[146:147]
    v_xor_b32 v253, 32, v252
    s_waitcnt lgkmcnt(2)
    v_mfma_f32_32x32x16_bf16 v[112:127], v[172:175], v[108:111], v[112:127]
    ds_write_b64 v253, v[148:149]
    v_xor_b32 v253, 48, v252
    ds_write_b64 v253, v[150:151]
    ds_write_b32 v206, v180 offset:2048
    s_waitcnt lgkmcnt(0)
    s_barrier
    s_setprio 3
    v_lshrrev_b32 v248, 8, v204
    v_bfe_u32 v249, v204, 6, 2
    v_bfe_u32 v250, v204, 4, 2
    v_and_b32 v245, 1, v248
    v_lshlrev_b32 v245, 2, v245
    v_xor_b32 v244, v249, v245
    v_lshrrev_b32 v246, 1, v250
    v_lshl_add_u32 v246, s45, 1, v246
    v_xor_b32 v244, v244, v246
    v_lshlrev_b32 v244, 4, v244
    v_and_b32 v246, 1, v250
    v_lshl_add_u32 v244, v246, 3, v244
    v_lshl_add_u32 v248, v248, 3, v249
    v_lshl_add_u32 v244, v248, 7, v244
    v_add_u32 v244, 0x0, v244
    v_or_b32 v246, 4, v250
    v_xor_b32 v246, v246, v245
    v_lshlrev_b32 v246, 3, v246
    v_lshl_add_u32 v246, v248, 6, v246
    v_add_u32 v246, 0x26000, v246
    v_xor_b32 v245, 64, v244
    v_xor_b32 v247, 8, v246
    ds_read_b64_tr_b16 v[220:221], v244 offset:0
    ds_read_b64_tr_b16 v[222:223], v245 offset:512
    ds_read_b64_tr_b16 v[224:225], v246 offset:0
    ds_read_b64_tr_b16 v[226:227], v247 offset:256
    ds_read_b64_tr_b16 v[228:229], v244 offset:4096
    ds_read_b64_tr_b16 v[230:231], v245 offset:4608
    ds_read_b64_tr_b16 v[232:233], v246 offset:2048
    ds_read_b64_tr_b16 v[234:235], v247 offset:2304
    s_waitcnt lgkmcnt(4)
    v_mfma_f32_16x16x32_bf16 v[236:239], v[220:223], v[224:227], 0
    s_waitcnt lgkmcnt(0)
    v_mfma_f32_16x16x32_bf16 v[236:239], v[228:231], v[232:235], v[236:239]
    ds_read_b64_tr_b16 v[220:221], v244 offset:8192
    ds_read_b64_tr_b16 v[222:223], v245 offset:8704
    ds_read_b64_tr_b16 v[224:225], v246 offset:4096
    ds_read_b64_tr_b16 v[226:227], v247 offset:4352
    ds_read_b64_tr_b16 v[228:229], v244 offset:12288
    ds_read_b64_tr_b16 v[230:231], v245 offset:12800
    ds_read_b64_tr_b16 v[232:233], v246 offset:6144
    ds_read_b64_tr_b16 v[234:235], v247 offset:6400
    s_waitcnt lgkmcnt(4)
    v_mfma_f32_16x16x32_bf16 v[236:239], v[220:223], v[224:227], v[236:239]
    s_waitcnt lgkmcnt(0)
    v_mfma_f32_16x16x32_bf16 v[236:239], v[228:231], v[232:235], v[236:239]
    v_lshrrev_b32 v248, 8, v204
    v_bfe_u32 v250, v204, 4, 4
    v_lshlrev_b32 v250, 2, v250
    v_lshl_add_u32 v248, v248, 9, v250
    s_lshl_b32 s94, s50, 13
    s_lshl_b32 s95, s45, 11
    s_add_u32 s94, s94, s95
    s_add_u32 s94, s94, 10485824
    buffer_atomic_add_f32 v236, v248, s[40:43], s94 offen offset:0
    buffer_atomic_add_f32 v237, v248, s[40:43], s94 offen offset:128
    buffer_atomic_add_f32 v238, v248, s[40:43], s94 offen offset:256
    buffer_atomic_add_f32 v239, v248, s[40:43], s94 offen offset:384
    s_setprio 3
    ds_read_b128 v[236:239], v201 offset:2048
    ds_read_b128 v[240:243], v201 offset:3072
    ds_read_b64 v[228:229], v207 offset:2048
    s_add_u32 m0, s52, 131072
    s_nop 0
    buffer_load_dwordx4 v200, s[8:11], s82 offen lds
    s_waitcnt lgkmcnt(0)
    v_add_f32 v228, v228, v229
    s_nop 1
    v_mfma_f32_32x32x2_f32 v[112:127], v228, v208, v[112:127]
    s_nop 15
    s_nop 3
    v_cvt_pk_bf16_f32 v112, v112, v113
    v_cvt_pk_bf16_f32 v113, v114, v115
    s_add_u32 m0, s52, 139264
    s_nop 0
    buffer_load_dwordx4 v200, s[8:11], s83 offen lds
    v_cvt_pk_bf16_f32 v114, v116, v117
    v_cvt_pk_bf16_f32 v115, v118, v119
    v_cvt_pk_bf16_f32 v116, v120, v121
    v_cvt_pk_bf16_f32 v117, v122, v123
    v_cvt_pk_bf16_f32 v118, v124, v125
    v_cvt_pk_bf16_f32 v119, v126, v127
    v_mfma_f32_32x32x16_bf16 v[220:235], v[236:239], v[112:115], 0
    s_add_u32 m0, s52, 16384
    s_nop 0
    buffer_load_dwordx4 v200, s[8:11], s84 offen lds
    v_mfma_f32_32x32x16_bf16 v[220:235], v[240:243], v[116:119], v[220:235]
    s_setprio 0
    s_nop 10
    v_max3_f32 v244, v220, v221, v222
    v_min3_f32 v245, v220, v221, v222
    v_max3_f32 v244, v244, v223, v224
    v_min3_f32 v245, v245, v223, v224
    v_max3_f32 v244, v244, v225, v226
    v_min3_f32 v245, v245, v225, v226
    v_max3_f32 v244, v244, v227, v228
    v_min3_f32 v245, v245, v227, v228
    v_max3_f32 v244, v244, v229, v230
    v_min3_f32 v245, v245, v229, v230
    v_max3_f32 v244, v244, v231, v232
    v_min3_f32 v245, v245, v231, v232
    v_max_f32 v244, v244, v233
    v_min_f32 v245, v245, v233
    v_mul_f32 v245, -1.0, v245
    s_nop 1
    v_permlane32_swap_b32 v244, v245
    v_max_f32 v244, v244, v245
    v_mov_b32 v245, v244
    s_nop 1
    v_permlane32_swap_b32 v244, v245
    v_mul_f32 v244, v244, v211
    v_mul_f32 v245, v245, v211
    v_fma_f32 v112, -v220, v211, -v245
    v_fma_f32 v113, -v221, v211, -v245
    v_fma_f32 v220, v220, v211, -v244
    v_fma_f32 v221, v221, v211, -v244
    v_fma_f32 v114, -v222, v211, -v245
    v_fma_f32 v115, -v223, v211, -v245
    v_fma_f32 v222, v222, v211, -v244
    v_fma_f32 v223, v223, v211, -v244
    v_fma_f32 v116, -v224, v211, -v245
    v_fma_f32 v117, -v225, v211, -v245
    v_fma_f32 v224, v224, v211, -v244
    v_fma_f32 v225, v225, v211, -v244
    v_fma_f32 v118, -v226, v211, -v245
    v_fma_f32 v119, -v227, v211, -v245
    v_fma_f32 v226, v226, v211, -v244
    v_fma_f32 v227, v227, v211, -v244
    v_fma_f32 v120, -v228, v211, -v245
    v_fma_f32 v121, -v229, v211, -v245
    v_fma_f32 v228, v228, v211, -v244
    v_fma_f32 v229, v229, v211, -v244
    v_fma_f32 v122, -v230, v211, -v245
    v_fma_f32 v123, -v231, v211, -v245
    v_fma_f32 v230, v230, v211, -v244
    v_fma_f32 v231, v231, v211, -v244
    v_fma_f32 v124, -v232, v211, -v245
    v_fma_f32 v125, -v233, v211, -v245
    v_fma_f32 v232, v232, v211, -v244
    v_fma_f32 v233, v233, v211, -v244
    v_exp_f32 v112, v112
    v_exp_f32 v220, v220
    v_exp_f32 v113, v113
    v_exp_f32 v221, v221
    v_exp_f32 v114, v114
    v_exp_f32 v222, v222
    v_exp_f32 v115, v115
    v_exp_f32 v223, v223
    v_exp_f32 v116, v116
    v_exp_f32 v224, v224
    v_exp_f32 v117, v117
    v_exp_f32 v225, v225
    v_exp_f32 v118, v118
    v_exp_f32 v226, v226
    v_exp_f32 v119, v119
    v_exp_f32 v227, v227
    v_exp_f32 v120, v120
    v_exp_f32 v228, v228
    v_exp_f32 v121, v121
    v_exp_f32 v229, v229
    v_exp_f32 v122, v122
    v_exp_f32 v230, v230
    v_exp_f32 v123, v123
    v_exp_f32 v231, v231
    v_exp_f32 v124, v124
    v_exp_f32 v232, v232
    v_exp_f32 v125, v125
    v_exp_f32 v233, v233
    v_cvt_pk_bf16_f32 v144, v220, v221
    v_cvt_pk_bf16_f32 v152, v112, v113
    v_cvt_pk_bf16_f32 v145, v222, v223
    v_cvt_pk_bf16_f32 v153, v114, v115
    v_cvt_pk_bf16_f32 v146, v224, v225
    v_cvt_pk_bf16_f32 v154, v116, v117
    v_cvt_pk_bf16_f32 v147, v226, v227
    v_cvt_pk_bf16_f32 v155, v118, v119
    v_cvt_pk_bf16_f32 v148, v228, v229
    v_cvt_pk_bf16_f32 v156, v120, v121
    v_cvt_pk_bf16_f32 v149, v230, v231
    v_cvt_pk_bf16_f32 v157, v122, v123
    v_cvt_pk_bf16_f32 v150, v232, v233
    v_cvt_pk_bf16_f32 v158, v124, v125
    v_mov_b32 v151, 0
    v_mov_b32 v159, 0
    s_setprio 2
    s_waitcnt vmcnt(0)
    s_barrier
    v_add_u32 v196, 0x10000, v196
    ds_read_b64_tr_b16 v[160:161], v196 offset:32768
    ds_read_b64_tr_b16 v[162:163], v196 offset:33280
    v_add_u32 v197, 0x10000, v197
    ds_read_b64_tr_b16 v[164:165], v197 offset:32768
    ds_read_b64_tr_b16 v[166:167], v197 offset:33280
    v_add_u32 v198, 0x10000, v198
    ds_read_b64_tr_b16 v[168:169], v198 offset:32768
    ds_read_b64_tr_b16 v[170:171], v198 offset:33280
    v_add_u32 v199, 0x10000, v199
    ds_read_b64_tr_b16 v[172:173], v199 offset:32768
    ds_read_b64_tr_b16 v[174:175], v199 offset:33280
    ds_read_b64_tr_b16 v[128:129], v196 offset:40960
    ds_read_b64_tr_b16 v[130:131], v196 offset:41472
    ds_read_b64_tr_b16 v[132:133], v197 offset:40960
    ds_read_b64_tr_b16 v[134:135], v197 offset:41472
    ds_read_b64_tr_b16 v[136:137], v198 offset:40960
    ds_read_b64_tr_b16 v[138:139], v198 offset:41472
    s_waitcnt lgkmcnt(12)
    v_mfma_f32_32x32x16_bf16 v[112:127], v[160:163], v[0:3], 0
    v_mfma_f32_16x16x32_bf16 v[180:183], v[176:179], v[160:163], 0
    ds_read_b64_tr_b16 v[140:141], v199 offset:40960
    ds_read_b64_tr_b16 v[142:143], v199 offset:41472
    v_add_u32 v200, 112, v200
    s_add_u32 m0, s52, 32768
    s_nop 0
    buffer_load_dwordx4 v200, s[8:11], s78 offen lds
    s_waitcnt lgkmcnt(12)
    v_mfma_f32_32x32x16_bf16 v[112:127], v[164:167], v[4:7], v[112:127]
    ds_read_b64_tr_b16 v[160:161], v196 offset:49152
    ds_read_b64_tr_b16 v[162:163], v196 offset:49664
    s_waitcnt lgkmcnt(12)
    v_mfma_f32_32x32x16_bf16 v[112:127], v[168:171], v[8:11], v[112:127]
    ds_read_b64_tr_b16 v[164:165], v197 offset:49152
    ds_read_b64_tr_b16 v[166:167], v197 offset:49664
    s_waitcnt lgkmcnt(12)
    v_mfma_f32_32x32x16_bf16 v[112:127], v[172:175], v[12:15], v[112:127]
    ds_read_b64_tr_b16 v[168:169], v198 offset:49152
    ds_read_b64_tr_b16 v[170:171], v198 offset:49664
    s_waitcnt lgkmcnt(12)
    v_mfma_f32_32x32x16_bf16 v[112:127], v[128:131], v[16:19], v[112:127]
    v_mfma_f32_16x16x32_bf16 v[180:183], v[176:179], v[128:131], v[180:183]
    ds_read_b64_tr_b16 v[172:173], v199 offset:49152
    ds_read_b64_tr_b16 v[174:175], v199 offset:49664
    s_add_u32 m0, s52, 40960
    s_nop 0
    buffer_load_dwordx4 v200, s[8:11], s79 offen lds
    s_waitcnt lgkmcnt(12)
    v_mfma_f32_32x32x16_bf16 v[112:127], v[132:135], v[20:23], v[112:127]
    ds_read_b64_tr_b16 v[128:129], v196 offset:57344
    ds_read_b64_tr_b16 v[130:131], v196 offset:57856
    s_waitcnt lgkmcnt(12)
    v_mfma_f32_32x32x16_bf16 v[112:127], v[136:139], v[24:27], v[112:127]
    ds_read_b64_tr_b16 v[132:133], v197 offset:57344
    ds_read_b64_tr_b16 v[134:135], v197 offset:57856
    s_waitcnt lgkmcnt(12)
    v_mfma_f32_32x32x16_bf16 v[112:127], v[140:143], v[28:31], v[112:127]
    ds_read_b64_tr_b16 v[136:137], v198 offset:57344
    ds_read_b64_tr_b16 v[138:139], v198 offset:57856
    s_add_u32 m0, s52, 49152
    s_nop 0
    buffer_load_dwordx4 v200, s[8:11], s80 offen lds
    s_waitcnt lgkmcnt(12)
    v_mfma_f32_32x32x16_bf16 v[112:127], v[160:163], v[32:35], v[112:127]
    v_mfma_f32_16x16x32_bf16 v[180:183], v[176:179], v[160:163], v[180:183]
    ds_read_b64_tr_b16 v[140:141], v199 offset:57344
    ds_read_b64_tr_b16 v[142:143], v199 offset:57856
    s_waitcnt lgkmcnt(12)
    v_mfma_f32_32x32x16_bf16 v[112:127], v[164:167], v[36:39], v[112:127]
    v_add_u32 v196, 0x10000, v196
    ds_read_b64_tr_b16 v[160:161], v196 offset:0
    ds_read_b64_tr_b16 v[162:163], v196 offset:512
    s_waitcnt lgkmcnt(12)
    v_mfma_f32_32x32x16_bf16 v[112:127], v[168:171], v[40:43], v[112:127]
    v_add_u32 v197, 0x10000, v197
    ds_read_b64_tr_b16 v[164:165], v197 offset:0
    ds_read_b64_tr_b16 v[166:167], v197 offset:512
    s_waitcnt lgkmcnt(12)
    v_mfma_f32_32x32x16_bf16 v[112:127], v[172:175], v[44:47], v[112:127]
    v_add_u32 v198, 0x10000, v198
    ds_read_b64_tr_b16 v[168:169], v198 offset:0
    ds_read_b64_tr_b16 v[170:171], v198 offset:512
    s_add_u32 m0, s52, 57344
    s_nop 0
    buffer_load_dwordx4 v200, s[8:11], s81 offen lds
    s_lshl_b32 s95, s50, 9
    s_lshl_b32 s94, s47, 5
    s_add_u32 s95, s95, s94
    s_lshl_b32 s94, s44, 2
    s_add_u32 s95, s95, s94
    s_add_u32 s95, s95, 10637312
    s_waitcnt lgkmcnt(12)
    v_mfma_f32_32x32x16_bf16 v[112:127], v[128:131], v[48:51], v[112:127]
    v_mfma_f32_16x16x32_bf16 v[180:183], v[176:179], v[128:131], v[180:183]
    v_add_u32 v199, 0x10000, v199
    ds_read_b64_tr_b16 v[172:173], v199 offset:0
    ds_read_b64_tr_b16 v[174:175], v199 offset:512
    v_mov_b32 v255, 1
    buffer_store_dword v255, v205, s[40:43], s95 offen sc1
    s_waitcnt lgkmcnt(12)
    v_mfma_f32_32x32x16_bf16 v[112:127], v[132:135], v[52:55], v[112:127]
    ds_read_b64_tr_b16 v[128:129], v196 offset:8192
    ds_read_b64_tr_b16 v[130:131], v196 offset:8704
    s_waitcnt lgkmcnt(12)
    v_mfma_f32_32x32x16_bf16 v[112:127], v[136:139], v[56:59], v[112:127]
    ds_read_b64_tr_b16 v[132:133], v197 offset:8192
    ds_read_b64_tr_b16 v[134:135], v197 offset:8704
    s_waitcnt lgkmcnt(12)
    v_mfma_f32_32x32x16_bf16 v[112:127], v[140:143], v[60:63], v[112:127]
    ds_read_b64_tr_b16 v[136:137], v198 offset:8192
    ds_read_b64_tr_b16 v[138:139], v198 offset:8704
    s_waitcnt lgkmcnt(12)
    v_mfma_f32_32x32x16_bf16 v[112:127], v[160:163], v[64:67], v[112:127]
    v_mfma_f32_16x16x32_bf16 v[180:183], v[176:179], v[160:163], v[180:183]
    ds_read_b64_tr_b16 v[140:141], v199 offset:8192
    ds_read_b64_tr_b16 v[142:143], v199 offset:8704
    s_waitcnt lgkmcnt(12)
    v_mfma_f32_32x32x16_bf16 v[112:127], v[164:167], v[68:71], v[112:127]
    v_add_u32 v196, 0xfffe0000, v196
    ds_read_b64_tr_b16 v[160:161], v196 offset:16384
    ds_read_b64_tr_b16 v[162:163], v196 offset:16896
    s_waitcnt lgkmcnt(12)
    v_mfma_f32_32x32x16_bf16 v[112:127], v[168:171], v[72:75], v[112:127]
    v_add_u32 v197, 0xfffe0000, v197
    ds_read_b64_tr_b16 v[164:165], v197 offset:16384
    ds_read_b64_tr_b16 v[166:167], v197 offset:16896
    s_waitcnt lgkmcnt(12)
    v_mfma_f32_32x32x16_bf16 v[112:127], v[172:175], v[76:79], v[112:127]
    v_add_u32 v198, 0xfffe0000, v198
    ds_read_b64_tr_b16 v[168:169], v198 offset:16384
    ds_read_b64_tr_b16 v[170:171], v198 offset:16896
    s_waitcnt lgkmcnt(12)
    v_mfma_f32_32x32x16_bf16 v[112:127], v[128:131], v[80:83], v[112:127]
    v_mfma_f32_16x16x32_bf16 v[180:183], v[176:179], v[128:131], v[180:183]
    v_add_u32 v199, 0xfffe0000, v199
    ds_read_b64_tr_b16 v[172:173], v199 offset:16384
    ds_read_b64_tr_b16 v[174:175], v199 offset:16896
    s_waitcnt lgkmcnt(12)
    v_mfma_f32_32x32x16_bf16 v[112:127], v[132:135], v[84:87], v[112:127]
    s_waitcnt lgkmcnt(10)
    v_mfma_f32_32x32x16_bf16 v[112:127], v[136:139], v[88:91], v[112:127]
    s_waitcnt lgkmcnt(8)
    v_mfma_f32_32x32x16_bf16 v[112:127], v[140:143], v[92:95], v[112:127]
    s_waitcnt lgkmcnt(6)
    v_mfma_f32_32x32x16_bf16 v[112:127], v[160:163], v[96:99], v[112:127]
    v_mfma_f32_16x16x32_bf16 v[180:183], v[176:179], v[160:163], v[180:183]
    s_waitcnt lgkmcnt(4)
    v_mfma_f32_32x32x16_bf16 v[112:127], v[164:167], v[100:103], v[112:127]
    s_waitcnt lgkmcnt(2)
    v_mfma_f32_32x32x16_bf16 v[112:127], v[168:171], v[104:107], v[112:127]
    s_nop 3
    ds_write_b32 v206, v180 offset:0
    s_waitcnt lgkmcnt(1)
    v_mfma_f32_32x32x16_bf16 v[112:127], v[172:175], v[108:111], v[112:127]
    s_waitcnt lgkmcnt(0)
    s_barrier
    s_setprio 3
    ds_read_b128 v[236:239], v201 offset:6144
    ds_read_b128 v[240:243], v201 offset:7168
    ds_read_b64 v[228:229], v207 offset:0
    s_waitcnt lgkmcnt(0)
    v_add_f32 v228, v228, v229
    s_add_u32 m0, s52, 65536
    s_nop 0
    buffer_load_dwordx4 v200, s[8:11], s82 offen lds
    v_mfma_f32_32x32x2_f32 v[112:127], v228, v208, v[112:127]
    s_nop 15
    s_nop 3
    v_cvt_pk_bf16_f32 v112, v112, v113
    v_cvt_pk_bf16_f32 v113, v114, v115
    v_cvt_pk_bf16_f32 v114, v116, v117
    v_cvt_pk_bf16_f32 v115, v118, v119
    s_add_u32 m0, s52, 73728
    s_nop 0
    buffer_load_dwordx4 v200, s[8:11], s83 offen lds
    v_cvt_pk_bf16_f32 v116, v120, v121
    v_cvt_pk_bf16_f32 v117, v122, v123
    v_cvt_pk_bf16_f32 v118, v124, v125
    v_cvt_pk_bf16_f32 v119, v126, v127
    v_mfma_f32_32x32x16_bf16 v[220:235], v[236:239], v[112:115], 0
    s_nop 0
    v_mfma_f32_32x32x16_bf16 v[220:235], v[240:243], v[116:119], v[220:235]
    s_setprio 0
    s_add_u32 m0, s52, 24576
    s_nop 0
    buffer_load_dwordx4 v200, s[8:11], s84 offen lds
    s_nop 7
    v_max3_f32 v244, v220, v221, v222
    v_min3_f32 v245, v220, v221, v222
    v_max3_f32 v244, v244, v223, v224
    v_min3_f32 v245, v245, v223, v224
    v_max3_f32 v244, v244, v225, v226
    v_min3_f32 v245, v245, v225, v226
    v_max3_f32 v244, v244, v227, v228
    v_min3_f32 v245, v245, v227, v228
    v_max3_f32 v244, v244, v229, v230
    v_min3_f32 v245, v245, v229, v230
    v_max3_f32 v244, v244, v231, v232
    v_min3_f32 v245, v245, v231, v232
    v_max_f32 v244, v244, v233
    v_min_f32 v245, v245, v233
    v_mul_f32 v245, -1.0, v245
    s_nop 1
    v_permlane32_swap_b32 v244, v245
    v_max_f32 v244, v244, v245
    v_mov_b32 v245, v244
    s_nop 1
    v_permlane32_swap_b32 v244, v245
    v_mul_f32 v244, v244, v211
    v_mul_f32 v245, v245, v211
    v_fma_f32 v112, -v220, v211, -v245
    v_fma_f32 v113, -v221, v211, -v245
    v_fma_f32 v220, v220, v211, -v244
    v_fma_f32 v221, v221, v211, -v244
    v_fma_f32 v114, -v222, v211, -v245
    v_fma_f32 v115, -v223, v211, -v245
    v_fma_f32 v222, v222, v211, -v244
    v_fma_f32 v223, v223, v211, -v244
    v_fma_f32 v116, -v224, v211, -v245
    v_fma_f32 v117, -v225, v211, -v245
    v_fma_f32 v224, v224, v211, -v244
    v_fma_f32 v225, v225, v211, -v244
    v_fma_f32 v118, -v226, v211, -v245
    v_fma_f32 v119, -v227, v211, -v245
    v_fma_f32 v226, v226, v211, -v244
    v_fma_f32 v227, v227, v211, -v244
    v_fma_f32 v120, -v228, v211, -v245
    v_fma_f32 v121, -v229, v211, -v245
    v_fma_f32 v228, v228, v211, -v244
    v_fma_f32 v229, v229, v211, -v244
    v_fma_f32 v122, -v230, v211, -v245
    v_fma_f32 v123, -v231, v211, -v245
    v_fma_f32 v230, v230, v211, -v244
    v_fma_f32 v231, v231, v211, -v244
    v_fma_f32 v124, -v232, v211, -v245
    v_fma_f32 v125, -v233, v211, -v245
    v_fma_f32 v232, v232, v211, -v244
    v_fma_f32 v233, v233, v211, -v244
    v_exp_f32 v112, v112
    v_exp_f32 v220, v220
    v_exp_f32 v113, v113
    v_exp_f32 v221, v221
    v_exp_f32 v114, v114
    v_exp_f32 v222, v222
    v_exp_f32 v115, v115
    v_exp_f32 v223, v223
    v_exp_f32 v116, v116
    v_exp_f32 v224, v224
    v_exp_f32 v117, v117
    v_exp_f32 v225, v225
    v_exp_f32 v118, v118
    v_exp_f32 v226, v226
    v_exp_f32 v119, v119
    v_exp_f32 v227, v227
    v_exp_f32 v120, v120
    v_exp_f32 v228, v228
    v_exp_f32 v121, v121
    v_exp_f32 v229, v229
    v_exp_f32 v122, v122
    v_exp_f32 v230, v230
    v_exp_f32 v123, v123
    v_exp_f32 v231, v231
    v_exp_f32 v124, v124
    v_exp_f32 v232, v232
    v_exp_f32 v125, v125
    v_exp_f32 v233, v233
    v_cvt_pk_bf16_f32 v188, v220, v221
    v_cvt_pk_bf16_f32 v212, v112, v113
    v_cvt_pk_bf16_f32 v189, v222, v223
    v_cvt_pk_bf16_f32 v213, v114, v115
    v_cvt_pk_bf16_f32 v190, v224, v225
    v_cvt_pk_bf16_f32 v214, v116, v117
    v_cvt_pk_bf16_f32 v191, v226, v227
    v_cvt_pk_bf16_f32 v215, v118, v119
    v_cvt_pk_bf16_f32 v192, v228, v229
    v_cvt_pk_bf16_f32 v216, v120, v121
    v_cvt_pk_bf16_f32 v193, v230, v231
    v_cvt_pk_bf16_f32 v217, v122, v123
    v_cvt_pk_bf16_f32 v194, v232, v233
    v_cvt_pk_bf16_f32 v218, v124, v125
    v_mov_b32 v195, 0
    v_mov_b32 v219, 0
    s_setprio 2
    s_waitcnt vmcnt(0)
    s_barrier
    ds_read_b64_tr_b16 v[160:161], v196 offset:32768
    ds_read_b64_tr_b16 v[162:163], v196 offset:33280
    ds_read_b64_tr_b16 v[164:165], v197 offset:32768
    ds_read_b64_tr_b16 v[166:167], v197 offset:33280
    ds_read_b64_tr_b16 v[168:169], v198 offset:32768
    ds_read_b64_tr_b16 v[170:171], v198 offset:33280
    ds_read_b64_tr_b16 v[172:173], v199 offset:32768
    ds_read_b64_tr_b16 v[174:175], v199 offset:33280
    ds_read_b64_tr_b16 v[128:129], v196 offset:40960
    ds_read_b64_tr_b16 v[130:131], v196 offset:41472
    ds_read_b64_tr_b16 v[132:133], v197 offset:40960
    ds_read_b64_tr_b16 v[134:135], v197 offset:41472
    ds_read_b64_tr_b16 v[136:137], v198 offset:40960
    ds_read_b64_tr_b16 v[138:139], v198 offset:41472
    s_waitcnt lgkmcnt(12)
    v_mfma_f32_32x32x16_bf16 v[112:127], v[160:163], v[0:3], 0
    v_mfma_f32_16x16x32_bf16 v[180:183], v[176:179], v[160:163], 0
    ds_read_b64_tr_b16 v[140:141], v199 offset:40960
    ds_read_b64_tr_b16 v[142:143], v199 offset:41472
    v_add_u32 v200, 112, v200
    s_add_u32 m0, s52, 98304
    s_nop 0
    buffer_load_dwordx4 v200, s[8:11], s78 offen lds
    s_waitcnt lgkmcnt(12)
    v_mfma_f32_32x32x16_bf16 v[112:127], v[164:167], v[4:7], v[112:127]
    ds_read_b64_tr_b16 v[160:161], v196 offset:49152
    ds_read_b64_tr_b16 v[162:163], v196 offset:49664
    s_waitcnt lgkmcnt(12)
    v_mfma_f32_32x32x16_bf16 v[112:127], v[168:171], v[8:11], v[112:127]
    ds_read_b64_tr_b16 v[164:165], v197 offset:49152
    ds_read_b64_tr_b16 v[166:167], v197 offset:49664
    s_waitcnt lgkmcnt(12)
    v_mfma_f32_32x32x16_bf16 v[112:127], v[172:175], v[12:15], v[112:127]
    ds_read_b64_tr_b16 v[168:169], v198 offset:49152
    ds_read_b64_tr_b16 v[170:171], v198 offset:49664
    s_waitcnt lgkmcnt(12)
    v_mfma_f32_32x32x16_bf16 v[112:127], v[128:131], v[16:19], v[112:127]
    v_mfma_f32_16x16x32_bf16 v[180:183], v[176:179], v[128:131], v[180:183]
    ds_read_b64_tr_b16 v[172:173], v199 offset:49152
    ds_read_b64_tr_b16 v[174:175], v199 offset:49664
    s_add_u32 m0, s52, 106496
    s_nop 0
    buffer_load_dwordx4 v200, s[8:11], s79 offen lds
    s_waitcnt lgkmcnt(12)
    v_mfma_f32_32x32x16_bf16 v[112:127], v[132:135], v[20:23], v[112:127]
    ds_read_b64_tr_b16 v[128:129], v196 offset:57344
    ds_read_b64_tr_b16 v[130:131], v196 offset:57856
    s_waitcnt lgkmcnt(12)
    v_mfma_f32_32x32x16_bf16 v[112:127], v[136:139], v[24:27], v[112:127]
    ds_read_b64_tr_b16 v[132:133], v197 offset:57344
    ds_read_b64_tr_b16 v[134:135], v197 offset:57856
    s_waitcnt lgkmcnt(12)
    v_mfma_f32_32x32x16_bf16 v[112:127], v[140:143], v[28:31], v[112:127]
    ds_read_b64_tr_b16 v[136:137], v198 offset:57344
    ds_read_b64_tr_b16 v[138:139], v198 offset:57856
    s_add_u32 m0, s52, 114688
    s_nop 0
    buffer_load_dwordx4 v200, s[8:11], s80 offen lds
    s_waitcnt lgkmcnt(12)
    v_mfma_f32_32x32x16_bf16 v[112:127], v[160:163], v[32:35], v[112:127]
    v_mfma_f32_16x16x32_bf16 v[180:183], v[176:179], v[160:163], v[180:183]
    ds_read_b64_tr_b16 v[140:141], v199 offset:57344
    ds_read_b64_tr_b16 v[142:143], v199 offset:57856
    s_waitcnt lgkmcnt(12)
    v_mfma_f32_32x32x16_bf16 v[112:127], v[164:167], v[36:39], v[112:127]
    v_add_u32 v196, 0x10000, v196
    ds_read_b64_tr_b16 v[160:161], v196 offset:0
    ds_read_b64_tr_b16 v[162:163], v196 offset:512
    s_waitcnt lgkmcnt(12)
    v_mfma_f32_32x32x16_bf16 v[112:127], v[168:171], v[40:43], v[112:127]
    v_add_u32 v197, 0x10000, v197
    ds_read_b64_tr_b16 v[164:165], v197 offset:0
    ds_read_b64_tr_b16 v[166:167], v197 offset:512
    s_waitcnt lgkmcnt(12)
    v_mfma_f32_32x32x16_bf16 v[112:127], v[172:175], v[44:47], v[112:127]
    v_add_u32 v198, 0x10000, v198
    ds_read_b64_tr_b16 v[168:169], v198 offset:0
    ds_read_b64_tr_b16 v[170:171], v198 offset:512
    s_add_u32 m0, s52, 122880
    s_nop 0
    buffer_load_dwordx4 v200, s[8:11], s81 offen lds
    s_waitcnt lgkmcnt(12)
    v_mfma_f32_32x32x16_bf16 v[112:127], v[128:131], v[48:51], v[112:127]
    v_mfma_f32_16x16x32_bf16 v[180:183], v[176:179], v[128:131], v[180:183]
    v_add_u32 v199, 0x10000, v199
    ds_read_b64_tr_b16 v[172:173], v199 offset:0
    ds_read_b64_tr_b16 v[174:175], v199 offset:512
    s_waitcnt lgkmcnt(12)
    v_mfma_f32_32x32x16_bf16 v[112:127], v[132:135], v[52:55], v[112:127]
    ds_read_b64_tr_b16 v[128:129], v196 offset:8192
    ds_read_b64_tr_b16 v[130:131], v196 offset:8704
    s_waitcnt lgkmcnt(12)
    v_mfma_f32_32x32x16_bf16 v[112:127], v[136:139], v[56:59], v[112:127]
    ds_read_b64_tr_b16 v[132:133], v197 offset:8192
    ds_read_b64_tr_b16 v[134:135], v197 offset:8704
    s_waitcnt lgkmcnt(12)
    v_mfma_f32_32x32x16_bf16 v[112:127], v[140:143], v[60:63], v[112:127]
    ds_read_b64_tr_b16 v[136:137], v198 offset:8192
    ds_read_b64_tr_b16 v[138:139], v198 offset:8704
    s_waitcnt lgkmcnt(12)
    v_mfma_f32_32x32x16_bf16 v[112:127], v[160:163], v[64:67], v[112:127]
    v_mfma_f32_16x16x32_bf16 v[180:183], v[176:179], v[160:163], v[180:183]
    ds_read_b64_tr_b16 v[140:141], v199 offset:8192
    ds_read_b64_tr_b16 v[142:143], v199 offset:8704
    s_waitcnt lgkmcnt(12)
    v_mfma_f32_32x32x16_bf16 v[112:127], v[164:167], v[68:71], v[112:127]
    v_add_u32 v196, 0xffff0000, v196
    ds_read_b64_tr_b16 v[160:161], v196 offset:24576
    ds_read_b64_tr_b16 v[162:163], v196 offset:25088
    s_waitcnt lgkmcnt(12)
    v_mfma_f32_32x32x16_bf16 v[112:127], v[168:171], v[72:75], v[112:127]
    v_add_u32 v197, 0xffff0000, v197
    ds_read_b64_tr_b16 v[164:165], v197 offset:24576
    ds_read_b64_tr_b16 v[166:167], v197 offset:25088
    s_waitcnt lgkmcnt(12)
    v_mfma_f32_32x32x16_bf16 v[112:127], v[172:175], v[76:79], v[112:127]
    v_add_u32 v198, 0xffff0000, v198
    ds_read_b64_tr_b16 v[168:169], v198 offset:24576
    ds_read_b64_tr_b16 v[170:171], v198 offset:25088
    s_waitcnt lgkmcnt(12)
    v_mfma_f32_32x32x16_bf16 v[112:127], v[128:131], v[80:83], v[112:127]
    v_mfma_f32_16x16x32_bf16 v[180:183], v[176:179], v[128:131], v[180:183]
    v_add_u32 v199, 0xffff0000, v199
    ds_read_b64_tr_b16 v[172:173], v199 offset:24576
    ds_read_b64_tr_b16 v[174:175], v199 offset:25088
    s_waitcnt lgkmcnt(12)
    v_mfma_f32_32x32x16_bf16 v[112:127], v[132:135], v[84:87], v[112:127]
    s_waitcnt lgkmcnt(10)
    v_mfma_f32_32x32x16_bf16 v[112:127], v[136:139], v[88:91], v[112:127]
    s_waitcnt lgkmcnt(8)
    v_mfma_f32_32x32x16_bf16 v[112:127], v[140:143], v[92:95], v[112:127]
    s_waitcnt lgkmcnt(6)
    v_mfma_f32_32x32x16_bf16 v[112:127], v[160:163], v[96:99], v[112:127]
    v_mfma_f32_16x16x32_bf16 v[180:183], v[176:179], v[160:163], v[180:183]
    s_waitcnt lgkmcnt(4)
    v_mfma_f32_32x32x16_bf16 v[112:127], v[164:167], v[100:103], v[112:127]
    s_waitcnt lgkmcnt(2)
    v_mfma_f32_32x32x16_bf16 v[112:127], v[168:171], v[104:107], v[112:127]
    s_nop 3
    ds_write_b32 v206, v180 offset:2048
    s_waitcnt lgkmcnt(1)
    v_mfma_f32_32x32x16_bf16 v[112:127], v[172:175], v[108:111], v[112:127]
    s_waitcnt lgkmcnt(0)
    s_barrier
    s_setprio 3
    ds_read_b128 v[236:239], v201 offset:10240
    ds_read_b128 v[240:243], v201 offset:11264
    ds_read_b64 v[228:229], v207 offset:2048
    s_waitcnt lgkmcnt(0)
    v_add_f32 v228, v228, v229
    s_add_u32 m0, s52, 131072
    s_nop 0
    buffer_load_dwordx4 v200, s[8:11], s82 offen lds
    v_mfma_f32_32x32x2_f32 v[112:127], v228, v208, v[112:127]
    s_nop 15
    s_nop 3
    v_cvt_pk_bf16_f32 v112, v112, v113
    v_cvt_pk_bf16_f32 v113, v114, v115
    v_cvt_pk_bf16_f32 v114, v116, v117
    v_cvt_pk_bf16_f32 v115, v118, v119
    s_add_u32 m0, s52, 139264
    s_nop 0
    buffer_load_dwordx4 v200, s[8:11], s83 offen lds
    v_cvt_pk_bf16_f32 v116, v120, v121
    v_cvt_pk_bf16_f32 v117, v122, v123
    v_cvt_pk_bf16_f32 v118, v124, v125
    v_cvt_pk_bf16_f32 v119, v126, v127
    v_mfma_f32_32x32x16_bf16 v[220:235], v[236:239], v[112:115], 0
    s_nop 0
    v_mfma_f32_32x32x16_bf16 v[220:235], v[240:243], v[116:119], v[220:235]
    s_setprio 0
    s_add_u32 m0, s52, 16384
    s_nop 0
    buffer_load_dwordx4 v200, s[8:11], s84 offen lds
    s_nop 7
    v_max3_f32 v244, v220, v221, v222
    v_min3_f32 v245, v220, v221, v222
    v_max3_f32 v244, v244, v223, v224
    v_min3_f32 v245, v245, v223, v224
    v_max3_f32 v244, v244, v225, v226
    v_min3_f32 v245, v245, v225, v226
    v_max3_f32 v244, v244, v227, v228
    v_min3_f32 v245, v245, v227, v228
    v_max3_f32 v244, v244, v229, v230
    v_min3_f32 v245, v245, v229, v230
    v_max3_f32 v244, v244, v231, v232
    v_min3_f32 v245, v245, v231, v232
    v_max_f32 v244, v244, v233
    v_min_f32 v245, v245, v233
    v_mul_f32 v245, -1.0, v245
    s_nop 1
    v_permlane32_swap_b32 v244, v245
    v_max_f32 v244, v244, v245
    v_mov_b32 v245, v244
    s_nop 1
    v_permlane32_swap_b32 v244, v245
    v_mul_f32 v244, v244, v211
    v_mul_f32 v245, v245, v211
    v_fma_f32 v112, -v220, v211, -v245
    v_fma_f32 v113, -v221, v211, -v245
    v_fma_f32 v220, v220, v211, -v244
    v_fma_f32 v221, v221, v211, -v244
    v_fma_f32 v114, -v222, v211, -v245
    v_fma_f32 v115, -v223, v211, -v245
    v_fma_f32 v222, v222, v211, -v244
    v_fma_f32 v223, v223, v211, -v244
    v_fma_f32 v116, -v224, v211, -v245
    v_fma_f32 v117, -v225, v211, -v245
    v_fma_f32 v224, v224, v211, -v244
    v_fma_f32 v225, v225, v211, -v244
    v_fma_f32 v118, -v226, v211, -v245
    v_fma_f32 v119, -v227, v211, -v245
    v_fma_f32 v226, v226, v211, -v244
    v_fma_f32 v227, v227, v211, -v244
    v_fma_f32 v120, -v228, v211, -v245
    v_fma_f32 v121, -v229, v211, -v245
    v_fma_f32 v228, v228, v211, -v244
    v_fma_f32 v229, v229, v211, -v244
    v_fma_f32 v122, -v230, v211, -v245
    s_lshl_b32 s97, s48, 2
    s_add_u32 s97, s97, s45
    s_lshl_b32 s96, s97, 14
    s_lshl_b32 s97, s97, 10
    s_add_u32 s97, s97, 0xa25000
    s_add_u32 s96, s96, 0xa00000
    buffer_load_dwordx4 v[240:243], v204, s[40:43], s97 offen sc1
    v_fma_f32 v123, -v231, v211, -v245
    v_fma_f32 v230, v230, v211, -v244
    v_fma_f32 v231, v231, v211, -v244
    v_fma_f32 v124, -v232, v211, -v245
    v_fma_f32 v125, -v233, v211, -v245
    v_fma_f32 v232, v232, v211, -v244
    v_fma_f32 v233, v233, v211, -v244
    v_exp_f32 v112, v112
    v_exp_f32 v220, v220
    v_exp_f32 v113, v113
    v_exp_f32 v221, v221
    v_exp_f32 v114, v114
    v_exp_f32 v222, v222
    v_exp_f32 v115, v115
    v_exp_f32 v223, v223
    v_exp_f32 v116, v116
    v_exp_f32 v224, v224
    v_exp_f32 v117, v117
    v_exp_f32 v225, v225
    v_exp_f32 v118, v118
    v_exp_f32 v226, v226
    v_exp_f32 v119, v119
    v_exp_f32 v227, v227
    v_exp_f32 v120, v120
    v_exp_f32 v228, v228
    v_exp_f32 v121, v121
    v_exp_f32 v229, v229
    v_exp_f32 v122, v122
    v_exp_f32 v230, v230
    v_exp_f32 v123, v123
    v_exp_f32 v231, v231
    v_exp_f32 v124, v124
    v_exp_f32 v232, v232
    v_exp_f32 v125, v125
    v_exp_f32 v233, v233
    v_cvt_pk_bf16_f32 v128, v220, v221
    v_cvt_pk_bf16_f32 v136, v112, v113
    v_cvt_pk_bf16_f32 v129, v222, v223
    v_cvt_pk_bf16_f32 v137, v114, v115
    v_cvt_pk_bf16_f32 v130, v224, v225
    v_cvt_pk_bf16_f32 v138, v116, v117
    v_cvt_pk_bf16_f32 v131, v226, v227
    v_cvt_pk_bf16_f32 v139, v118, v119
    v_cvt_pk_bf16_f32 v132, v228, v229
    v_cvt_pk_bf16_f32 v140, v120, v121
    v_cvt_pk_bf16_f32 v133, v230, v231
    v_cvt_pk_bf16_f32 v141, v122, v123
    v_cvt_pk_bf16_f32 v134, v232, v233
    v_cvt_pk_bf16_f32 v142, v124, v125
    v_mov_b32 v135, 0
    v_mov_b32 v143, 0
    s_setprio 2
    s_waitcnt vmcnt(1)
    s_barrier
    v_add_u32 v196, 0x10000, v196
    ds_read_b64_tr_b16 v[160:161], v196 offset:32768
    ds_read_b64_tr_b16 v[162:163], v196 offset:33280
    v_add_u32 v197, 0x10000, v197
    ds_read_b64_tr_b16 v[164:165], v197 offset:32768
    ds_read_b64_tr_b16 v[166:167], v197 offset:33280
    v_add_u32 v198, 0x10000, v198
    ds_read_b64_tr_b16 v[168:169], v198 offset:32768
    ds_read_b64_tr_b16 v[170:171], v198 offset:33280
    v_add_u32 v199, 0x10000, v199
    ds_read_b64_tr_b16 v[172:173], v199 offset:32768
    ds_read_b64_tr_b16 v[174:175], v199 offset:33280
    ds_read_b64_tr_b16 v[220:221], v196 offset:40960
    ds_read_b64_tr_b16 v[222:223], v196 offset:41472
    ds_read_b64_tr_b16 v[224:225], v197 offset:40960
    ds_read_b64_tr_b16 v[226:227], v197 offset:41472
    ds_read_b64_tr_b16 v[228:229], v198 offset:40960
    ds_read_b64_tr_b16 v[230:231], v198 offset:41472
    s_waitcnt lgkmcnt(12)
    v_mfma_f32_32x32x16_bf16 v[112:127], v[160:163], v[0:3], 0
    v_mfma_f32_16x16x32_bf16 v[180:183], v[176:179], v[160:163], 0
    ds_read_b64_tr_b16 v[232:233], v199 offset:40960
    ds_read_b64_tr_b16 v[234:235], v199 offset:41472
    s_waitcnt lgkmcnt(12)
    v_mfma_f32_32x32x16_bf16 v[112:127], v[164:167], v[4:7], v[112:127]
    ds_read_b64_tr_b16 v[160:161], v196 offset:49152
    ds_read_b64_tr_b16 v[162:163], v196 offset:49664
    s_waitcnt lgkmcnt(12)
    v_mfma_f32_32x32x16_bf16 v[112:127], v[168:171], v[8:11], v[112:127]
    ds_read_b64_tr_b16 v[164:165], v197 offset:49152
    ds_read_b64_tr_b16 v[166:167], v197 offset:49664
    s_waitcnt lgkmcnt(12)
    v_mfma_f32_32x32x16_bf16 v[112:127], v[172:175], v[12:15], v[112:127]
    ds_read_b64_tr_b16 v[168:169], v198 offset:49152
    ds_read_b64_tr_b16 v[170:171], v198 offset:49664
    s_waitcnt vmcnt(0)
    v_min3_u32 v240, v240, v241, v242
    v_min_u32 v240, v240, v243
    v_cmp_ne_u32 vcc, 0, v240
    s_cmp_eq_u64 vcc, -1
    s_cbranch_scc1 .ok13
    s_mov_b32 s98, 20000
.sp14:
    buffer_load_dwordx4 v[240:243], v204, s[40:43], s97 offen sc1
    s_waitcnt vmcnt(0)
    v_min3_u32 v240, v240, v241, v242
    v_min_u32 v240, v240, v243
    v_cmp_ne_u32 vcc, 0, v240
    s_cmp_eq_u64 vcc, -1
    s_cbranch_scc1 .ok13
    s_sub_u32 s98, s98, 1
    s_cmp_lg_u32 s98, 0
    s_cbranch_scc1 .sp14
.ok13:
    s_nop 1
    s_waitcnt lgkmcnt(12)
    v_mfma_f32_32x32x16_bf16 v[112:127], v[220:223], v[16:19], v[112:127]
    v_mfma_f32_16x16x32_bf16 v[180:183], v[176:179], v[220:223], v[180:183]
    ds_read_b64_tr_b16 v[172:173], v199 offset:49152
    ds_read_b64_tr_b16 v[174:175], v199 offset:49664
    buffer_load_dwordx4 v[16:19], v204, s[40:43], s96 offen offset:0 sc1
    s_waitcnt lgkmcnt(12)
    v_mfma_f32_32x32x16_bf16 v[112:127], v[224:227], v[20:23], v[112:127]
    ds_read_b64_tr_b16 v[220:221], v196 offset:57344
    ds_read_b64_tr_b16 v[222:223], v196 offset:57856
    buffer_load_dwordx4 v[20:23], v204, s[40:43], s96 offen offset:1024 sc1
    s_waitcnt lgkmcnt(12)
    v_mfma_f32_32x32x16_bf16 v[112:127], v[228:231], v[24:27], v[112:127]
    ds_read_b64_tr_b16 v[224:225], v197 offset:57344
    ds_read_b64_tr_b16 v[226:227], v197 offset:57856
    buffer_load_dwordx4 v[24:27], v204, s[40:43], s96 offen offset:2048 sc1
    s_waitcnt lgkmcnt(12)
    v_mfma_f32_32x32x16_bf16 v[112:127], v[232:235], v[28:31], v[112:127]
    ds_read_b64_tr_b16 v[228:229], v198 offset:57344
    ds_read_b64_tr_b16 v[230:231], v198 offset:57856
    buffer_load_dwordx4 v[28:31], v204, s[40:43], s96 offen offset:3072 sc1
    s_waitcnt lgkmcnt(12)
    v_mfma_f32_32x32x16_bf16 v[112:127], v[160:163], v[32:35], v[112:127]
    v_mfma_f32_16x16x32_bf16 v[180:183], v[176:179], v[160:163], v[180:183]
    ds_read_b64_tr_b16 v[232:233], v199 offset:57344
    ds_read_b64_tr_b16 v[234:235], v199 offset:57856
    s_add_u32 s96, s96, 4096
    buffer_load_dwordx4 v[32:35], v204, s[40:43], s96 offen offset:0 sc1
    s_waitcnt lgkmcnt(12)
    v_mfma_f32_32x32x16_bf16 v[112:127], v[164:167], v[36:39], v[112:127]
    v_add_u32 v196, 0x10000, v196
    ds_read_b64_tr_b16 v[160:161], v196 offset:0
    ds_read_b64_tr_b16 v[162:163], v196 offset:512
    buffer_load_dwordx4 v[36:39], v204, s[40:43], s96 offen offset:1024 sc1
    s_waitcnt lgkmcnt(12)
    v_mfma_f32_32x32x16_bf16 v[112:127], v[168:171], v[40:43], v[112:127]
    v_add_u32 v197, 0x10000, v197
    ds_read_b64_tr_b16 v[164:165], v197 offset:0
    ds_read_b64_tr_b16 v[166:167], v197 offset:512
    buffer_load_dwordx4 v[40:43], v204, s[40:43], s96 offen offset:2048 sc1
    s_waitcnt lgkmcnt(12)
    v_mfma_f32_32x32x16_bf16 v[112:127], v[172:175], v[44:47], v[112:127]
    v_add_u32 v198, 0x10000, v198
    ds_read_b64_tr_b16 v[168:169], v198 offset:0
    ds_read_b64_tr_b16 v[170:171], v198 offset:512
    buffer_load_dwordx4 v[44:47], v204, s[40:43], s96 offen offset:3072 sc1
    s_waitcnt lgkmcnt(12)
    v_mfma_f32_32x32x16_bf16 v[112:127], v[220:223], v[48:51], v[112:127]
    v_mfma_f32_16x16x32_bf16 v[180:183], v[176:179], v[220:223], v[180:183]
    v_add_u32 v199, 0x10000, v199
    ds_read_b64_tr_b16 v[172:173], v199 offset:0
    ds_read_b64_tr_b16 v[174:175], v199 offset:512
    s_add_u32 s96, s96, 4096
    buffer_load_dwordx4 v[48:51], v204, s[40:43], s96 offen offset:0 sc1
    s_waitcnt lgkmcnt(12)
    v_mfma_f32_32x32x16_bf16 v[112:127], v[224:227], v[52:55], v[112:127]
    ds_read_b64_tr_b16 v[220:221], v196 offset:8192
    ds_read_b64_tr_b16 v[222:223], v196 offset:8704
    buffer_load_dwordx4 v[52:55], v204, s[40:43], s96 offen offset:1024 sc1
    s_waitcnt lgkmcnt(12)
    v_mfma_f32_32x32x16_bf16 v[112:127], v[228:231], v[56:59], v[112:127]
    ds_read_b64_tr_b16 v[224:225], v197 offset:8192
    ds_read_b64_tr_b16 v[226:227], v197 offset:8704
    buffer_load_dwordx4 v[56:59], v204, s[40:43], s96 offen offset:2048 sc1
    s_waitcnt lgkmcnt(12)
    v_mfma_f32_32x32x16_bf16 v[112:127], v[232:235], v[60:63], v[112:127]
    ds_read_b64_tr_b16 v[228:229], v198 offset:8192
    ds_read_b64_tr_b16 v[230:231], v198 offset:8704
    buffer_load_dwordx4 v[60:63], v204, s[40:43], s96 offen offset:3072 sc1
    s_waitcnt lgkmcnt(12)
    v_mfma_f32_32x32x16_bf16 v[112:127], v[160:163], v[64:67], v[112:127]
    v_mfma_f32_16x16x32_bf16 v[180:183], v[176:179], v[160:163], v[180:183]
    ds_read_b64_tr_b16 v[232:233], v199 offset:8192
    ds_read_b64_tr_b16 v[234:235], v199 offset:8704
    s_add_u32 s96, s96, 4096
    buffer_load_dwordx4 v[64:67], v204, s[40:43], s96 offen offset:0 sc1
    s_waitcnt lgkmcnt(12)
    v_mfma_f32_32x32x16_bf16 v[112:127], v[164:167], v[68:71], v[112:127]
    v_add_u32 v196, 0xfffe0000, v196
    ds_read_b64_tr_b16 v[160:161], v196 offset:16384
    ds_read_b64_tr_b16 v[162:163], v196 offset:16896
    buffer_load_dwordx4 v[68:71], v204, s[40:43], s96 offen offset:1024 sc1
    s_waitcnt lgkmcnt(12)
    v_mfma_f32_32x32x16_bf16 v[112:127], v[168:171], v[72:75], v[112:127]
    v_add_u32 v197, 0xfffe0000, v197
    ds_read_b64_tr_b16 v[164:165], v197 offset:16384
    ds_read_b64_tr_b16 v[166:167], v197 offset:16896
    buffer_load_dwordx4 v[72:75], v204, s[40:43], s96 offen offset:2048 sc1
    s_waitcnt lgkmcnt(12)
    v_mfma_f32_32x32x16_bf16 v[112:127], v[172:175], v[76:79], v[112:127]
    v_add_u32 v198, 0xfffe0000, v198
    ds_read_b64_tr_b16 v[168:169], v198 offset:16384
    ds_read_b64_tr_b16 v[170:171], v198 offset:16896
    buffer_load_dwordx4 v[76:79], v204, s[40:43], s96 offen offset:3072 sc1
    s_waitcnt lgkmcnt(12)
    v_mfma_f32_32x32x16_bf16 v[112:127], v[220:223], v[80:83], v[112:127]
    v_mfma_f32_16x16x32_bf16 v[180:183], v[176:179], v[220:223], v[180:183]
    v_add_u32 v199, 0xfffe0000, v199
    ds_read_b64_tr_b16 v[172:173], v199 offset:16384
    ds_read_b64_tr_b16 v[174:175], v199 offset:16896
    s_waitcnt lgkmcnt(12)
    v_mfma_f32_32x32x16_bf16 v[112:127], v[224:227], v[84:87], v[112:127]
    s_waitcnt lgkmcnt(10)
    v_mfma_f32_32x32x16_bf16 v[112:127], v[228:231], v[88:91], v[112:127]
    s_waitcnt lgkmcnt(8)
    v_mfma_f32_32x32x16_bf16 v[112:127], v[232:235], v[92:95], v[112:127]
    s_waitcnt lgkmcnt(6)
    v_mfma_f32_32x32x16_bf16 v[112:127], v[160:163], v[96:99], v[112:127]
    v_mfma_f32_16x16x32_bf16 v[180:183], v[176:179], v[160:163], v[180:183]
    s_waitcnt lgkmcnt(4)
    v_mfma_f32_32x32x16_bf16 v[112:127], v[164:167], v[100:103], v[112:127]
    s_waitcnt lgkmcnt(2)
    v_mfma_f32_32x32x16_bf16 v[112:127], v[168:171], v[104:107], v[112:127]
    s_nop 3
    ds_write_b32 v206, v180 offset:0
    s_waitcnt lgkmcnt(1)
    v_mfma_f32_32x32x16_bf16 v[112:127], v[172:175], v[108:111], v[112:127]
    v_lshrrev_b32 v184, 9, v204
    v_bfe_u32 v185, v204, 6, 2
    v_lshl_add_u32 v184, v184, 3, v185
    v_lshlrev_b32 v184, 6, v184
    v_bfe_u32 v185, v204, 8, 1
    v_lshl_add_u32 v184, v185, 5, v184
    v_bfe_u32 v185, v204, 4, 2
    v_lshl_add_u32 v184, v185, 3, v184
    s_waitcnt lgkmcnt(0)
    s_barrier
    s_setprio 3
    ds_read_b128 v[236:239], v201 offset:14336
    ds_read_b128 v[240:243], v201 offset:15360
    ds_read_b64 v[228:229], v207 offset:0
    s_waitcnt lgkmcnt(0)
    v_add_f32 v228, v228, v229
    s_nop 1
    v_mfma_f32_32x32x2_f32 v[112:127], v228, v208, v[112:127]
    s_nop 15
    s_nop 3
    v_cvt_pk_bf16_f32 v112, v112, v113
    v_cvt_pk_bf16_f32 v113, v114, v115
    v_cvt_pk_bf16_f32 v114, v116, v117
    v_cvt_pk_bf16_f32 v115, v118, v119
    v_cvt_pk_bf16_f32 v116, v120, v121
    v_cvt_pk_bf16_f32 v117, v122, v123
    v_cvt_pk_bf16_f32 v118, v124, v125
    v_cvt_pk_bf16_f32 v119, v126, v127
    v_mfma_f32_32x32x16_bf16 v[220:235], v[236:239], v[112:115], 0
    s_nop 0
    v_mfma_f32_32x32x16_bf16 v[220:235], v[240:243], v[116:119], v[220:235]
    s_setprio 0
    s_nop 10
    v_max3_f32 v244, v220, v221, v222
    v_min3_f32 v245, v220, v221, v222
    v_max3_f32 v244, v244, v223, v224
    v_min3_f32 v245, v245, v223, v224
    v_max3_f32 v244, v244, v225, v226
    v_min3_f32 v245, v245, v225, v226
    v_max3_f32 v244, v244, v227, v228
    v_min3_f32 v245, v245, v227, v228
    v_max3_f32 v244, v244, v229, v230
    v_min3_f32 v245, v245, v229, v230
    v_max3_f32 v244, v244, v231, v232
    v_min3_f32 v245, v245, v231, v232
    v_max_f32 v244, v244, v233
    v_min_f32 v245, v245, v233
    v_mul_f32 v245, -1.0, v245
    s_nop 1
    v_permlane32_swap_b32 v244, v245
    v_max_f32 v244, v244, v245
    v_mov_b32 v245, v244
    s_nop 1
    v_permlane32_swap_b32 v244, v245
    v_mul_f32 v244, v244, v211
    v_mul_f32 v245, v245, v211
    v_fma_f32 v112, -v220, v211, -v245
    v_fma_f32 v113, -v221, v211, -v245
    v_fma_f32 v220, v220, v211, -v244
    v_fma_f32 v221, v221, v211, -v244
    v_fma_f32 v114, -v222, v211, -v245
    v_fma_f32 v115, -v223, v211, -v245
    v_fma_f32 v222, v222, v211, -v244
    v_fma_f32 v223, v223, v211, -v244
    v_fma_f32 v116, -v224, v211, -v245
    v_fma_f32 v117, -v225, v211, -v245
    v_fma_f32 v224, v224, v211, -v244
    v_fma_f32 v225, v225, v211, -v244
    v_fma_f32 v118, -v226, v211, -v245
    v_fma_f32 v119, -v227, v211, -v245
    s_lshl_b32 s94, s45, 13
    s_add_u32 s94, s94, 32768
    v_lshrrev_b32 v96, 1, v204
    v_add_u32 v96, s94, v96
    s_mov_b32 s94, 0x40404040
    s_mov_b32 s95, 0x40404040
    s_waitcnt vmcnt(15)
    v_cndmask_b32 v17, v17, 1.0, s[94:95]
    v_cvt_pk_bf16_f32 v16, v16, v17
    v_cvt_pk_bf16_f32 v17, v18, v19
    ds_write_b64 v96, v[16:17] offset:0
    s_waitcnt vmcnt(14)
    v_cndmask_b32 v21, v21, 1.0, s[94:95]
    v_cvt_pk_bf16_f32 v20, v20, v21
    v_cvt_pk_bf16_f32 v21, v22, v23
    ds_write_b64 v96, v[20:21] offset:512
    s_waitcnt vmcnt(13)
    v_cndmask_b32 v25, v25, 1.0, s[94:95]
    v_cvt_pk_bf16_f32 v24, v24, v25
    v_cvt_pk_bf16_f32 v25, v26, v27
    ds_write_b64 v96, v[24:25] offset:1024
    s_waitcnt vmcnt(12)
    v_cndmask_b32 v29, v29, 1.0, s[94:95]
    v_cvt_pk_bf16_f32 v28, v28, v29
    v_cvt_pk_bf16_f32 v29, v30, v31
    ds_write_b64 v96, v[28:29] offset:1536
    s_waitcnt vmcnt(11)
    v_cndmask_b32 v33, v33, 1.0, s[94:95]
    v_cvt_pk_bf16_f32 v32, v32, v33
    v_cvt_pk_bf16_f32 v33, v34, v35
    ds_write_b64 v96, v[32:33] offset:2048
    s_waitcnt vmcnt(10)
    v_cndmask_b32 v37, v37, 1.0, s[94:95]
    v_cvt_pk_bf16_f32 v36, v36, v37
    v_cvt_pk_bf16_f32 v37, v38, v39
    ds_write_b64 v96, v[36:37] offset:2560
    s_waitcnt vmcnt(9)
    v_cndmask_b32 v41, v41, 1.0, s[94:95]
    v_cvt_pk_bf16_f32 v40, v40, v41
    v_cvt_pk_bf16_f32 v41, v42, v43
    ds_write_b64 v96, v[40:41] offset:3072
    s_waitcnt vmcnt(8)
    v_cndmask_b32 v45, v45, 1.0, s[94:95]
    v_cvt_pk_bf16_f32 v44, v44, v45
    v_cvt_pk_bf16_f32 v45, v46, v47
    ds_write_b64 v96, v[44:45] offset:3584
    s_waitcnt vmcnt(7)
    v_cndmask_b32 v49, v49, 1.0, s[94:95]
    v_cvt_pk_bf16_f32 v48, v48, v49
    v_cvt_pk_bf16_f32 v49, v50, v51
    ds_write_b64 v96, v[48:49] offset:4096
    s_waitcnt vmcnt(6)
    v_cndmask_b32 v53, v53, 1.0, s[94:95]
    v_cvt_pk_bf16_f32 v52, v52, v53
    v_cvt_pk_bf16_f32 v53, v54, v55
    ds_write_b64 v96, v[52:53] offset:4608
    s_waitcnt vmcnt(5)
    v_cndmask_b32 v57, v57, 1.0, s[94:95]
    v_cvt_pk_bf16_f32 v56, v56, v57
    v_cvt_pk_bf16_f32 v57, v58, v59
    ds_write_b64 v96, v[56:57] offset:5120
    s_waitcnt vmcnt(4)
    v_cndmask_b32 v61, v61, 1.0, s[94:95]
    v_cvt_pk_bf16_f32 v60, v60, v61
    v_cvt_pk_bf16_f32 v61, v62, v63
    ds_write_b64 v96, v[60:61] offset:5632
    s_waitcnt vmcnt(3)
    v_cndmask_b32 v65, v65, 1.0, s[94:95]
    v_cvt_pk_bf16_f32 v64, v64, v65
    v_cvt_pk_bf16_f32 v65, v66, v67
    ds_write_b64 v96, v[64:65] offset:6144
    s_waitcnt vmcnt(2)
    v_cndmask_b32 v69, v69, 1.0, s[94:95]
    v_cvt_pk_bf16_f32 v68, v68, v69
    v_cvt_pk_bf16_f32 v69, v70, v71
    ds_write_b64 v96, v[68:69] offset:6656
    s_waitcnt vmcnt(1)
    v_cndmask_b32 v73, v73, 1.0, s[94:95]
    v_cvt_pk_bf16_f32 v72, v72, v73
    v_cvt_pk_bf16_f32 v73, v74, v75
    ds_write_b64 v96, v[72:73] offset:7168
    s_waitcnt vmcnt(0)
    v_cndmask_b32 v77, v77, 1.0, s[94:95]
    v_cvt_pk_bf16_f32 v76, v76, v77
    v_cvt_pk_bf16_f32 v77, v78, v79
    ds_write_b64 v96, v[76:77] offset:7680
    v_fma_f32 v226, v226, v211, -v244
    v_fma_f32 v227, v227, v211, -v244
    v_fma_f32 v120, -v228, v211, -v245
    v_fma_f32 v121, -v229, v211, -v245
    v_fma_f32 v228, v228, v211, -v244
    v_fma_f32 v229, v229, v211, -v244
    v_fma_f32 v122, -v230, v211, -v245
    v_fma_f32 v123, -v231, v211, -v245
    v_fma_f32 v230, v230, v211, -v244
    v_fma_f32 v231, v231, v211, -v244
    v_fma_f32 v124, -v232, v211, -v245
    v_fma_f32 v125, -v233, v211, -v245
    v_fma_f32 v232, v232, v211, -v244
    v_fma_f32 v233, v233, v211, -v244
    v_exp_f32 v112, v112
    v_exp_f32 v220, v220
    v_exp_f32 v113, v113
    v_exp_f32 v221, v221
    v_exp_f32 v114, v114
    v_exp_f32 v222, v222
    v_exp_f32 v115, v115
    v_exp_f32 v223, v223
    v_exp_f32 v116, v116
    v_exp_f32 v224, v224
    v_exp_f32 v117, v117
    v_exp_f32 v225, v225
    v_exp_f32 v118, v118
    v_exp_f32 v226, v226
    v_exp_f32 v119, v119
    v_exp_f32 v227, v227
    v_exp_f32 v120, v120
    v_exp_f32 v228, v228
    v_exp_f32 v121, v121
    v_exp_f32 v229, v229
    v_exp_f32 v122, v122
    v_exp_f32 v230, v230
    v_exp_f32 v123, v123
    v_exp_f32 v231, v231
    v_exp_f32 v124, v124
    v_exp_f32 v232, v232
    v_exp_f32 v125, v125
    v_exp_f32 v233, v233
    v_cvt_pk_bf16_f32 v0, v220, v221
    v_cvt_pk_bf16_f32 v8, v112, v113
    v_cvt_pk_bf16_f32 v1, v222, v223
    v_cvt_pk_bf16_f32 v9, v114, v115
    v_cvt_pk_bf16_f32 v2, v224, v225
    v_cvt_pk_bf16_f32 v10, v116, v117
    v_cvt_pk_bf16_f32 v3, v226, v227
    v_cvt_pk_bf16_f32 v11, v118, v119
    v_cvt_pk_bf16_f32 v4, v228, v229
    v_cvt_pk_bf16_f32 v12, v120, v121
    v_cvt_pk_bf16_f32 v5, v230, v231
    v_cvt_pk_bf16_f32 v13, v122, v123
    v_cvt_pk_bf16_f32 v6, v232, v233
    v_cvt_pk_bf16_f32 v14, v124, v125
    v_mov_b32 v7, 0
    v_mov_b32 v15, 0
    s_setprio 2
    s_waitcnt lgkmcnt(0)
    s_barrier
    ds_read_b64_tr_b16 v[32:33], v184 offset:36864
    ds_read_b64_tr_b16 v[34:35], v184 offset:37120
    ds_read_b64_tr_b16 v[36:37], v184 offset:37888
    ds_read_b64_tr_b16 v[38:39], v184 offset:38144
    ds_read_b64_tr_b16 v[40:41], v184 offset:38912
    ds_read_b64_tr_b16 v[42:43], v184 offset:39168
    ds_read_b64_tr_b16 v[44:45], v184 offset:39936
    ds_read_b64_tr_b16 v[46:47], v184 offset:40192
    ds_read_b64_tr_b16 v[48:49], v184 offset:45056
    ds_read_b64_tr_b16 v[50:51], v184 offset:45312
    ds_read_b64_tr_b16 v[52:53], v184 offset:46080
    ds_read_b64_tr_b16 v[54:55], v184 offset:46336
    ds_read_b64_tr_b16 v[56:57], v184 offset:47104
    ds_read_b64_tr_b16 v[58:59], v184 offset:47360
    ds_read_b64_tr_b16 v[60:61], v184 offset:48128
    ds_read_b64_tr_b16 v[62:63], v184 offset:48384
    ds_read_b64_tr_b16 v[64:65], v184 offset:53248
    ds_read_b64_tr_b16 v[66:67], v184 offset:53504
    ds_read_b64_tr_b16 v[68:69], v184 offset:54272
    ds_read_b64_tr_b16 v[70:71], v184 offset:54528
    ds_read_b64_tr_b16 v[72:73], v184 offset:55296
    ds_read_b64_tr_b16 v[74:75], v184 offset:55552
    ds_read_b64_tr_b16 v[76:77], v184 offset:56320
    ds_read_b64_tr_b16 v[78:79], v184 offset:56576
    ds_read_b64_tr_b16 v[160:161], v184 offset:61440
    ds_read_b64_tr_b16 v[162:163], v184 offset:61696
    ds_read_b64_tr_b16 v[164:165], v184 offset:62464
    ds_read_b64_tr_b16 v[166:167], v184 offset:62720
    ds_read_b64_tr_b16 v[168:169], v184 offset:63488
    ds_read_b64_tr_b16 v[170:171], v184 offset:63744
    ds_read_b64_tr_b16 v[172:173], v184 offset:64512
    ds_read_b64_tr_b16 v[174:175], v184 offset:64768
    v_mov_b32 v255, 1
    s_waitcnt lgkmcnt(15)
    v_mfma_f32_32x32x16_bf16 v[16:31], v[32:35], v[144:147], 0
    v_mfma_f32_32x32x16_bf16 v[80:95], v[40:43], v[152:155], 0
    v_mfma_f32_32x32x16_bf16 v[16:31], v[36:39], v[148:151], v[16:31]
    v_mfma_f32_32x32x16_bf16 v[80:95], v[44:47], v[156:159], v[80:95]
    v_mfma_f32_32x32x16_bf16 v[96:111], v[48:51], v[188:191], 0
    v_mfma_f32_32x32x16_bf16 v[32:47], v[56:59], v[212:215], 0
    v_mfma_f32_32x32x16_bf16 v[96:111], v[52:55], v[192:195], v[96:111]
    v_mfma_f32_32x32x16_bf16 v[32:47], v[60:63], v[216:219], v[32:47]
    s_nop 7
    v_mul_f32 v252, v28, v93
    v_mul_f32 v253, v29, v93
    v_fmac_f32 v252, v92, v29
    v_fmac_f32 v252, 0x358637bd, v253
    v_rcp_f32 v252, v252
    s_nop 0
    v_mul_f32 v254, v93, v252
    v_mul_f32 v185, v93, v252
    v_mul_f32 v186, v29, v252
    v_mul_f32 v187, v29, v252
    v_permlane32_swap_b32 v254, v185
    s_nop 0
    v_permlane32_swap_b32 v186, v187
    v_cndmask_b32 v185, v254, 0, s[60:61]
    v_cndmask_b32 v187, v186, 0, s[60:61]
    v_mul_f32 v16, v16, v254
    v_mul_f32 v17, v17, v254
    v_mul_f32 v18, v18, v254
    v_mul_f32 v19, v19, v254
    v_mul_f32 v20, v20, v254
    v_mul_f32 v21, v21, v254
    v_mul_f32 v22, v22, v254
    v_mul_f32 v23, v23, v254
    v_mul_f32 v24, v24, v254
    v_mul_f32 v25, v25, v254
    v_mul_f32 v26, v26, v254
    v_mul_f32 v27, v27, v254
    v_mul_f32 v28, v28, v185
    v_mul_f32 v29, v29, v185
    v_mul_f32 v30, v30, v185
    v_mul_f32 v31, v31, v185
    v_fmac_f32 v16, v80, v186
    v_fmac_f32 v17, v81, v186
    v_fmac_f32 v18, v82, v186
    v_fmac_f32 v19, v83, v186
    v_fmac_f32 v20, v84, v186
    v_fmac_f32 v21, v85, v186
    v_fmac_f32 v22, v86, v186
    v_fmac_f32 v23, v87, v186
    v_fmac_f32 v24, v88, v186
    v_fmac_f32 v25, v89, v186
    v_fmac_f32 v26, v90, v186
    v_fmac_f32 v27, v91, v186
    v_fmac_f32 v28, v92, v187
    v_fmac_f32 v29, v93, v187
    v_fmac_f32 v30, v94, v187
    v_fmac_f32 v31, v95, v187
    v_cvt_pk_bf16_f32 v16, v16, v17
    v_cvt_pk_bf16_f32 v17, v18, v19
    v_cvt_pk_bf16_f32 v18, v20, v21
    v_cvt_pk_bf16_f32 v19, v22, v23
    v_cvt_pk_bf16_f32 v20, v24, v25
    v_cvt_pk_bf16_f32 v21, v26, v27
    v_cvt_pk_bf16_f32 v22, v28, v29
    v_cvt_pk_bf16_f32 v23, v30, v31
    s_add_u32 s94, s54, 0
    buffer_store_dwordx4 v[16:19], v204, s[40:43], s94 offen offset:0 sc1
    buffer_store_dwordx4 v[20:23], v204, s[40:43], s94 offen offset:1024 sc1
    s_waitcnt lgkmcnt(14)
    v_mfma_f32_32x32x16_bf16 v[48:63], v[64:67], v[128:131], 0
    s_waitcnt lgkmcnt(10)
    v_mfma_f32_32x32x16_bf16 v[80:95], v[72:75], v[136:139], 0
    v_mfma_f32_32x32x16_bf16 v[48:63], v[68:71], v[132:135], v[48:63]
    s_waitcnt lgkmcnt(8)
    v_mfma_f32_32x32x16_bf16 v[80:95], v[76:79], v[140:143], v[80:95]
    v_mul_f32 v252, v108, v45
    v_mul_f32 v253, v109, v45
    v_fmac_f32 v252, v44, v109
    v_fmac_f32 v252, 0x358637bd, v253
    v_rcp_f32 v252, v252
    s_nop 0
    v_mul_f32 v254, v45, v252
    v_mul_f32 v185, v45, v252
    v_mul_f32 v186, v109, v252
    v_mul_f32 v187, v109, v252
    v_permlane32_swap_b32 v254, v185
    s_nop 0
    v_permlane32_swap_b32 v186, v187
    v_cndmask_b32 v185, v254, 0, s[60:61]
    v_cndmask_b32 v187, v186, 0, s[60:61]
    v_mul_f32 v96, v96, v254
    v_mul_f32 v97, v97, v254
    v_mul_f32 v98, v98, v254
    v_mul_f32 v99, v99, v254
    v_mul_f32 v100, v100, v254
    v_mul_f32 v101, v101, v254
    v_mul_f32 v102, v102, v254
    v_mul_f32 v103, v103, v254
    v_mul_f32 v104, v104, v254
    v_mul_f32 v105, v105, v254
    v_mul_f32 v106, v106, v254
    v_mul_f32 v107, v107, v254
    v_mul_f32 v108, v108, v185
    v_mul_f32 v109, v109, v185
    v_mul_f32 v110, v110, v185
    v_mul_f32 v111, v111, v185
    v_fmac_f32 v96, v32, v186
    v_fmac_f32 v97, v33, v186
    v_fmac_f32 v98, v34, v186
    v_fmac_f32 v99, v35, v186
    v_fmac_f32 v100, v36, v186
    v_fmac_f32 v101, v37, v186
    v_fmac_f32 v102, v38, v186
    v_fmac_f32 v103, v39, v186
    v_fmac_f32 v104, v40, v186
    v_fmac_f32 v105, v41, v186
    v_fmac_f32 v106, v42, v186
    v_fmac_f32 v107, v43, v186
    v_fmac_f32 v108, v44, v187
    v_fmac_f32 v109, v45, v187
    v_fmac_f32 v110, v46, v187
    v_fmac_f32 v111, v47, v187
    v_cvt_pk_bf16_f32 v96, v96, v97
    v_cvt_pk_bf16_f32 v97, v98, v99
    v_cvt_pk_bf16_f32 v98, v100, v101
    v_cvt_pk_bf16_f32 v99, v102, v103
    v_cvt_pk_bf16_f32 v100, v104, v105
    v_cvt_pk_bf16_f32 v101, v106, v107
    v_cvt_pk_bf16_f32 v102, v108, v109
    v_cvt_pk_bf16_f32 v103, v110, v111
    s_add_u32 s94, s54, 4096
    buffer_store_dwordx4 v[96:99], v204, s[40:43], s94 offen offset:0 sc1
    buffer_store_dwordx4 v[100:103], v204, s[40:43], s94 offen offset:1024 sc1
    s_waitcnt lgkmcnt(6)
    v_mfma_f32_32x32x16_bf16 v[64:79], v[160:163], v[0:3], 0
    s_waitcnt lgkmcnt(2)
    v_mfma_f32_32x32x16_bf16 v[32:47], v[168:171], v[8:11], 0
    v_mfma_f32_32x32x16_bf16 v[64:79], v[164:167], v[4:7], v[64:79]
    s_waitcnt lgkmcnt(0)
    v_mfma_f32_32x32x16_bf16 v[32:47], v[172:175], v[12:15], v[32:47]
    v_mul_f32 v252, v60, v93
    v_mul_f32 v253, v61, v93
    v_fmac_f32 v252, v92, v61
    v_fmac_f32 v252, 0x358637bd, v253
    v_rcp_f32 v252, v252
    s_nop 0
    v_mul_f32 v254, v93, v252
    v_mul_f32 v185, v93, v252
    v_mul_f32 v186, v61, v252
    v_mul_f32 v187, v61, v252
    v_permlane32_swap_b32 v254, v185
    s_nop 0
    v_permlane32_swap_b32 v186, v187
    v_cndmask_b32 v185, v254, 0, s[60:61]
    v_cndmask_b32 v187, v186, 0, s[60:61]
    v_mul_f32 v48, v48, v254
    v_mul_f32 v49, v49, v254
    v_mul_f32 v50, v50, v254
    v_mul_f32 v51, v51, v254
    v_mul_f32 v52, v52, v254
    v_mul_f32 v53, v53, v254
    v_mul_f32 v54, v54, v254
    v_mul_f32 v55, v55, v254
    v_mul_f32 v56, v56, v254
    v_mul_f32 v57, v57, v254
    v_mul_f32 v58, v58, v254
    v_mul_f32 v59, v59, v254
    v_mul_f32 v60, v60, v185
    v_mul_f32 v61, v61, v185
    v_mul_f32 v62, v62, v185
    v_mul_f32 v63, v63, v185
    v_fmac_f32 v48, v80, v186
    v_fmac_f32 v49, v81, v186
    v_fmac_f32 v50, v82, v186
    v_fmac_f32 v51, v83, v186
    v_fmac_f32 v52, v84, v186
    v_fmac_f32 v53, v85, v186
    v_fmac_f32 v54, v86, v186
    v_fmac_f32 v55, v87, v186
    v_fmac_f32 v56, v88, v186
    v_fmac_f32 v57, v89, v186
    v_fmac_f32 v58, v90, v186
    v_fmac_f32 v59, v91, v186
    v_fmac_f32 v60, v92, v187
    v_fmac_f32 v61, v93, v187
    v_fmac_f32 v62, v94, v187
    v_fmac_f32 v63, v95, v187
    v_cvt_pk_bf16_f32 v48, v48, v49
    v_cvt_pk_bf16_f32 v49, v50, v51
    v_cvt_pk_bf16_f32 v50, v52, v53
    v_cvt_pk_bf16_f32 v51, v54, v55
    v_cvt_pk_bf16_f32 v52, v56, v57
    v_cvt_pk_bf16_f32 v53, v58, v59
    v_cvt_pk_bf16_f32 v54, v60, v61
    v_cvt_pk_bf16_f32 v55, v62, v63
    s_add_u32 s94, s54, 8192
    buffer_store_dwordx4 v[48:51], v204, s[40:43], s94 offen offset:0 sc1
    buffer_store_dwordx4 v[52:55], v204, s[40:43], s94 offen offset:1024 sc1
    v_mul_f32 v252, v76, v45
    v_mul_f32 v253, v77, v45
    v_fmac_f32 v252, v44, v77
    v_fmac_f32 v252, 0x358637bd, v253
    v_rcp_f32 v252, v252
    s_nop 0
    v_mul_f32 v254, v45, v252
    v_mul_f32 v185, v45, v252
    v_mul_f32 v186, v77, v252
    v_mul_f32 v187, v77, v252
    v_permlane32_swap_b32 v254, v185
    s_nop 0
    v_permlane32_swap_b32 v186, v187
    v_cndmask_b32 v185, v254, 0, s[60:61]
    v_cndmask_b32 v187, v186, 0, s[60:61]
    v_mul_f32 v64, v64, v254
    v_mul_f32 v65, v65, v254
    v_mul_f32 v66, v66, v254
    v_mul_f32 v67, v67, v254
    v_mul_f32 v68, v68, v254
    v_mul_f32 v69, v69, v254
    v_mul_f32 v70, v70, v254
    v_mul_f32 v71, v71, v254
    v_mul_f32 v72, v72, v254
    v_mul_f32 v73, v73, v254
    v_mul_f32 v74, v74, v254
    v_mul_f32 v75, v75, v254
    v_mul_f32 v76, v76, v185
    v_mul_f32 v77, v77, v185
    v_mul_f32 v78, v78, v185
    v_mul_f32 v79, v79, v185
    v_fmac_f32 v64, v32, v186
    v_fmac_f32 v65, v33, v186
    v_fmac_f32 v66, v34, v186
    v_fmac_f32 v67, v35, v186
    v_fmac_f32 v68, v36, v186
    v_fmac_f32 v69, v37, v186
    v_fmac_f32 v70, v38, v186
    v_fmac_f32 v71, v39, v186
    v_fmac_f32 v72, v40, v186
    v_fmac_f32 v73, v41, v186
    v_fmac_f32 v74, v42, v186
    v_fmac_f32 v75, v43, v186
    v_fmac_f32 v76, v44, v187
    v_fmac_f32 v77, v45, v187
    v_fmac_f32 v78, v46, v187
    v_fmac_f32 v79, v47, v187
    v_cvt_pk_bf16_f32 v64, v64, v65
    v_cvt_pk_bf16_f32 v65, v66, v67
    v_cvt_pk_bf16_f32 v66, v68, v69
    v_cvt_pk_bf16_f32 v67, v70, v71
    v_cvt_pk_bf16_f32 v68, v72, v73
    v_cvt_pk_bf16_f32 v69, v74, v75
    v_cvt_pk_bf16_f32 v70, v76, v77
    v_cvt_pk_bf16_f32 v71, v78, v79
    s_add_u32 s94, s54, 12288
    buffer_store_dwordx4 v[64:67], v204, s[40:43], s94 offen offset:0 sc1
    buffer_store_dwordx4 v[68:71], v204, s[40:43], s94 offen offset:1024 sc1
    s_waitcnt vmcnt(6)
    buffer_store_dword v255, v205, s[40:43], s55 offen offset:0 sc1
    s_waitcnt vmcnt(5)
    buffer_store_dword v255, v205, s[40:43], s55 offen offset:8 sc1
    s_waitcnt vmcnt(4)
    buffer_store_dword v255, v205, s[40:43], s55 offen offset:16 sc1
    s_waitcnt vmcnt(3)
    buffer_store_dword v255, v205, s[40:43], s55 offen offset:24 sc1
    s_endpgm
.Lend:
    s_endpgm

.section .rodata,"a"
.p2align 6
.amdhsa_kernel parallel_sum__linear_kernel_hedgehog__glu_gated_reglu__prompt_kernel
    .amdhsa_next_free_vgpr 256
    .amdhsa_next_free_sgpr 102
    .amdhsa_accum_offset 256
    .amdhsa_group_segment_fixed_size 0
    .amdhsa_kernarg_size 88
    .amdhsa_user_sgpr_count 2
    .amdhsa_user_sgpr_kernarg_segment_ptr 1
    .amdhsa_system_sgpr_workgroup_id_x 1
.end_amdhsa_kernel
```
